```python
import torch

def _softmax(x, axis=-1):
    return torch.softmax(x, dim=axis)

def _gelu(x):
    return torch.nn.functional.gelu(x, approximate='tanh')

def _silu(x):
    return torch.nn.functional.silu(x)

def _sigmoid(x):
    return torch.sigmoid(x)

def _layernorm(x, axis=-1, eps=1e-05):
    m = x.mean(dim=axis, keepdim=True)
    v = x.var(dim=axis, keepdim=True, unbiased=False)
    return (x - m) / torch.sqrt(v + eps)

def _scatter_add(tgt, idx, src, axis=0):
    return tgt.clone().index_add_(axis, idx, src)

def _segment_sum(src, seg, n):
    out = torch.zeros((n,) + src.shape[1:], dtype=src.dtype)
    return out.index_add_(0, seg, src)

def _pad(x, pw):
    flat = tuple((v for pair in reversed(pw) for v in pair))
    return torch.nn.functional.pad(x, flat)
kernel_name = 'adaLN_cond__compressed_kv_cla__geglu_ffn__prompt'

def setup_inputs():

    _w = lambda a: (lambda t: t.to(torch.bfloat16) if t.is_floating_point() else t)(torch.as_tensor(a))

    def _A_setup():
        B, H, Sq, Sk, D, M = (1, 32, 2048, 2048, 128, 512)
        Dc = 4 * D
        return {'x': _w((lambda *s: torch.randn(*s, dtype=torch.bfloat16) * 0.05)(B, Sq, M)), 'c_kv': _w((lambda *s: torch.randn(*s, dtype=torch.bfloat16) * 1.6)(B, Sk, Dc)), 'w_q': _w((lambda *s: torch.randn(*s, dtype=torch.bfloat16) * 0.8)(M, H, D) * M ** (-0.5)), 'w_uk': _w((lambda *s: torch.randn(*s, dtype=torch.bfloat16) * 0.8)(Dc, H, D) * Dc ** (-0.5)), 'w_uv': _w((lambda *s: torch.randn(*s, dtype=torch.bfloat16) * 1.6)(Dc, H, D) * Dc ** (-0.5)), 'w_o': _w((lambda *s: torch.randn(*s, dtype=torch.bfloat16) * 1.6)(H, D, M) * (H * D) ** (-0.5))}
    _A_in = _A_setup()

    def _B_setup():
        B, S, D, F = (1, 2048, 512, 1792)
        return {'x': _w((lambda *s: torch.randn(*s, dtype=torch.bfloat16) * 0.05)(B, S, D)), 'w_gate': _w((lambda *s: torch.randn(*s, dtype=torch.bfloat16) * 0.05)(D, F)), 'w_up': _w((lambda *s: torch.randn(*s, dtype=torch.bfloat16) * 0.05)(D, F)), 'w_down': _w((lambda *s: torch.randn(*s, dtype=torch.bfloat16) * 0.05)(F, D))}
    _B_in = _B_setup()
    return {'A_x': _A_in['x'], 'A_c_kv': _A_in['c_kv'], 'A_w_q': _A_in['w_q'], 'A_w_uk': _A_in['w_uk'], 'A_w_uv': _A_in['w_uv'], 'A_w_o': _A_in['w_o'], 'B_x': _B_in['x'], 'B_w_gate': _B_in['w_gate'], 'B_w_up': _B_in['w_up'], 'B_w_down': _B_in['w_down'], 'c': _w((lambda *s: torch.randn(*s, dtype=torch.bfloat16) * 0.1)(1, 512) * 8.0), 'w_mod': _w((lambda *s: torch.randn(*s, dtype=torch.bfloat16) * 0.1)(512, 6 * 512) * 512 ** (-0.5) * 8.0)}

def reference(A_x, A_c_kv, A_w_q, A_w_uk, A_w_uv, A_w_o, B_x, B_w_gate, B_w_up, B_w_down, c, w_mod):

    def _A_ref(x, c_kv, w_q, w_uk, w_uv, w_o):
        B, Sq, M = (x.shape[0], x.shape[1], x.shape[2])
        Sk = c_kv.shape[1]
        H, D = (w_q.shape[1], w_q.shape[2])
        q = torch.einsum('bqm,mhd->bhqd', x, w_q)
        k = torch.einsum('bkc,chd->bhkd', c_kv, w_uk)
        v = torch.einsum('bkc,chd->bhkd', c_kv, w_uv)
        scores = torch.einsum('bhqd,bhkd->bhqk', q, k) * D ** (-0.5)
        off = Sk - Sq
        qi = torch.arange(Sq)[:, None]
        kj = torch.arange(Sk)[None, :]
        cmask = kj <= qi + off
        scores = torch.where(cmask[None, None], scores, -1000000000.0)
        p = _softmax(scores, axis=-1)
        ctx = torch.einsum('bhqk,bhkd->bhqd', p, v)
        return torch.einsum('bhqd,hdm->bqm', ctx, w_o)

    def _B_ref(x, w_gate, w_up, w_down):
        return _gelu(x @ w_gate) * (x @ w_up) @ w_down
    x = A_x
    mod = (_silu(c) @ w_mod).reshape(c.shape[0], 6, 1, -1)
    sa, ca, ga, sb, cb, gb = (mod[:, 0].clone(), mod[:, 1].clone(), mod[:, 2].clone(), mod[:, 3].clone(), mod[:, 4].clone(), mod[:, 5].clone())
    h = _layernorm(x, axis=-1) * (1 + ca) + sa
    x = x + ga * _A_ref(h, A_c_kv, A_w_q, A_w_uk, A_w_uv, A_w_o)
    h = _layernorm(x, axis=-1) * (1 + cb) + sb
    x = x + gb * _B_ref(h, B_w_gate, B_w_up, B_w_down)
    return x
```

```asm
; @launch kernel=front_kernel grid=(176,1,1) block=(256,1,1) lds=10240
; @launch kernel=qkv_kernel grid=(256,1,1) block=(256,1,1) lds=131072
; @launch kernel=attn_kernel grid=(256,1,1) block=(512,1,1) lds=135168
; @launch kernel=oproj_kernel grid=(256,1,1) block=(256,1,1) lds=131072
; @launch kernel=red_kernel grid=(256,1,1) block=(256,1,1) lds=256
; @launch kernel=ffn1_kernel grid=(224,1,1) block=(256,1,1) lds=131072
; @launch kernel=ffn2_kernel grid=(256,1,1) block=(256,1,1) lds=131072
.amdgcn_target "amdgcn-amd-amdhsa--gfx950"
.text
.globl front_kernel
.p2align 8
.type front_kernel,@function
front_kernel:
    s_cmp_ge_u32 s2, 176
    s_cbranch_scc1 L_fr_end
    s_cmp_ge_u32 s2, 112
    s_cbranch_scc1 L_fr_pf
    s_load_dwordx2 s[4:5], s[0:1], 80
    s_load_dwordx2 s[6:7], s[0:1], 88
    s_load_dwordx2 s[8:9], s[0:1], 112
    s_load_dwordx2 s[36:37], s[0:1], 8
    v_and_b32 v1, 7, v0
    v_lshrrev_b32 v2, 3, v0
    s_cmp_ge_u32 s2, 48
    s_cbranch_scc1 L_fr_rel
    s_mov_b32 s20, 98304
    v_mul_lo_u32 v3, v2, s20
    v_lshl_add_u32 v3, v1, 4, v3
    s_lshl_b32 s21, s2, 7
    v_add_u32 v3, s21, v3
    v_lshlrev_b32 v4, 2, v0
    s_waitcnt lgkmcnt(0)
    s_mov_b32 s12, s4
    s_mov_b32 s13, s5
    s_and_b32 s13, s13, 0xffff
    s_mov_b32 s14, 1024
    s_mov_b32 s15, 0x00020000
    s_mov_b32 s16, s6
    s_mov_b32 s17, s7
    s_and_b32 s17, s17, 0xffff
    s_mov_b32 s18, 3145728
    s_mov_b32 s19, 0x00020000
    s_mov_b32 s24, s8
    s_mov_b32 s25, s9
    s_and_b32 s25, s25, 0xffff
    s_mov_b32 s26, 12288
    s_mov_b32 s27, 0x00020000
    buffer_load_dword v5, v4, s[12:15], 0 offen
    s_mov_b32 s22, 0
    buffer_load_dwordx4 v[32:35], v3, s[16:19], s22 offen
    s_mov_b32 s22, 6144
    buffer_load_dwordx4 v[36:39], v3, s[16:19], s22 offen
    s_mov_b32 s22, 12288
    buffer_load_dwordx4 v[40:43], v3, s[16:19], s22 offen
    s_mov_b32 s22, 18432
    buffer_load_dwordx4 v[44:47], v3, s[16:19], s22 offen
    s_mov_b32 s22, 24576
    buffer_load_dwordx4 v[48:51], v3, s[16:19], s22 offen
    s_mov_b32 s22, 30720
    buffer_load_dwordx4 v[52:55], v3, s[16:19], s22 offen
    s_mov_b32 s22, 36864
    buffer_load_dwordx4 v[56:59], v3, s[16:19], s22 offen
    s_mov_b32 s22, 43008
    buffer_load_dwordx4 v[60:63], v3, s[16:19], s22 offen
    s_mov_b32 s22, 49152
    buffer_load_dwordx4 v[64:67], v3, s[16:19], s22 offen
    s_mov_b32 s22, 55296
    buffer_load_dwordx4 v[68:71], v3, s[16:19], s22 offen
    s_mov_b32 s22, 61440
    buffer_load_dwordx4 v[72:75], v3, s[16:19], s22 offen
    s_mov_b32 s22, 67584
    buffer_load_dwordx4 v[76:79], v3, s[16:19], s22 offen
    s_mov_b32 s22, 73728
    buffer_load_dwordx4 v[80:83], v3, s[16:19], s22 offen
    s_mov_b32 s22, 79872
    buffer_load_dwordx4 v[84:87], v3, s[16:19], s22 offen
    s_mov_b32 s22, 86016
    buffer_load_dwordx4 v[88:91], v3, s[16:19], s22 offen
    s_mov_b32 s22, 92160
    buffer_load_dwordx4 v[92:95], v3, s[16:19], s22 offen
    s_waitcnt vmcnt(16)
    v_lshlrev_b32 v6, 16, v5
    v_and_b32 v7, 0xffff0000, v5
    v_mul_f32 v8, -1.4426950408889634, v6
    v_exp_f32 v8, v8
    s_nop 0
    v_add_f32 v8, 1.0, v8
    v_rcp_f32 v8, v8
    s_nop 0
    v_mul_f32 v6, v8, v6
    v_mul_f32 v8, -1.4426950408889634, v7
    v_exp_f32 v8, v8
    s_nop 0
    v_add_f32 v8, 1.0, v8
    v_rcp_f32 v8, v8
    s_nop 0
    v_mul_f32 v7, v8, v7
    v_lshlrev_b32 v9, 3, v0
    ds_write_b64 v9, v[6:7]
    s_waitcnt lgkmcnt(0)
    s_barrier
    v_lshlrev_b32 v9, 6, v2
    ds_read_b128 v[12:15], v9 offset:0
    ds_read_b128 v[16:19], v9 offset:16
    ds_read_b128 v[20:23], v9 offset:32
    ds_read_b128 v[24:27], v9 offset:48
    v_mov_b32 v28, 0
    v_mov_b32 v29, 0
    v_mov_b32 v30, 0
    v_mov_b32 v31, 0
    v_mov_b32 v5, 0
    v_mov_b32 v6, 0
    v_mov_b32 v7, 0
    v_mov_b32 v8, 0
    s_waitcnt vmcnt(0) lgkmcnt(0)
    v_lshlrev_b32 v10, 16, v32
    v_and_b32 v11, 0xffff0000, v32
    v_fmac_f32 v28, v10, v12
    v_fmac_f32 v29, v11, v12
    v_lshlrev_b32 v10, 16, v33
    v_and_b32 v11, 0xffff0000, v33
    v_fmac_f32 v30, v10, v12
    v_fmac_f32 v31, v11, v12
    v_lshlrev_b32 v10, 16, v34
    v_and_b32 v11, 0xffff0000, v34
    v_fmac_f32 v5, v10, v12
    v_fmac_f32 v6, v11, v12
    v_lshlrev_b32 v10, 16, v35
    v_and_b32 v11, 0xffff0000, v35
    v_fmac_f32 v7, v10, v12
    v_fmac_f32 v8, v11, v12
    v_lshlrev_b32 v10, 16, v36
    v_and_b32 v11, 0xffff0000, v36
    v_fmac_f32 v28, v10, v13
    v_fmac_f32 v29, v11, v13
    v_lshlrev_b32 v10, 16, v37
    v_and_b32 v11, 0xffff0000, v37
    v_fmac_f32 v30, v10, v13
    v_fmac_f32 v31, v11, v13
    v_lshlrev_b32 v10, 16, v38
    v_and_b32 v11, 0xffff0000, v38
    v_fmac_f32 v5, v10, v13
    v_fmac_f32 v6, v11, v13
    v_lshlrev_b32 v10, 16, v39
    v_and_b32 v11, 0xffff0000, v39
    v_fmac_f32 v7, v10, v13
    v_fmac_f32 v8, v11, v13
    v_lshlrev_b32 v10, 16, v40
    v_and_b32 v11, 0xffff0000, v40
    v_fmac_f32 v28, v10, v14
    v_fmac_f32 v29, v11, v14
    v_lshlrev_b32 v10, 16, v41
    v_and_b32 v11, 0xffff0000, v41
    v_fmac_f32 v30, v10, v14
    v_fmac_f32 v31, v11, v14
    v_lshlrev_b32 v10, 16, v42
    v_and_b32 v11, 0xffff0000, v42
    v_fmac_f32 v5, v10, v14
    v_fmac_f32 v6, v11, v14
    v_lshlrev_b32 v10, 16, v43
    v_and_b32 v11, 0xffff0000, v43
    v_fmac_f32 v7, v10, v14
    v_fmac_f32 v8, v11, v14
    v_lshlrev_b32 v10, 16, v44
    v_and_b32 v11, 0xffff0000, v44
    v_fmac_f32 v28, v10, v15
    v_fmac_f32 v29, v11, v15
    v_lshlrev_b32 v10, 16, v45
    v_and_b32 v11, 0xffff0000, v45
    v_fmac_f32 v30, v10, v15
    v_fmac_f32 v31, v11, v15
    v_lshlrev_b32 v10, 16, v46
    v_and_b32 v11, 0xffff0000, v46
    v_fmac_f32 v5, v10, v15
    v_fmac_f32 v6, v11, v15
    v_lshlrev_b32 v10, 16, v47
    v_and_b32 v11, 0xffff0000, v47
    v_fmac_f32 v7, v10, v15
    v_fmac_f32 v8, v11, v15
    v_lshlrev_b32 v10, 16, v48
    v_and_b32 v11, 0xffff0000, v48
    v_fmac_f32 v28, v10, v16
    v_fmac_f32 v29, v11, v16
    v_lshlrev_b32 v10, 16, v49
    v_and_b32 v11, 0xffff0000, v49
    v_fmac_f32 v30, v10, v16
    v_fmac_f32 v31, v11, v16
    v_lshlrev_b32 v10, 16, v50
    v_and_b32 v11, 0xffff0000, v50
    v_fmac_f32 v5, v10, v16
    v_fmac_f32 v6, v11, v16
    v_lshlrev_b32 v10, 16, v51
    v_and_b32 v11, 0xffff0000, v51
    v_fmac_f32 v7, v10, v16
    v_fmac_f32 v8, v11, v16
    v_lshlrev_b32 v10, 16, v52
    v_and_b32 v11, 0xffff0000, v52
    v_fmac_f32 v28, v10, v17
    v_fmac_f32 v29, v11, v17
    v_lshlrev_b32 v10, 16, v53
    v_and_b32 v11, 0xffff0000, v53
    v_fmac_f32 v30, v10, v17
    v_fmac_f32 v31, v11, v17
    v_lshlrev_b32 v10, 16, v54
    v_and_b32 v11, 0xffff0000, v54
    v_fmac_f32 v5, v10, v17
    v_fmac_f32 v6, v11, v17
    v_lshlrev_b32 v10, 16, v55
    v_and_b32 v11, 0xffff0000, v55
    v_fmac_f32 v7, v10, v17
    v_fmac_f32 v8, v11, v17
    v_lshlrev_b32 v10, 16, v56
    v_and_b32 v11, 0xffff0000, v56
    v_fmac_f32 v28, v10, v18
    v_fmac_f32 v29, v11, v18
    v_lshlrev_b32 v10, 16, v57
    v_and_b32 v11, 0xffff0000, v57
    v_fmac_f32 v30, v10, v18
    v_fmac_f32 v31, v11, v18
    v_lshlrev_b32 v10, 16, v58
    v_and_b32 v11, 0xffff0000, v58
    v_fmac_f32 v5, v10, v18
    v_fmac_f32 v6, v11, v18
    v_lshlrev_b32 v10, 16, v59
    v_and_b32 v11, 0xffff0000, v59
    v_fmac_f32 v7, v10, v18
    v_fmac_f32 v8, v11, v18
    v_lshlrev_b32 v10, 16, v60
    v_and_b32 v11, 0xffff0000, v60
    v_fmac_f32 v28, v10, v19
    v_fmac_f32 v29, v11, v19
    v_lshlrev_b32 v10, 16, v61
    v_and_b32 v11, 0xffff0000, v61
    v_fmac_f32 v30, v10, v19
    v_fmac_f32 v31, v11, v19
    v_lshlrev_b32 v10, 16, v62
    v_and_b32 v11, 0xffff0000, v62
    v_fmac_f32 v5, v10, v19
    v_fmac_f32 v6, v11, v19
    v_lshlrev_b32 v10, 16, v63
    v_and_b32 v11, 0xffff0000, v63
    v_fmac_f32 v7, v10, v19
    v_fmac_f32 v8, v11, v19
    v_lshlrev_b32 v10, 16, v64
    v_and_b32 v11, 0xffff0000, v64
    v_fmac_f32 v28, v10, v20
    v_fmac_f32 v29, v11, v20
    v_lshlrev_b32 v10, 16, v65
    v_and_b32 v11, 0xffff0000, v65
    v_fmac_f32 v30, v10, v20
    v_fmac_f32 v31, v11, v20
    v_lshlrev_b32 v10, 16, v66
    v_and_b32 v11, 0xffff0000, v66
    v_fmac_f32 v5, v10, v20
    v_fmac_f32 v6, v11, v20
    v_lshlrev_b32 v10, 16, v67
    v_and_b32 v11, 0xffff0000, v67
    v_fmac_f32 v7, v10, v20
    v_fmac_f32 v8, v11, v20
    v_lshlrev_b32 v10, 16, v68
    v_and_b32 v11, 0xffff0000, v68
    v_fmac_f32 v28, v10, v21
    v_fmac_f32 v29, v11, v21
    v_lshlrev_b32 v10, 16, v69
    v_and_b32 v11, 0xffff0000, v69
    v_fmac_f32 v30, v10, v21
    v_fmac_f32 v31, v11, v21
    v_lshlrev_b32 v10, 16, v70
    v_and_b32 v11, 0xffff0000, v70
    v_fmac_f32 v5, v10, v21
    v_fmac_f32 v6, v11, v21
    v_lshlrev_b32 v10, 16, v71
    v_and_b32 v11, 0xffff0000, v71
    v_fmac_f32 v7, v10, v21
    v_fmac_f32 v8, v11, v21
    v_lshlrev_b32 v10, 16, v72
    v_and_b32 v11, 0xffff0000, v72
    v_fmac_f32 v28, v10, v22
    v_fmac_f32 v29, v11, v22
    v_lshlrev_b32 v10, 16, v73
    v_and_b32 v11, 0xffff0000, v73
    v_fmac_f32 v30, v10, v22
    v_fmac_f32 v31, v11, v22
    v_lshlrev_b32 v10, 16, v74
    v_and_b32 v11, 0xffff0000, v74
    v_fmac_f32 v5, v10, v22
    v_fmac_f32 v6, v11, v22
    v_lshlrev_b32 v10, 16, v75
    v_and_b32 v11, 0xffff0000, v75
    v_fmac_f32 v7, v10, v22
    v_fmac_f32 v8, v11, v22
    v_lshlrev_b32 v10, 16, v76
    v_and_b32 v11, 0xffff0000, v76
    v_fmac_f32 v28, v10, v23
    v_fmac_f32 v29, v11, v23
    v_lshlrev_b32 v10, 16, v77
    v_and_b32 v11, 0xffff0000, v77
    v_fmac_f32 v30, v10, v23
    v_fmac_f32 v31, v11, v23
    v_lshlrev_b32 v10, 16, v78
    v_and_b32 v11, 0xffff0000, v78
    v_fmac_f32 v5, v10, v23
    v_fmac_f32 v6, v11, v23
    v_lshlrev_b32 v10, 16, v79
    v_and_b32 v11, 0xffff0000, v79
    v_fmac_f32 v7, v10, v23
    v_fmac_f32 v8, v11, v23
    v_lshlrev_b32 v10, 16, v80
    v_and_b32 v11, 0xffff0000, v80
    v_fmac_f32 v28, v10, v24
    v_fmac_f32 v29, v11, v24
    v_lshlrev_b32 v10, 16, v81
    v_and_b32 v11, 0xffff0000, v81
    v_fmac_f32 v30, v10, v24
    v_fmac_f32 v31, v11, v24
    v_lshlrev_b32 v10, 16, v82
    v_and_b32 v11, 0xffff0000, v82
    v_fmac_f32 v5, v10, v24
    v_fmac_f32 v6, v11, v24
    v_lshlrev_b32 v10, 16, v83
    v_and_b32 v11, 0xffff0000, v83
    v_fmac_f32 v7, v10, v24
    v_fmac_f32 v8, v11, v24
    v_lshlrev_b32 v10, 16, v84
    v_and_b32 v11, 0xffff0000, v84
    v_fmac_f32 v28, v10, v25
    v_fmac_f32 v29, v11, v25
    v_lshlrev_b32 v10, 16, v85
    v_and_b32 v11, 0xffff0000, v85
    v_fmac_f32 v30, v10, v25
    v_fmac_f32 v31, v11, v25
    v_lshlrev_b32 v10, 16, v86
    v_and_b32 v11, 0xffff0000, v86
    v_fmac_f32 v5, v10, v25
    v_fmac_f32 v6, v11, v25
    v_lshlrev_b32 v10, 16, v87
    v_and_b32 v11, 0xffff0000, v87
    v_fmac_f32 v7, v10, v25
    v_fmac_f32 v8, v11, v25
    v_lshlrev_b32 v10, 16, v88
    v_and_b32 v11, 0xffff0000, v88
    v_fmac_f32 v28, v10, v26
    v_fmac_f32 v29, v11, v26
    v_lshlrev_b32 v10, 16, v89
    v_and_b32 v11, 0xffff0000, v89
    v_fmac_f32 v30, v10, v26
    v_fmac_f32 v31, v11, v26
    v_lshlrev_b32 v10, 16, v90
    v_and_b32 v11, 0xffff0000, v90
    v_fmac_f32 v5, v10, v26
    v_fmac_f32 v6, v11, v26
    v_lshlrev_b32 v10, 16, v91
    v_and_b32 v11, 0xffff0000, v91
    v_fmac_f32 v7, v10, v26
    v_fmac_f32 v8, v11, v26
    v_lshlrev_b32 v10, 16, v92
    v_and_b32 v11, 0xffff0000, v92
    v_fmac_f32 v28, v10, v27
    v_fmac_f32 v29, v11, v27
    v_lshlrev_b32 v10, 16, v93
    v_and_b32 v11, 0xffff0000, v93
    v_fmac_f32 v30, v10, v27
    v_fmac_f32 v31, v11, v27
    v_lshlrev_b32 v10, 16, v94
    v_and_b32 v11, 0xffff0000, v94
    v_fmac_f32 v5, v10, v27
    v_fmac_f32 v6, v11, v27
    v_lshlrev_b32 v10, 16, v95
    v_and_b32 v11, 0xffff0000, v95
    v_fmac_f32 v7, v10, v27
    v_fmac_f32 v8, v11, v27
    v_mov_b32 v32, v28
    v_mov_b32 v33, v29
    v_mov_b32 v34, v30
    v_mov_b32 v35, v31
    v_mov_b32 v36, v5
    v_mov_b32 v37, v6
    v_mov_b32 v38, v7
    v_mov_b32 v39, v8
    v_lshlrev_b32 v9, 8, v2
    v_lshl_add_u32 v9, v1, 5, v9
    ds_write_b128 v9, v[32:35] offset:2048
    ds_write_b128 v9, v[36:39] offset:2064
    s_waitcnt lgkmcnt(0)
    s_barrier
    v_cmp_gt_u32 vcc, 64, v0
    s_nop 0
    s_and_saveexec_b64 s[30:31], vcc
    s_cbranch_execz L_fr_end
    v_lshlrev_b32 v9, 2, v0
    ds_read_b32 v32, v9 offset:2048
    ds_read_b32 v33, v9 offset:2304
    ds_read_b32 v34, v9 offset:2560
    ds_read_b32 v35, v9 offset:2816
    ds_read_b32 v36, v9 offset:3072
    ds_read_b32 v37, v9 offset:3328
    ds_read_b32 v38, v9 offset:3584
    ds_read_b32 v39, v9 offset:3840
    ds_read_b32 v40, v9 offset:4096
    ds_read_b32 v41, v9 offset:4352
    ds_read_b32 v42, v9 offset:4608
    ds_read_b32 v43, v9 offset:4864
    ds_read_b32 v44, v9 offset:5120
    ds_read_b32 v45, v9 offset:5376
    ds_read_b32 v46, v9 offset:5632
    ds_read_b32 v47, v9 offset:5888
    ds_read_b32 v48, v9 offset:6144
    ds_read_b32 v49, v9 offset:6400
    ds_read_b32 v50, v9 offset:6656
    ds_read_b32 v51, v9 offset:6912
    ds_read_b32 v52, v9 offset:7168
    ds_read_b32 v53, v9 offset:7424
    ds_read_b32 v54, v9 offset:7680
    ds_read_b32 v55, v9 offset:7936
    ds_read_b32 v56, v9 offset:8192
    ds_read_b32 v57, v9 offset:8448
    ds_read_b32 v58, v9 offset:8704
    ds_read_b32 v59, v9 offset:8960
    ds_read_b32 v60, v9 offset:9216
    ds_read_b32 v61, v9 offset:9472
    ds_read_b32 v62, v9 offset:9728
    ds_read_b32 v63, v9 offset:9984
    s_waitcnt lgkmcnt(0)
    v_add_f32 v32, v32, v33
    v_add_f32 v32, v32, v34
    v_add_f32 v32, v32, v35
    v_add_f32 v32, v32, v36
    v_add_f32 v32, v32, v37
    v_add_f32 v32, v32, v38
    v_add_f32 v32, v32, v39
    v_add_f32 v32, v32, v40
    v_add_f32 v32, v32, v41
    v_add_f32 v32, v32, v42
    v_add_f32 v32, v32, v43
    v_add_f32 v32, v32, v44
    v_add_f32 v32, v32, v45
    v_add_f32 v32, v32, v46
    v_add_f32 v32, v32, v47
    v_add_f32 v32, v32, v48
    v_add_f32 v32, v32, v49
    v_add_f32 v32, v32, v50
    v_add_f32 v32, v32, v51
    v_add_f32 v32, v32, v52
    v_add_f32 v32, v32, v53
    v_add_f32 v32, v32, v54
    v_add_f32 v32, v32, v55
    v_add_f32 v32, v32, v56
    v_add_f32 v32, v32, v57
    v_add_f32 v32, v32, v58
    v_add_f32 v32, v32, v59
    v_add_f32 v32, v32, v60
    v_add_f32 v32, v32, v61
    v_add_f32 v32, v32, v62
    v_add_f32 v32, v32, v63
    s_lshl_b32 s21, s2, 8
    v_add_u32 v9, s21, v9
    buffer_store_dword v32, v9, s[24:27], 0 offen
    s_branch L_fr_end
L_fr_rel:
    s_sub_u32 s21, s2, 48
    s_lshl_b32 s21, s21, 5
    v_and_b32 v1, 31, v0
    v_lshrrev_b32 v2, 5, v0
    v_add_u32 v3, s21, v1
    v_lshlrev_b32 v4, 10, v3
    v_lshl_add_u32 v4, v2, 7, v4
    v_lshlrev_b32 v5, 4, v3
    v_lshl_add_u32 v5, v2, 18, v5
    s_waitcnt lgkmcnt(0)
    s_mov_b32 s44, s36
    s_mov_b32 s45, s37
    s_and_b32 s45, s45, 0xffff
    s_mov_b32 s46, 2097152
    s_mov_b32 s47, 0x00020000
    s_add_u32 s48, s8, 119537664
    s_addc_u32 s49, s9, 0
    s_and_b32 s49, s49, 0xffff
    s_mov_b32 s50, 2097152
    s_mov_b32 s51, 0x00020000
    buffer_load_dwordx4 v[32:35], v4, s[44:47], 0 offen offset:0
    buffer_load_dwordx4 v[36:39], v4, s[44:47], 0 offen offset:16
    buffer_load_dwordx4 v[40:43], v4, s[44:47], 0 offen offset:32
    buffer_load_dwordx4 v[44:47], v4, s[44:47], 0 offen offset:48
    buffer_load_dwordx4 v[48:51], v4, s[44:47], 0 offen offset:64
    buffer_load_dwordx4 v[52:55], v4, s[44:47], 0 offen offset:80
    buffer_load_dwordx4 v[56:59], v4, s[44:47], 0 offen offset:96
    buffer_load_dwordx4 v[60:63], v4, s[44:47], 0 offen offset:112
    s_waitcnt vmcnt(0)
    s_mov_b32 s22, 0
    buffer_store_dwordx4 v[32:35], v5, s[48:51], s22 offen
    s_mov_b32 s22, 32768
    buffer_store_dwordx4 v[36:39], v5, s[48:51], s22 offen
    s_mov_b32 s22, 65536
    buffer_store_dwordx4 v[40:43], v5, s[48:51], s22 offen
    s_mov_b32 s22, 98304
    buffer_store_dwordx4 v[44:47], v5, s[48:51], s22 offen
    s_mov_b32 s22, 131072
    buffer_store_dwordx4 v[48:51], v5, s[48:51], s22 offen
    s_mov_b32 s22, 163840
    buffer_store_dwordx4 v[52:55], v5, s[48:51], s22 offen
    s_mov_b32 s22, 196608
    buffer_store_dwordx4 v[56:59], v5, s[48:51], s22 offen
    s_mov_b32 s22, 229376
    buffer_store_dwordx4 v[60:63], v5, s[48:51], s22 offen
    s_branch L_fr_end
L_fr_pf:
    s_sub_u32 s21, s2, 112
    s_load_dwordx2 s[6:7], s[0:1], 24
    v_lshlrev_b32 v3, 4, v0
    s_lshl_b32 s21, s21, 16
    v_add_u32 v3, s21, v3
    s_waitcnt lgkmcnt(0)
    s_mov_b32 s12, s6
    s_mov_b32 s13, s7
    s_and_b32 s13, s13, 0xffff
    s_mov_b32 s14, 4194304
    s_mov_b32 s15, 0x00020000
    s_mov_b32 s22, 0
    buffer_load_dwordx4 v[32:35], v3, s[12:15], s22 offen
    s_mov_b32 s22, 4096
    buffer_load_dwordx4 v[36:39], v3, s[12:15], s22 offen
    s_mov_b32 s22, 8192
    buffer_load_dwordx4 v[40:43], v3, s[12:15], s22 offen
    s_mov_b32 s22, 12288
    buffer_load_dwordx4 v[44:47], v3, s[12:15], s22 offen
    s_mov_b32 s22, 16384
    buffer_load_dwordx4 v[48:51], v3, s[12:15], s22 offen
    s_mov_b32 s22, 20480
    buffer_load_dwordx4 v[52:55], v3, s[12:15], s22 offen
    s_mov_b32 s22, 24576
    buffer_load_dwordx4 v[56:59], v3, s[12:15], s22 offen
    s_mov_b32 s22, 28672
    buffer_load_dwordx4 v[60:63], v3, s[12:15], s22 offen
    s_mov_b32 s22, 32768
    buffer_load_dwordx4 v[64:67], v3, s[12:15], s22 offen
    s_mov_b32 s22, 36864
    buffer_load_dwordx4 v[68:71], v3, s[12:15], s22 offen
    s_mov_b32 s22, 40960
    buffer_load_dwordx4 v[72:75], v3, s[12:15], s22 offen
    s_mov_b32 s22, 45056
    buffer_load_dwordx4 v[76:79], v3, s[12:15], s22 offen
    s_mov_b32 s22, 49152
    buffer_load_dwordx4 v[80:83], v3, s[12:15], s22 offen
    s_mov_b32 s22, 53248
    buffer_load_dwordx4 v[84:87], v3, s[12:15], s22 offen
    s_mov_b32 s22, 57344
    buffer_load_dwordx4 v[88:91], v3, s[12:15], s22 offen
    s_mov_b32 s22, 61440
    buffer_load_dwordx4 v[92:95], v3, s[12:15], s22 offen
    s_waitcnt vmcnt(0)
L_fr_end:
    s_endpgm
.globl qkv_kernel
.p2align 8
.type qkv_kernel,@function
qkv_kernel:
    s_cmp_ge_u32 s2, 256
    s_cbranch_scc1 L_qkv_end
    s_load_dwordx2 s[16:17], s[0:1], 0
    s_load_dwordx2 s[18:19], s[0:1], 16
    s_load_dwordx2 s[20:21], s[0:1], 24
    s_load_dwordx2 s[22:23], s[0:1], 32
    s_load_dwordx2 s[24:25], s[0:1], 112
    s_load_dwordx2 s[26:27], s[0:1], 104
    v_and_b32 v1, 63, v0
    v_lshrrev_b32 v2, 6, v0
    s_nop 0
    v_readfirstlane_b32 s38, v2
    s_and_b32 s30, s2, 7
    s_lshr_b32 s31, s2, 3
    s_and_b32 s32, s30, 0
    s_lshl_b32 s32, s32, 3
    s_lshr_b32 s33, s31, 2
    s_add_u32 s59, s32, s33
    s_lshr_b32 s32, s30, 0
    s_lshl_b32 s32, s32, 2
    s_and_b32 s33, s31, 3
    s_add_u32 s58, s32, s33
    s_lshl_b32 s39, s59, 8
    s_lshl_b32 s32, s38, 6
    s_add_u32 s39, s39, s32
    s_mov_b32 s61, 1040356334
    s_lshl_b32 s33, s58, 3
    s_lshl_b32 s34, s59, 8
    s_add_u32 s33, s33, s34
    s_lshl_b32 s34, s38, 1
    s_add_u32 s33, s33, s34
    s_lshl_b32 s34, s33, 10
    v_lshlrev_b32 v25, 4, v1
    v_add_u32 v25, s34, v25
    v_lshlrev_b32 v26, 5, v1
    v_lshlrev_b32 v24, 15, v1
    s_lshl_b32 s34, s33, 4
    v_add_u32 v24, s34, v24
    s_mov_b32 s37, 8192
    s_lshl_b32 s36, s58, 8
    v_lshrrev_b32 v2, 4, v1
    v_and_b32 v3, 15, v1
    v_lshrrev_b32 v4, 2, v3
    v_and_b32 v5, 3, v3
    v_lshrrev_b32 v6, 1, v2
    v_lshl_add_u32 v6, v6, 3, v4
    v_lshlrev_b32 v6, 7, v6
    v_and_b32 v7, 1, v2
    v_lshlrev_b32 v7, 1, v7
    v_lshrrev_b32 v2, 1, v5
    v_add_u32 v7, v7, v2
    v_lshrrev_b32 v2, 1, v4
    v_lshl_add_u32 v7, v2, 2, v7
    v_lshl_add_u32 v6, v7, 4, v6
    v_and_b32 v2, 1, v5
    v_lshl_add_u32 v12, v2, 3, v6
    v_xor_b32 v13, 64, v12
    v_mov_b32 v8, v12
    v_mov_b32 v9, v13
    v_add_u32 v10, 32768, v12
    v_add_u32 v11, 32768, v13
    s_mov_b32 s43, 32768
    v_lshrrev_b32 v2, 3, v1
    v_bfe_u32 v4, v1, 4, 1
    v_lshlrev_b32 v4, 2, v4
    v_and_b32 v3, 7, v1
    v_xor_b32 v3, v3, v4
    s_lshl_b32 s30, s38, 6
    v_add_u32 v2, s30, v2
    v_mul_lo_u32 v2, v2, s37
    v_lshl_add_u32 v2, v3, 4, v2
    v_add_u32 v14, s36, v2
    s_mul_i32 s44, s37, 0
    s_mul_i32 s45, s37, 8
    s_mul_i32 s46, s37, 16
    s_mul_i32 s47, s37, 24
    s_mul_i32 s48, s37, 32
    s_mul_i32 s49, s37, 40
    s_mul_i32 s50, s37, 48
    s_mul_i32 s51, s37, 56
    s_lshl_b32 s42, s38, 13
    s_mov_b32 s41, 0
    s_mov_b32 s40, s42
    v_and_b32 v2, 31, v1
    v_add_u32 v2, s39, v2
    v_lshlrev_b32 v2, 4, v2
    v_lshrrev_b32 v3, 5, v1
    v_lshl_add_u32 v19, v3, 15, v2
    s_lshl_b32 s60, s58, 19
    s_add_u32 s62, s60, 0x40000
    v_and_b32 v4, 31, v1
    v_lshrrev_b32 v5, 5, v1
    v_add_u32 v6, s39, v4
    v_lshlrev_b32 v6, 4, v6
    v_lshl_add_u32 v6, v5, 16, v6
    v_mov_b32 v15, v6
    v_add_u32 v16, 0x8000, v6
    v_add_u32 v17, 0x20000, v6
    v_add_u32 v18, 0x28000, v6
    s_lshl_b32 s63, s39, 8
    v_lshlrev_b32 v7, 4, v4
    v_lshl_add_u32 v7, v5, 11, v7
    v_add_u32 v20, s63, v7
    v_add_u32 v21, 4096, v20
    v_add_u32 v22, 8192, v20
    v_add_u32 v23, 12288, v20
    v_mov_b32 v27, v20
    v_add_u32 v28, 4096, v20
    s_add_u32 s63, s60, 8192
    s_waitcnt lgkmcnt(0)
    s_mov_b32 s8, s20
    s_mov_b32 s9, s21
    s_and_b32 s9, s9, 0xffff
    s_mov_b32 s10, 4194304
    s_mov_b32 s11, 0x00020000
    s_add_u32 m0, s40, 0
    s_nop 0
    buffer_load_dwordx4 v14, s[8:11], s44 offen lds
    s_add_u32 m0, s40, 1024
    s_nop 0
    buffer_load_dwordx4 v14, s[8:11], s45 offen lds
    s_add_u32 m0, s40, 2048
    s_nop 0
    buffer_load_dwordx4 v14, s[8:11], s46 offen lds
    s_add_u32 m0, s40, 3072
    s_nop 0
    buffer_load_dwordx4 v14, s[8:11], s47 offen lds
    s_add_u32 m0, s40, 4096
    s_nop 0
    buffer_load_dwordx4 v14, s[8:11], s48 offen lds
    s_add_u32 m0, s40, 5120
    s_nop 0
    buffer_load_dwordx4 v14, s[8:11], s49 offen lds
    s_add_u32 m0, s40, 6144
    s_nop 0
    buffer_load_dwordx4 v14, s[8:11], s50 offen lds
    s_add_u32 m0, s40, 7168
    s_nop 0
    buffer_load_dwordx4 v14, s[8:11], s51 offen lds
    v_add_u32 v14, 2097152, v14
    s_add_u32 s41, s41, 32768
    s_and_b32 s41, s41, 0x1ffff
    s_add_u32 s40, s41, s42
    s_add_u32 s4, s24, 119537664
    s_addc_u32 s5, s25, 0
    s_and_b32 s5, s5, 0xffff
    s_mov_b32 s6, 2097152
    s_mov_b32 s7, 0x00020000
    s_mov_b32 s30, 0
    buffer_load_dwordx4 a[0:3], v19, s[4:7], s30 offen offset:0
    buffer_load_dwordx4 a[128:131], v19, s[4:7], s30 offen offset:512
    s_mov_b32 s30, 65536
    buffer_load_dwordx4 a[4:7], v19, s[4:7], s30 offen offset:0
    buffer_load_dwordx4 a[132:135], v19, s[4:7], s30 offen offset:512
    s_mov_b32 s30, 131072
    buffer_load_dwordx4 a[8:11], v19, s[4:7], s30 offen offset:0
    buffer_load_dwordx4 a[136:139], v19, s[4:7], s30 offen offset:512
    s_mov_b32 s30, 196608
    buffer_load_dwordx4 a[12:15], v19, s[4:7], s30 offen offset:0
    buffer_load_dwordx4 a[140:143], v19, s[4:7], s30 offen offset:512
    s_mov_b32 s30, 262144
    buffer_load_dwordx4 a[16:19], v19, s[4:7], s30 offen offset:0
    buffer_load_dwordx4 a[144:147], v19, s[4:7], s30 offen offset:512
    s_mov_b32 s30, 327680
    buffer_load_dwordx4 a[20:23], v19, s[4:7], s30 offen offset:0
    buffer_load_dwordx4 a[148:151], v19, s[4:7], s30 offen offset:512
    s_mov_b32 s30, 393216
    buffer_load_dwordx4 a[24:27], v19, s[4:7], s30 offen offset:0
    buffer_load_dwordx4 a[152:155], v19, s[4:7], s30 offen offset:512
    s_mov_b32 s30, 458752
    buffer_load_dwordx4 a[28:31], v19, s[4:7], s30 offen offset:0
    buffer_load_dwordx4 a[156:159], v19, s[4:7], s30 offen offset:512
    s_mov_b32 s84, s16
    s_mov_b32 s85, s17
    s_and_b32 s85, s85, 0xffff
    s_mov_b32 s86, 2097152
    s_mov_b32 s87, 0x00020000
    s_mov_b32 s88, s24
    s_mov_b32 s89, s25
    s_and_b32 s89, s89, 0xffff
    s_mov_b32 s90, 12288
    s_mov_b32 s91, 0x00020000
    buffer_load_dwordx4 v[64:67], v25, s[84:87], 0 offen
    buffer_load_dwordx4 v[68:71], v25, s[84:87], 0 offen offset:1024
    buffer_load_dwordx4 v[96:99], v26, s[88:91], 0 offen
    buffer_load_dwordx4 v[100:103], v26, s[88:91], 0 offen offset:16
    buffer_load_dwordx4 v[104:107], v26, s[88:91], 0 offen offset:2048
    buffer_load_dwordx4 v[108:111], v26, s[88:91], 0 offen offset:2064
    s_mov_b32 s64, s22
    s_mov_b32 s65, s23
    s_and_b32 s65, s65, 0xffff
    s_mov_b32 s66, 4194304
    s_mov_b32 s67, 0x00020000
    s_mov_b32 s68, s18
    s_mov_b32 s69, s19
    s_and_b32 s69, s69, 0xffff
    s_mov_b32 s70, 4194304
    s_mov_b32 s71, 0x00020000
    s_add_u32 s12, s24, 20971520
    s_addc_u32 s13, s25, 0
    s_and_b32 s13, s13, 0xffff
    s_mov_b32 s14, 16777216
    s_mov_b32 s15, 0x00020000
    s_add_u32 s72, s24, 37748736
    s_addc_u32 s73, s25, 0
    s_and_b32 s73, s73, 0xffff
    s_mov_b32 s74, 16777216
    s_mov_b32 s75, 0x00020000
    s_add_u32 s76, s24, 4194304
    s_addc_u32 s77, s25, 0
    s_and_b32 s77, s77, 0xffff
    s_mov_b32 s78, 16777216
    s_mov_b32 s79, 0x00020000
    s_add_u32 s80, s24, 1048576
    s_addc_u32 s81, s25, 0
    s_and_b32 s81, s81, 0xffff
    s_mov_b32 s82, 2097152
    s_mov_b32 s83, 0x00020000
    s_mov_b32 s52, s26
    s_mov_b32 s53, s27
    s_and_b32 s53, s53, 0xffff
    s_mov_b32 s54, 256
    s_mov_b32 s55, 0x00020000
    s_waitcnt vmcnt(0)
    v_lshlrev_b32 v72, 16, v64
    v_and_b32 v73, 0xffff0000, v64
    v_lshlrev_b32 v74, 16, v65
    v_and_b32 v75, 0xffff0000, v65
    v_lshlrev_b32 v76, 16, v66
    v_and_b32 v77, 0xffff0000, v66
    v_lshlrev_b32 v78, 16, v67
    v_and_b32 v79, 0xffff0000, v67
    v_mov_b32 v112, v104
    v_mov_b32 v113, v105
    v_mov_b32 v114, v106
    v_mov_b32 v115, v107
    v_mov_b32 v116, v108
    v_mov_b32 v117, v109
    v_mov_b32 v118, v110
    v_mov_b32 v119, v111
    v_add_f32 v25, v72, v73
    v_add_f32 v25, v25, v74
    v_add_f32 v25, v25, v75
    v_add_f32 v25, v25, v76
    v_add_f32 v25, v25, v77
    v_add_f32 v25, v25, v78
    v_add_f32 v25, v25, v79
    s_nop 1
    v_add_f32_dpp v25, v25, v25 quad_perm:[1,0,3,2] row_mask:0xf bank_mask:0xf
    s_nop 1
    v_add_f32_dpp v25, v25, v25 quad_perm:[2,3,0,1] row_mask:0xf bank_mask:0xf
    s_nop 1
    v_add_f32_dpp v25, v25, v25 row_half_mirror row_mask:0xf bank_mask:0xf
    s_nop 1
    v_add_f32_dpp v25, v25, v25 row_mirror row_mask:0xf bank_mask:0xf
    v_mov_b32 v26, v25
    s_nop 1
    v_permlane16_swap_b32 v25, v26
    v_add_f32 v25, v25, v26
    v_mov_b32 v26, v25
    s_nop 1
    v_permlane32_swap_b32 v25, v26
    v_add_f32 v25, v25, v26
    v_mul_f32 v25, 0.001953125, v25
    v_sub_f32 v72, v72, v25
    v_sub_f32 v73, v73, v25
    v_sub_f32 v74, v74, v25
    v_sub_f32 v75, v75, v25
    v_sub_f32 v76, v76, v25
    v_sub_f32 v77, v77, v25
    v_sub_f32 v78, v78, v25
    v_sub_f32 v79, v79, v25
    v_mul_f32 v25, v72, v72
    v_fmac_f32 v25, v73, v73
    v_fmac_f32 v25, v74, v74
    v_fmac_f32 v25, v75, v75
    v_fmac_f32 v25, v76, v76
    v_fmac_f32 v25, v77, v77
    v_fmac_f32 v25, v78, v78
    v_fmac_f32 v25, v79, v79
    s_nop 1
    v_add_f32_dpp v25, v25, v25 quad_perm:[1,0,3,2] row_mask:0xf bank_mask:0xf
    s_nop 1
    v_add_f32_dpp v25, v25, v25 quad_perm:[2,3,0,1] row_mask:0xf bank_mask:0xf
    s_nop 1
    v_add_f32_dpp v25, v25, v25 row_half_mirror row_mask:0xf bank_mask:0xf
    s_nop 1
    v_add_f32_dpp v25, v25, v25 row_mirror row_mask:0xf bank_mask:0xf
    v_mov_b32 v26, v25
    s_nop 1
    v_permlane16_swap_b32 v25, v26
    v_add_f32 v25, v25, v26
    v_mov_b32 v26, v25
    s_nop 1
    v_permlane32_swap_b32 v25, v26
    v_add_f32 v25, v25, v26
    v_mov_b32 v26, 925353388
    v_fmac_f32 v26, 0.001953125, v25
    v_rsq_f32 v25, v26
    v_add_f32 v112, 1.0, v112
    v_mul_f32 v72, v72, v25
    v_fma_f32 v72, v72, v112, v96
    v_add_f32 v113, 1.0, v113
    v_mul_f32 v73, v73, v25
    v_fma_f32 v73, v73, v113, v97
    v_add_f32 v114, 1.0, v114
    v_mul_f32 v74, v74, v25
    v_fma_f32 v74, v74, v114, v98
    v_add_f32 v115, 1.0, v115
    v_mul_f32 v75, v75, v25
    v_fma_f32 v75, v75, v115, v99
    v_add_f32 v116, 1.0, v116
    v_mul_f32 v76, v76, v25
    v_fma_f32 v76, v76, v116, v100
    v_add_f32 v117, 1.0, v117
    v_mul_f32 v77, v77, v25
    v_fma_f32 v77, v77, v117, v101
    v_add_f32 v118, 1.0, v118
    v_mul_f32 v78, v78, v25
    v_fma_f32 v78, v78, v118, v102
    v_add_f32 v119, 1.0, v119
    v_mul_f32 v79, v79, v25
    v_fma_f32 v79, v79, v119, v103
    v_cvt_pk_bf16_f32 v120, v72, v73
    v_cvt_pk_bf16_f32 v121, v74, v75
    v_cvt_pk_bf16_f32 v122, v76, v77
    v_cvt_pk_bf16_f32 v123, v78, v79
    buffer_store_dwordx4 v[120:123], v24, s[80:83], 0 offen offset:0 sc1
    v_lshlrev_b32 v80, 16, v68
    v_and_b32 v81, 0xffff0000, v68
    v_lshlrev_b32 v82, 16, v69
    v_and_b32 v83, 0xffff0000, v69
    v_lshlrev_b32 v84, 16, v70
    v_and_b32 v85, 0xffff0000, v70
    v_lshlrev_b32 v86, 16, v71
    v_and_b32 v87, 0xffff0000, v71
    v_mov_b32 v112, v104
    v_mov_b32 v113, v105
    v_mov_b32 v114, v106
    v_mov_b32 v115, v107
    v_mov_b32 v116, v108
    v_mov_b32 v117, v109
    v_mov_b32 v118, v110
    v_mov_b32 v119, v111
    v_add_f32 v25, v80, v81
    v_add_f32 v25, v25, v82
    v_add_f32 v25, v25, v83
    v_add_f32 v25, v25, v84
    v_add_f32 v25, v25, v85
    v_add_f32 v25, v25, v86
    v_add_f32 v25, v25, v87
    s_nop 1
    v_add_f32_dpp v25, v25, v25 quad_perm:[1,0,3,2] row_mask:0xf bank_mask:0xf
    s_nop 1
    v_add_f32_dpp v25, v25, v25 quad_perm:[2,3,0,1] row_mask:0xf bank_mask:0xf
    s_nop 1
    v_add_f32_dpp v25, v25, v25 row_half_mirror row_mask:0xf bank_mask:0xf
    s_nop 1
    v_add_f32_dpp v25, v25, v25 row_mirror row_mask:0xf bank_mask:0xf
    v_mov_b32 v26, v25
    s_nop 1
    v_permlane16_swap_b32 v25, v26
    v_add_f32 v25, v25, v26
    v_mov_b32 v26, v25
    s_nop 1
    v_permlane32_swap_b32 v25, v26
    v_add_f32 v25, v25, v26
    v_mul_f32 v25, 0.001953125, v25
    v_sub_f32 v80, v80, v25
    v_sub_f32 v81, v81, v25
    v_sub_f32 v82, v82, v25
    v_sub_f32 v83, v83, v25
    v_sub_f32 v84, v84, v25
    v_sub_f32 v85, v85, v25
    v_sub_f32 v86, v86, v25
    v_sub_f32 v87, v87, v25
    v_mul_f32 v25, v80, v80
    v_fmac_f32 v25, v81, v81
    v_fmac_f32 v25, v82, v82
    v_fmac_f32 v25, v83, v83
    v_fmac_f32 v25, v84, v84
    v_fmac_f32 v25, v85, v85
    v_fmac_f32 v25, v86, v86
    v_fmac_f32 v25, v87, v87
    s_nop 1
    v_add_f32_dpp v25, v25, v25 quad_perm:[1,0,3,2] row_mask:0xf bank_mask:0xf
    s_nop 1
    v_add_f32_dpp v25, v25, v25 quad_perm:[2,3,0,1] row_mask:0xf bank_mask:0xf
    s_nop 1
    v_add_f32_dpp v25, v25, v25 row_half_mirror row_mask:0xf bank_mask:0xf
    s_nop 1
    v_add_f32_dpp v25, v25, v25 row_mirror row_mask:0xf bank_mask:0xf
    v_mov_b32 v26, v25
    s_nop 1
    v_permlane16_swap_b32 v25, v26
    v_add_f32 v25, v25, v26
    v_mov_b32 v26, v25
    s_nop 1
    v_permlane32_swap_b32 v25, v26
    v_add_f32 v25, v25, v26
    v_mov_b32 v26, 925353388
    v_fmac_f32 v26, 0.001953125, v25
    v_rsq_f32 v25, v26
    v_add_f32 v112, 1.0, v112
    v_mul_f32 v80, v80, v25
    v_fma_f32 v80, v80, v112, v96
    v_add_f32 v113, 1.0, v113
    v_mul_f32 v81, v81, v25
    v_fma_f32 v81, v81, v113, v97
    v_add_f32 v114, 1.0, v114
    v_mul_f32 v82, v82, v25
    v_fma_f32 v82, v82, v114, v98
    v_add_f32 v115, 1.0, v115
    v_mul_f32 v83, v83, v25
    v_fma_f32 v83, v83, v115, v99
    v_add_f32 v116, 1.0, v116
    v_mul_f32 v84, v84, v25
    v_fma_f32 v84, v84, v116, v100
    v_add_f32 v117, 1.0, v117
    v_mul_f32 v85, v85, v25
    v_fma_f32 v85, v85, v117, v101
    v_add_f32 v118, 1.0, v118
    v_mul_f32 v86, v86, v25
    v_fma_f32 v86, v86, v118, v102
    v_add_f32 v119, 1.0, v119
    v_mul_f32 v87, v87, v25
    v_fma_f32 v87, v87, v119, v103
    v_cvt_pk_bf16_f32 v124, v80, v81
    v_cvt_pk_bf16_f32 v125, v82, v83
    v_cvt_pk_bf16_f32 v126, v84, v85
    v_cvt_pk_bf16_f32 v127, v86, v87
    buffer_store_dwordx4 v[124:127], v24, s[80:83], 0 offen offset:16 sc1
    s_waitcnt vmcnt(24)
    s_barrier
    ds_read_b64_tr_b16 v[32:33], v8 offset:0
    ds_read_b64_tr_b16 v[34:35], v8 offset:512
    ds_read_b64_tr_b16 v[36:37], v9 offset:0
    ds_read_b64_tr_b16 v[38:39], v9 offset:512
    ds_read_b64_tr_b16 v[40:41], v8 offset:2048
    ds_read_b64_tr_b16 v[42:43], v8 offset:2560
    s_waitcnt lgkmcnt(4)
    ds_read_b64_tr_b16 v[44:45], v9 offset:2048
    ds_read_b64_tr_b16 v[46:47], v9 offset:2560
    s_mov_b32 s30, 524288
    buffer_load_dwordx4 a[32:35], v19, s[4:7], s30 offen offset:0
    buffer_load_dwordx4 a[160:163], v19, s[4:7], s30 offen offset:512
    s_waitcnt vmcnt(24)
    v_mfma_f32_32x32x16_bf16 v[64:79], v[32:35], a[0:3], 0
    s_add_u32 m0, s40, 0
    s_nop 0
    buffer_load_dwordx4 v14, s[8:11], s44 offen lds
    v_mfma_f32_32x32x16_bf16 v[80:95], v[32:35], a[128:131], 0
    s_waitcnt lgkmcnt(4)
    ds_read_b64_tr_b16 v[32:33], v8 offset:4096
    ds_read_b64_tr_b16 v[34:35], v8 offset:4608
    s_add_u32 m0, s40, 1024
    s_nop 0
    buffer_load_dwordx4 v14, s[8:11], s45 offen lds
    v_mfma_f32_32x32x16_bf16 v[96:111], v[36:39], a[0:3], 0
    v_mfma_f32_32x32x16_bf16 v[112:127], v[36:39], a[128:131], 0
    s_waitcnt lgkmcnt(4)
    ds_read_b64_tr_b16 v[36:37], v9 offset:4096
    ds_read_b64_tr_b16 v[38:39], v9 offset:4608
    s_mov_b32 s30, 589824
    buffer_load_dwordx4 a[36:39], v19, s[4:7], s30 offen offset:0
    buffer_load_dwordx4 a[164:167], v19, s[4:7], s30 offen offset:512
    s_waitcnt vmcnt(26)
    s_add_u32 m0, s40, 2048
    s_nop 0
    buffer_load_dwordx4 v14, s[8:11], s46 offen lds
    v_mfma_f32_32x32x16_bf16 v[64:79], v[40:43], a[4:7], v[64:79]
    s_add_u32 m0, s40, 3072
    s_nop 0
    buffer_load_dwordx4 v14, s[8:11], s47 offen lds
    v_mfma_f32_32x32x16_bf16 v[80:95], v[40:43], a[132:135], v[80:95]
    s_waitcnt lgkmcnt(4)
    ds_read_b64_tr_b16 v[40:41], v8 offset:6144
    ds_read_b64_tr_b16 v[42:43], v8 offset:6656
    v_mfma_f32_32x32x16_bf16 v[96:111], v[44:47], a[4:7], v[96:111]
    s_add_u32 m0, s40, 4096
    s_nop 0
    buffer_load_dwordx4 v14, s[8:11], s48 offen lds
    v_mfma_f32_32x32x16_bf16 v[112:127], v[44:47], a[132:135], v[112:127]
    s_waitcnt lgkmcnt(4)
    ds_read_b64_tr_b16 v[44:45], v9 offset:6144
    ds_read_b64_tr_b16 v[46:47], v9 offset:6656
    s_mov_b32 s30, 655360
    buffer_load_dwordx4 a[40:43], v19, s[4:7], s30 offen offset:0
    buffer_load_dwordx4 a[168:171], v19, s[4:7], s30 offen offset:512
    s_waitcnt vmcnt(29)
    v_mfma_f32_32x32x16_bf16 v[64:79], v[32:35], a[8:11], v[64:79]
    s_add_u32 m0, s40, 5120
    s_nop 0
    buffer_load_dwordx4 v14, s[8:11], s49 offen lds
    v_mfma_f32_32x32x16_bf16 v[80:95], v[32:35], a[136:139], v[80:95]
    s_waitcnt lgkmcnt(4)
    ds_read_b64_tr_b16 v[32:33], v8 offset:8192
    ds_read_b64_tr_b16 v[34:35], v8 offset:8704
    s_add_u32 m0, s40, 6144
    s_nop 0
    buffer_load_dwordx4 v14, s[8:11], s50 offen lds
    v_mfma_f32_32x32x16_bf16 v[96:111], v[36:39], a[8:11], v[96:111]
    v_mfma_f32_32x32x16_bf16 v[112:127], v[36:39], a[136:139], v[112:127]
    s_waitcnt lgkmcnt(4)
    ds_read_b64_tr_b16 v[36:37], v9 offset:8192
    ds_read_b64_tr_b16 v[38:39], v9 offset:8704
    s_mov_b32 s30, 720896
    buffer_load_dwordx4 a[44:47], v19, s[4:7], s30 offen offset:0
    buffer_load_dwordx4 a[172:175], v19, s[4:7], s30 offen offset:512
    s_waitcnt vmcnt(31)
    s_add_u32 m0, s40, 7168
    s_nop 0
    buffer_load_dwordx4 v14, s[8:11], s51 offen lds
    v_mfma_f32_32x32x16_bf16 v[64:79], v[40:43], a[12:15], v[64:79]
    v_add_u32 v14, 4292870272, v14
    s_add_u32 s41, s41, 32768
    s_and_b32 s41, s41, 0x1ffff
    s_add_u32 s40, s41, s42
    v_mfma_f32_32x32x16_bf16 v[80:95], v[40:43], a[140:143], v[80:95]
    s_waitcnt lgkmcnt(4)
    ds_read_b64_tr_b16 v[40:41], v8 offset:10240
    ds_read_b64_tr_b16 v[42:43], v8 offset:10752
    v_mfma_f32_32x32x16_bf16 v[96:111], v[44:47], a[12:15], v[96:111]
    s_add_u32 m0, s40, 0
    s_nop 0
    buffer_load_dwordx4 v14, s[8:11], s44 offen lds
    v_mfma_f32_32x32x16_bf16 v[112:127], v[44:47], a[140:143], v[112:127]
    s_waitcnt lgkmcnt(4)
    ds_read_b64_tr_b16 v[44:45], v9 offset:10240
    ds_read_b64_tr_b16 v[46:47], v9 offset:10752
    s_mov_b32 s30, 786432
    buffer_load_dwordx4 a[48:51], v19, s[4:7], s30 offen offset:0
    buffer_load_dwordx4 a[176:179], v19, s[4:7], s30 offen offset:512
    s_waitcnt vmcnt(33)
    v_mfma_f32_32x32x16_bf16 v[64:79], v[32:35], a[16:19], v[64:79]
    s_add_u32 m0, s40, 1024
    s_nop 0
    buffer_load_dwordx4 v14, s[8:11], s45 offen lds
    v_mfma_f32_32x32x16_bf16 v[80:95], v[32:35], a[144:147], v[80:95]
    s_waitcnt lgkmcnt(4)
    ds_read_b64_tr_b16 v[32:33], v8 offset:12288
    ds_read_b64_tr_b16 v[34:35], v8 offset:12800
    s_add_u32 m0, s40, 2048
    s_nop 0
    buffer_load_dwordx4 v14, s[8:11], s46 offen lds
    v_mfma_f32_32x32x16_bf16 v[96:111], v[36:39], a[16:19], v[96:111]
    v_mfma_f32_32x32x16_bf16 v[112:127], v[36:39], a[144:147], v[112:127]
    s_waitcnt lgkmcnt(4)
    ds_read_b64_tr_b16 v[36:37], v9 offset:12288
    ds_read_b64_tr_b16 v[38:39], v9 offset:12800
    s_mov_b32 s30, 851968
    buffer_load_dwordx4 a[52:55], v19, s[4:7], s30 offen offset:0
    buffer_load_dwordx4 a[180:183], v19, s[4:7], s30 offen offset:512
    s_waitcnt vmcnt(35)
    s_add_u32 m0, s40, 3072
    s_nop 0
    buffer_load_dwordx4 v14, s[8:11], s47 offen lds
    v_mfma_f32_32x32x16_bf16 v[64:79], v[40:43], a[20:23], v[64:79]
    s_add_u32 m0, s40, 4096
    s_nop 0
    buffer_load_dwordx4 v14, s[8:11], s48 offen lds
    v_mfma_f32_32x32x16_bf16 v[80:95], v[40:43], a[148:151], v[80:95]
    s_waitcnt lgkmcnt(4)
    ds_read_b64_tr_b16 v[40:41], v8 offset:14336
    ds_read_b64_tr_b16 v[42:43], v8 offset:14848
    v_mfma_f32_32x32x16_bf16 v[96:111], v[44:47], a[20:23], v[96:111]
    s_add_u32 m0, s40, 5120
    s_nop 0
    buffer_load_dwordx4 v14, s[8:11], s49 offen lds
    v_mfma_f32_32x32x16_bf16 v[112:127], v[44:47], a[148:151], v[112:127]
    s_waitcnt lgkmcnt(4)
    ds_read_b64_tr_b16 v[44:45], v9 offset:14336
    ds_read_b64_tr_b16 v[46:47], v9 offset:14848
    s_mov_b32 s30, 917504
    buffer_load_dwordx4 a[56:59], v19, s[4:7], s30 offen offset:0
    buffer_load_dwordx4 a[184:187], v19, s[4:7], s30 offen offset:512
    s_waitcnt vmcnt(38)
    v_mfma_f32_32x32x16_bf16 v[64:79], v[32:35], a[24:27], v[64:79]
    s_add_u32 m0, s40, 6144
    s_nop 0
    buffer_load_dwordx4 v14, s[8:11], s50 offen lds
    v_mfma_f32_32x32x16_bf16 v[80:95], v[32:35], a[152:155], v[80:95]
    s_waitcnt lgkmcnt(4)
    ds_read_b64_tr_b16 v[32:33], v8 offset:16384
    ds_read_b64_tr_b16 v[34:35], v8 offset:16896
    s_add_u32 m0, s40, 7168
    s_nop 0
    buffer_load_dwordx4 v14, s[8:11], s51 offen lds
    v_mfma_f32_32x32x16_bf16 v[96:111], v[36:39], a[24:27], v[96:111]
    v_mfma_f32_32x32x16_bf16 v[112:127], v[36:39], a[152:155], v[112:127]
    s_waitcnt lgkmcnt(4)
    ds_read_b64_tr_b16 v[36:37], v9 offset:16384
    ds_read_b64_tr_b16 v[38:39], v9 offset:16896
    s_mov_b32 s30, 983040
    buffer_load_dwordx4 a[60:63], v19, s[4:7], s30 offen offset:0
    buffer_load_dwordx4 a[188:191], v19, s[4:7], s30 offen offset:512
    s_waitcnt vmcnt(40)
    v_add_u32 v14, 2097152, v14
    s_add_u32 s41, s41, 32768
    s_and_b32 s41, s41, 0x1ffff
    s_add_u32 s40, s41, s42
    v_mfma_f32_32x32x16_bf16 v[64:79], v[40:43], a[28:31], v[64:79]
    v_mfma_f32_32x32x16_bf16 v[80:95], v[40:43], a[156:159], v[80:95]
    s_waitcnt lgkmcnt(4)
    ds_read_b64_tr_b16 v[40:41], v8 offset:18432
    ds_read_b64_tr_b16 v[42:43], v8 offset:18944
    v_mfma_f32_32x32x16_bf16 v[96:111], v[44:47], a[28:31], v[96:111]
    v_mfma_f32_32x32x16_bf16 v[112:127], v[44:47], a[156:159], v[112:127]
    s_waitcnt vmcnt(16)
    s_barrier
    s_waitcnt lgkmcnt(4)
    ds_read_b64_tr_b16 v[44:45], v9 offset:18432
    ds_read_b64_tr_b16 v[46:47], v9 offset:18944
    s_mov_b32 s30, 1048576
    buffer_load_dwordx4 a[64:67], v19, s[4:7], s30 offen offset:0
    buffer_load_dwordx4 a[192:195], v19, s[4:7], s30 offen offset:512
    s_waitcnt vmcnt(32)
    v_mfma_f32_32x32x16_bf16 v[64:79], v[32:35], a[32:35], v[64:79]
    v_mfma_f32_32x32x16_bf16 v[80:95], v[32:35], a[160:163], v[80:95]
    s_waitcnt lgkmcnt(4)
    ds_read_b64_tr_b16 v[32:33], v8 offset:20480
    ds_read_b64_tr_b16 v[34:35], v8 offset:20992
    s_add_u32 m0, s40, 0
    s_nop 0
    buffer_load_dwordx4 v14, s[8:11], s44 offen lds
    v_mfma_f32_32x32x16_bf16 v[96:111], v[36:39], a[32:35], v[96:111]
    v_mfma_f32_32x32x16_bf16 v[112:127], v[36:39], a[160:163], v[112:127]
    s_waitcnt lgkmcnt(4)
    ds_read_b64_tr_b16 v[36:37], v9 offset:20480
    ds_read_b64_tr_b16 v[38:39], v9 offset:20992
    s_mov_b32 s30, 1114112
    buffer_load_dwordx4 a[68:71], v19, s[4:7], s30 offen offset:0
    buffer_load_dwordx4 a[196:199], v19, s[4:7], s30 offen offset:512
    s_waitcnt vmcnt(31)
    v_mfma_f32_32x32x16_bf16 v[64:79], v[40:43], a[36:39], v[64:79]
    s_add_u32 m0, s40, 1024
    s_nop 0
    buffer_load_dwordx4 v14, s[8:11], s45 offen lds
    v_mfma_f32_32x32x16_bf16 v[80:95], v[40:43], a[164:167], v[80:95]
    s_waitcnt lgkmcnt(4)
    ds_read_b64_tr_b16 v[40:41], v8 offset:22528
    ds_read_b64_tr_b16 v[42:43], v8 offset:23040
    v_mfma_f32_32x32x16_bf16 v[96:111], v[44:47], a[36:39], v[96:111]
    v_mfma_f32_32x32x16_bf16 v[112:127], v[44:47], a[164:167], v[112:127]
    s_waitcnt lgkmcnt(4)
    ds_read_b64_tr_b16 v[44:45], v9 offset:22528
    ds_read_b64_tr_b16 v[46:47], v9 offset:23040
    s_mov_b32 s30, 1179648
    buffer_load_dwordx4 a[72:75], v19, s[4:7], s30 offen offset:0
    buffer_load_dwordx4 a[200:203], v19, s[4:7], s30 offen offset:512
    s_waitcnt vmcnt(29)
    s_add_u32 m0, s40, 2048
    s_nop 0
    buffer_load_dwordx4 v14, s[8:11], s46 offen lds
    v_mfma_f32_32x32x16_bf16 v[64:79], v[32:35], a[40:43], v[64:79]
    v_mfma_f32_32x32x16_bf16 v[80:95], v[32:35], a[168:171], v[80:95]
    s_waitcnt lgkmcnt(4)
    ds_read_b64_tr_b16 v[32:33], v8 offset:24576
    ds_read_b64_tr_b16 v[34:35], v8 offset:25088
    v_mfma_f32_32x32x16_bf16 v[96:111], v[36:39], a[40:43], v[96:111]
    s_add_u32 m0, s40, 3072
    s_nop 0
    buffer_load_dwordx4 v14, s[8:11], s47 offen lds
    v_mfma_f32_32x32x16_bf16 v[112:127], v[36:39], a[168:171], v[112:127]
    s_waitcnt lgkmcnt(4)
    ds_read_b64_tr_b16 v[36:37], v9 offset:24576
    ds_read_b64_tr_b16 v[38:39], v9 offset:25088
    s_mov_b32 s30, 1245184
    buffer_load_dwordx4 a[76:79], v19, s[4:7], s30 offen offset:0
    buffer_load_dwordx4 a[204:207], v19, s[4:7], s30 offen offset:512
    s_waitcnt vmcnt(29)
    v_mfma_f32_32x32x16_bf16 v[64:79], v[40:43], a[44:47], v[64:79]
    v_mfma_f32_32x32x16_bf16 v[80:95], v[40:43], a[172:175], v[80:95]
    s_waitcnt lgkmcnt(4)
    ds_read_b64_tr_b16 v[40:41], v8 offset:26624
    ds_read_b64_tr_b16 v[42:43], v8 offset:27136
    s_add_u32 m0, s40, 4096
    s_nop 0
    buffer_load_dwordx4 v14, s[8:11], s48 offen lds
    v_mfma_f32_32x32x16_bf16 v[96:111], v[44:47], a[44:47], v[96:111]
    v_mfma_f32_32x32x16_bf16 v[112:127], v[44:47], a[172:175], v[112:127]
    s_waitcnt lgkmcnt(4)
    ds_read_b64_tr_b16 v[44:45], v9 offset:26624
    ds_read_b64_tr_b16 v[46:47], v9 offset:27136
    s_mov_b32 s30, 1310720
    buffer_load_dwordx4 a[80:83], v19, s[4:7], s30 offen offset:0
    buffer_load_dwordx4 a[208:211], v19, s[4:7], s30 offen offset:512
    s_waitcnt vmcnt(28)
    v_mfma_f32_32x32x16_bf16 v[64:79], v[32:35], a[48:51], v[64:79]
    s_add_u32 m0, s40, 5120
    s_nop 0
    buffer_load_dwordx4 v14, s[8:11], s49 offen lds
    v_mfma_f32_32x32x16_bf16 v[80:95], v[32:35], a[176:179], v[80:95]
    s_waitcnt lgkmcnt(4)
    ds_read_b64_tr_b16 v[32:33], v8 offset:28672
    ds_read_b64_tr_b16 v[34:35], v8 offset:29184
    v_mfma_f32_32x32x16_bf16 v[96:111], v[36:39], a[48:51], v[96:111]
    v_mfma_f32_32x32x16_bf16 v[112:127], v[36:39], a[176:179], v[112:127]
    s_waitcnt lgkmcnt(4)
    ds_read_b64_tr_b16 v[36:37], v9 offset:28672
    ds_read_b64_tr_b16 v[38:39], v9 offset:29184
    s_mov_b32 s30, 1376256
    buffer_load_dwordx4 a[84:87], v19, s[4:7], s30 offen offset:0
    buffer_load_dwordx4 a[212:215], v19, s[4:7], s30 offen offset:512
    s_waitcnt vmcnt(27)
    s_add_u32 m0, s40, 6144
    s_nop 0
    buffer_load_dwordx4 v14, s[8:11], s50 offen lds
    v_mfma_f32_32x32x16_bf16 v[64:79], v[40:43], a[52:55], v[64:79]
    v_mfma_f32_32x32x16_bf16 v[80:95], v[40:43], a[180:183], v[80:95]
    s_waitcnt lgkmcnt(4)
    ds_read_b64_tr_b16 v[40:41], v8 offset:30720
    ds_read_b64_tr_b16 v[42:43], v8 offset:31232
    v_mfma_f32_32x32x16_bf16 v[96:111], v[44:47], a[52:55], v[96:111]
    s_add_u32 m0, s40, 7168
    s_nop 0
    buffer_load_dwordx4 v14, s[8:11], s51 offen lds
    v_mfma_f32_32x32x16_bf16 v[112:127], v[44:47], a[180:183], v[112:127]
    s_waitcnt lgkmcnt(4)
    ds_read_b64_tr_b16 v[44:45], v9 offset:30720
    ds_read_b64_tr_b16 v[46:47], v9 offset:31232
    s_mov_b32 s30, 1441792
    buffer_load_dwordx4 a[88:91], v19, s[4:7], s30 offen offset:0
    buffer_load_dwordx4 a[216:219], v19, s[4:7], s30 offen offset:512
    s_waitcnt vmcnt(26)
    v_mfma_f32_32x32x16_bf16 v[64:79], v[32:35], a[56:59], v[64:79]
    v_mfma_f32_32x32x16_bf16 v[80:95], v[32:35], a[184:187], v[80:95]
    s_waitcnt lgkmcnt(4)
    ds_read_b64_tr_b16 v[32:33], v10 offset:0
    ds_read_b64_tr_b16 v[34:35], v10 offset:512
    v_add_u32 v14, 4292870016, v14
    s_add_u32 s41, s41, 32768
    s_and_b32 s41, s41, 0x1ffff
    s_add_u32 s40, s41, s42
    v_mfma_f32_32x32x16_bf16 v[96:111], v[36:39], a[56:59], v[96:111]
    v_mfma_f32_32x32x16_bf16 v[112:127], v[36:39], a[184:187], v[112:127]
    s_waitcnt lgkmcnt(4)
    ds_read_b64_tr_b16 v[36:37], v11 offset:0
    ds_read_b64_tr_b16 v[38:39], v11 offset:512
    s_mov_b32 s30, 1507328
    buffer_load_dwordx4 a[92:95], v19, s[4:7], s30 offen offset:0
    buffer_load_dwordx4 a[220:223], v19, s[4:7], s30 offen offset:512
    s_waitcnt vmcnt(24)
    v_mfma_f32_32x32x16_bf16 v[64:79], v[40:43], a[60:63], v[64:79]
    v_mfma_f32_32x32x16_bf16 v[80:95], v[40:43], a[188:191], v[80:95]
    s_waitcnt lgkmcnt(4)
    ds_read_b64_tr_b16 v[40:41], v10 offset:2048
    ds_read_b64_tr_b16 v[42:43], v10 offset:2560
    v_mfma_f32_32x32x16_bf16 v[96:111], v[44:47], a[60:63], v[96:111]
    v_mfma_f32_32x32x16_bf16 v[112:127], v[44:47], a[188:191], v[112:127]
    v_mov_b32 v8, v10
    v_mov_b32 v9, v11
    s_add_u32 s43, s43, 32768
    s_and_b32 s43, s43, 0x1ffff
    v_add_u32 v10, s43, v12
    v_add_u32 v11, s43, v13
    s_waitcnt lgkmcnt(4)
    ds_read_b64_tr_b16 v[44:45], v9 offset:2048
    ds_read_b64_tr_b16 v[46:47], v9 offset:2560
    s_mov_b32 s30, 1572864
    buffer_load_dwordx4 a[96:99], v19, s[4:7], s30 offen offset:0
    buffer_load_dwordx4 a[224:227], v19, s[4:7], s30 offen offset:512
    s_waitcnt vmcnt(24)
    v_mfma_f32_32x32x16_bf16 v[64:79], v[32:35], a[64:67], v[64:79]
    v_mfma_f32_32x32x16_bf16 v[80:95], v[32:35], a[192:195], v[80:95]
    s_waitcnt lgkmcnt(4)
    ds_read_b64_tr_b16 v[32:33], v8 offset:4096
    ds_read_b64_tr_b16 v[34:35], v8 offset:4608
    v_mfma_f32_32x32x16_bf16 v[96:111], v[36:39], a[64:67], v[96:111]
    v_mfma_f32_32x32x16_bf16 v[112:127], v[36:39], a[192:195], v[112:127]
    s_waitcnt lgkmcnt(4)
    ds_read_b64_tr_b16 v[36:37], v9 offset:4096
    ds_read_b64_tr_b16 v[38:39], v9 offset:4608
    s_mov_b32 s30, 1638400
    buffer_load_dwordx4 a[100:103], v19, s[4:7], s30 offen offset:0
    buffer_load_dwordx4 a[228:231], v19, s[4:7], s30 offen offset:512
    s_waitcnt vmcnt(23)
    v_mfma_f32_32x32x16_bf16 v[64:79], v[40:43], a[68:71], v[64:79]
    v_mfma_f32_32x32x16_bf16 v[80:95], v[40:43], a[196:199], v[80:95]
    s_waitcnt lgkmcnt(4)
    ds_read_b64_tr_b16 v[40:41], v8 offset:6144
    ds_read_b64_tr_b16 v[42:43], v8 offset:6656
    v_mfma_f32_32x32x16_bf16 v[96:111], v[44:47], a[68:71], v[96:111]
    v_mfma_f32_32x32x16_bf16 v[112:127], v[44:47], a[196:199], v[112:127]
    s_waitcnt lgkmcnt(4)
    ds_read_b64_tr_b16 v[44:45], v9 offset:6144
    ds_read_b64_tr_b16 v[46:47], v9 offset:6656
    s_mov_b32 s30, 1703936
    buffer_load_dwordx4 a[104:107], v19, s[4:7], s30 offen offset:0
    buffer_load_dwordx4 a[232:235], v19, s[4:7], s30 offen offset:512
    s_waitcnt vmcnt(22)
    v_mfma_f32_32x32x16_bf16 v[64:79], v[32:35], a[72:75], v[64:79]
    v_mfma_f32_32x32x16_bf16 v[80:95], v[32:35], a[200:203], v[80:95]
    s_waitcnt lgkmcnt(4)
    ds_read_b64_tr_b16 v[32:33], v8 offset:8192
    ds_read_b64_tr_b16 v[34:35], v8 offset:8704
    v_mfma_f32_32x32x16_bf16 v[96:111], v[36:39], a[72:75], v[96:111]
    v_mfma_f32_32x32x16_bf16 v[112:127], v[36:39], a[200:203], v[112:127]
    s_waitcnt lgkmcnt(4)
    ds_read_b64_tr_b16 v[36:37], v9 offset:8192
    ds_read_b64_tr_b16 v[38:39], v9 offset:8704
    s_mov_b32 s30, 1769472
    buffer_load_dwordx4 a[108:111], v19, s[4:7], s30 offen offset:0
    buffer_load_dwordx4 a[236:239], v19, s[4:7], s30 offen offset:512
    s_waitcnt vmcnt(20)
    v_mfma_f32_32x32x16_bf16 v[64:79], v[40:43], a[76:79], v[64:79]
    v_mfma_f32_32x32x16_bf16 v[80:95], v[40:43], a[204:207], v[80:95]
    s_waitcnt lgkmcnt(4)
    ds_read_b64_tr_b16 v[40:41], v8 offset:10240
    ds_read_b64_tr_b16 v[42:43], v8 offset:10752
    v_mfma_f32_32x32x16_bf16 v[96:111], v[44:47], a[76:79], v[96:111]
    v_mfma_f32_32x32x16_bf16 v[112:127], v[44:47], a[204:207], v[112:127]
    s_waitcnt lgkmcnt(4)
    ds_read_b64_tr_b16 v[44:45], v9 offset:10240
    ds_read_b64_tr_b16 v[46:47], v9 offset:10752
    s_mov_b32 s30, 1835008
    buffer_load_dwordx4 a[112:115], v19, s[4:7], s30 offen offset:0
    buffer_load_dwordx4 a[240:243], v19, s[4:7], s30 offen offset:512
    s_waitcnt vmcnt(19)
    v_mfma_f32_32x32x16_bf16 v[64:79], v[32:35], a[80:83], v[64:79]
    v_mfma_f32_32x32x16_bf16 v[80:95], v[32:35], a[208:211], v[80:95]
    s_waitcnt lgkmcnt(4)
    ds_read_b64_tr_b16 v[32:33], v8 offset:12288
    ds_read_b64_tr_b16 v[34:35], v8 offset:12800
    v_mfma_f32_32x32x16_bf16 v[96:111], v[36:39], a[80:83], v[96:111]
    v_mfma_f32_32x32x16_bf16 v[112:127], v[36:39], a[208:211], v[112:127]
    s_waitcnt lgkmcnt(4)
    ds_read_b64_tr_b16 v[36:37], v9 offset:12288
    ds_read_b64_tr_b16 v[38:39], v9 offset:12800
    s_mov_b32 s30, 1900544
    buffer_load_dwordx4 a[116:119], v19, s[4:7], s30 offen offset:0
    buffer_load_dwordx4 a[244:247], v19, s[4:7], s30 offen offset:512
    s_waitcnt vmcnt(18)
    v_mfma_f32_32x32x16_bf16 v[64:79], v[40:43], a[84:87], v[64:79]
    v_mfma_f32_32x32x16_bf16 v[80:95], v[40:43], a[212:215], v[80:95]
    s_waitcnt lgkmcnt(4)
    ds_read_b64_tr_b16 v[40:41], v8 offset:14336
    ds_read_b64_tr_b16 v[42:43], v8 offset:14848
    v_mfma_f32_32x32x16_bf16 v[96:111], v[44:47], a[84:87], v[96:111]
    v_mfma_f32_32x32x16_bf16 v[112:127], v[44:47], a[212:215], v[112:127]
    s_waitcnt lgkmcnt(4)
    ds_read_b64_tr_b16 v[44:45], v9 offset:14336
    ds_read_b64_tr_b16 v[46:47], v9 offset:14848
    s_mov_b32 s30, 1966080
    buffer_load_dwordx4 a[120:123], v19, s[4:7], s30 offen offset:0
    buffer_load_dwordx4 a[248:251], v19, s[4:7], s30 offen offset:512
    s_waitcnt vmcnt(16)
    v_mfma_f32_32x32x16_bf16 v[64:79], v[32:35], a[88:91], v[64:79]
    v_mfma_f32_32x32x16_bf16 v[80:95], v[32:35], a[216:219], v[80:95]
    s_waitcnt lgkmcnt(4)
    ds_read_b64_tr_b16 v[32:33], v8 offset:16384
    ds_read_b64_tr_b16 v[34:35], v8 offset:16896
    v_mfma_f32_32x32x16_bf16 v[96:111], v[36:39], a[88:91], v[96:111]
    v_mfma_f32_32x32x16_bf16 v[112:127], v[36:39], a[216:219], v[112:127]
    s_waitcnt lgkmcnt(4)
    ds_read_b64_tr_b16 v[36:37], v9 offset:16384
    ds_read_b64_tr_b16 v[38:39], v9 offset:16896
    s_mov_b32 s30, 2031616
    buffer_load_dwordx4 a[124:127], v19, s[4:7], s30 offen offset:0
    buffer_load_dwordx4 a[252:255], v19, s[4:7], s30 offen offset:512
    s_waitcnt vmcnt(16)
    v_mfma_f32_32x32x16_bf16 v[64:79], v[40:43], a[92:95], v[64:79]
    v_mfma_f32_32x32x16_bf16 v[80:95], v[40:43], a[220:223], v[80:95]
    s_waitcnt lgkmcnt(4)
    ds_read_b64_tr_b16 v[40:41], v8 offset:18432
    ds_read_b64_tr_b16 v[42:43], v8 offset:18944
    v_mfma_f32_32x32x16_bf16 v[96:111], v[44:47], a[92:95], v[96:111]
    v_mfma_f32_32x32x16_bf16 v[112:127], v[44:47], a[220:223], v[112:127]
    s_waitcnt vmcnt(63)
    s_waitcnt vmcnt(42)
    s_barrier
    s_cmp_lg_u32 s38, 0
    s_cbranch_scc1 L_qkv_nosig
    v_mov_b32 v25, 1
    s_lshl_b32 s33, s59, 2
    v_mov_b32 v26, s33
    s_mov_b64 s[34:35], exec
    s_mov_b64 exec, 1
    buffer_atomic_add v25, v26, s[52:55], 0 offen sc1
    s_mov_b64 exec, s[34:35]
L_qkv_nosig:
    s_waitcnt lgkmcnt(4)
    ds_read_b64_tr_b16 v[44:45], v9 offset:18432
    ds_read_b64_tr_b16 v[46:47], v9 offset:18944
    s_waitcnt vmcnt(14)
    v_mfma_f32_32x32x16_bf16 v[64:79], v[32:35], a[96:99], v[64:79]
    v_mfma_f32_32x32x16_bf16 v[80:95], v[32:35], a[224:227], v[80:95]
    s_waitcnt lgkmcnt(4)
    ds_read_b64_tr_b16 v[32:33], v8 offset:20480
    ds_read_b64_tr_b16 v[34:35], v8 offset:20992
    s_add_u32 m0, s40, 0
    s_nop 0
    buffer_load_dwordx4 v14, s[64:67], s44 offen lds
    v_mfma_f32_32x32x16_bf16 v[96:111], v[36:39], a[96:99], v[96:111]
    v_mfma_f32_32x32x16_bf16 v[112:127], v[36:39], a[224:227], v[112:127]
    s_waitcnt lgkmcnt(4)
    ds_read_b64_tr_b16 v[36:37], v9 offset:20480
    ds_read_b64_tr_b16 v[38:39], v9 offset:20992
    s_waitcnt vmcnt(13)
    v_mfma_f32_32x32x16_bf16 v[64:79], v[40:43], a[100:103], v[64:79]
    s_add_u32 m0, s40, 1024
    s_nop 0
    buffer_load_dwordx4 v14, s[64:67], s45 offen lds
    v_mfma_f32_32x32x16_bf16 v[80:95], v[40:43], a[228:231], v[80:95]
    s_waitcnt lgkmcnt(4)
    ds_read_b64_tr_b16 v[40:41], v8 offset:22528
    ds_read_b64_tr_b16 v[42:43], v8 offset:23040
    v_mfma_f32_32x32x16_bf16 v[96:111], v[44:47], a[100:103], v[96:111]
    v_mfma_f32_32x32x16_bf16 v[112:127], v[44:47], a[228:231], v[112:127]
    s_waitcnt lgkmcnt(4)
    ds_read_b64_tr_b16 v[44:45], v9 offset:22528
    ds_read_b64_tr_b16 v[46:47], v9 offset:23040
    s_waitcnt vmcnt(12)
    s_add_u32 m0, s40, 2048
    s_nop 0
    buffer_load_dwordx4 v14, s[64:67], s46 offen lds
    v_mfma_f32_32x32x16_bf16 v[64:79], v[32:35], a[104:107], v[64:79]
    v_mfma_f32_32x32x16_bf16 v[80:95], v[32:35], a[232:235], v[80:95]
    s_waitcnt lgkmcnt(4)
    ds_read_b64_tr_b16 v[32:33], v8 offset:24576
    ds_read_b64_tr_b16 v[34:35], v8 offset:25088
    v_mfma_f32_32x32x16_bf16 v[96:111], v[36:39], a[104:107], v[96:111]
    s_add_u32 m0, s40, 3072
    s_nop 0
    buffer_load_dwordx4 v14, s[64:67], s47 offen lds
    v_mfma_f32_32x32x16_bf16 v[112:127], v[36:39], a[232:235], v[112:127]
    s_waitcnt lgkmcnt(4)
    ds_read_b64_tr_b16 v[36:37], v9 offset:24576
    ds_read_b64_tr_b16 v[38:39], v9 offset:25088
    s_waitcnt vmcnt(12)
    v_mfma_f32_32x32x16_bf16 v[64:79], v[40:43], a[108:111], v[64:79]
    v_mfma_f32_32x32x16_bf16 v[80:95], v[40:43], a[236:239], v[80:95]
    s_waitcnt lgkmcnt(4)
    ds_read_b64_tr_b16 v[40:41], v8 offset:26624
    ds_read_b64_tr_b16 v[42:43], v8 offset:27136
    s_add_u32 m0, s40, 4096
    s_nop 0
    buffer_load_dwordx4 v14, s[64:67], s48 offen lds
    v_mfma_f32_32x32x16_bf16 v[96:111], v[44:47], a[108:111], v[96:111]
    v_mfma_f32_32x32x16_bf16 v[112:127], v[44:47], a[236:239], v[112:127]
    s_waitcnt lgkmcnt(4)
    ds_read_b64_tr_b16 v[44:45], v9 offset:26624
    ds_read_b64_tr_b16 v[46:47], v9 offset:27136
    s_waitcnt vmcnt(11)
    v_mfma_f32_32x32x16_bf16 v[64:79], v[32:35], a[112:115], v[64:79]
    s_add_u32 m0, s40, 5120
    s_nop 0
    buffer_load_dwordx4 v14, s[64:67], s49 offen lds
    v_mfma_f32_32x32x16_bf16 v[80:95], v[32:35], a[240:243], v[80:95]
    s_waitcnt lgkmcnt(4)
    ds_read_b64_tr_b16 v[32:33], v8 offset:28672
    ds_read_b64_tr_b16 v[34:35], v8 offset:29184
    v_mfma_f32_32x32x16_bf16 v[96:111], v[36:39], a[112:115], v[96:111]
    v_mfma_f32_32x32x16_bf16 v[112:127], v[36:39], a[240:243], v[112:127]
    s_waitcnt lgkmcnt(4)
    ds_read_b64_tr_b16 v[36:37], v9 offset:28672
    ds_read_b64_tr_b16 v[38:39], v9 offset:29184
    s_waitcnt vmcnt(10)
    s_add_u32 m0, s40, 6144
    s_nop 0
    buffer_load_dwordx4 v14, s[64:67], s50 offen lds
    v_mfma_f32_32x32x16_bf16 v[64:79], v[40:43], a[116:119], v[64:79]
    v_mfma_f32_32x32x16_bf16 v[80:95], v[40:43], a[244:247], v[80:95]
    s_waitcnt lgkmcnt(4)
    ds_read_b64_tr_b16 v[40:41], v8 offset:30720
    ds_read_b64_tr_b16 v[42:43], v8 offset:31232
    v_mfma_f32_32x32x16_bf16 v[96:111], v[44:47], a[116:119], v[96:111]
    s_add_u32 m0, s40, 7168
    s_nop 0
    buffer_load_dwordx4 v14, s[64:67], s51 offen lds
    v_mfma_f32_32x32x16_bf16 v[112:127], v[44:47], a[244:247], v[112:127]
    s_waitcnt lgkmcnt(4)
    ds_read_b64_tr_b16 v[44:45], v9 offset:30720
    ds_read_b64_tr_b16 v[46:47], v9 offset:31232
    s_waitcnt vmcnt(10)
    v_mfma_f32_32x32x16_bf16 v[64:79], v[32:35], a[120:123], v[64:79]
    v_mfma_f32_32x32x16_bf16 v[80:95], v[32:35], a[248:251], v[80:95]
    s_waitcnt lgkmcnt(4)
    ds_read_b64_tr_b16 v[32:33], v10 offset:0
    ds_read_b64_tr_b16 v[34:35], v10 offset:512
    v_add_u32 v14, 2097152, v14
    s_add_u32 s41, s41, 32768
    s_and_b32 s41, s41, 0x1ffff
    s_add_u32 s40, s41, s42
    v_mfma_f32_32x32x16_bf16 v[96:111], v[36:39], a[120:123], v[96:111]
    v_mfma_f32_32x32x16_bf16 v[112:127], v[36:39], a[248:251], v[112:127]
    s_waitcnt lgkmcnt(4)
    ds_read_b64_tr_b16 v[36:37], v11 offset:0
    ds_read_b64_tr_b16 v[38:39], v11 offset:512
    s_waitcnt vmcnt(8)
    v_mfma_f32_32x32x16_bf16 v[64:79], v[40:43], a[124:127], v[64:79]
    v_mfma_f32_32x32x16_bf16 v[80:95], v[40:43], a[252:255], v[80:95]
    s_waitcnt lgkmcnt(4)
    ds_read_b64_tr_b16 v[40:41], v10 offset:2048
    ds_read_b64_tr_b16 v[42:43], v10 offset:2560
    v_mfma_f32_32x32x16_bf16 v[96:111], v[44:47], a[124:127], v[96:111]
    v_mfma_f32_32x32x16_bf16 v[112:127], v[44:47], a[252:255], v[112:127]
    v_mov_b32 v8, v10
    v_mov_b32 v9, v11
    s_add_u32 s43, s43, 32768
    s_and_b32 s43, s43, 0x1ffff
    v_add_u32 v10, s43, v12
    v_add_u32 v11, s43, v13
    s_waitcnt lgkmcnt(4)
    ds_read_b64_tr_b16 v[44:45], v9 offset:2048
    ds_read_b64_tr_b16 v[46:47], v9 offset:2560
    v_mfma_f32_32x32x16_bf16 v[128:143], v[32:35], a[0:3], 0
    v_mfma_f32_32x32x16_bf16 v[144:159], v[32:35], a[128:131], 0
    s_waitcnt lgkmcnt(4)
    ds_read_b64_tr_b16 v[32:33], v8 offset:4096
    ds_read_b64_tr_b16 v[34:35], v8 offset:4608
    v_mfma_f32_32x32x16_bf16 v[160:175], v[36:39], a[0:3], 0
    v_cvt_pk_bf16_f32 v48, v64, v65
    v_cvt_pk_bf16_f32 v49, v66, v67
    v_mfma_f32_32x32x16_bf16 v[176:191], v[36:39], a[128:131], 0
    s_waitcnt lgkmcnt(4)
    ds_read_b64_tr_b16 v[36:37], v9 offset:4096
    ds_read_b64_tr_b16 v[38:39], v9 offset:4608
    v_cvt_pk_bf16_f32 v50, v68, v69
    v_lshrrev_b32 v2, 4, v1
    s_lshl_b32 s33, s59, 6
    s_lshl_b32 s34, s38, 4
    s_add_u32 s33, s33, s34
    v_add_u32 v2, s33, v2
    v_lshlrev_b32 v2, 13, v2
    v_and_b32 v3, 15, v1
    v_lshl_add_u32 v2, v3, 4, v2
    v_add_u32 v2, s36, v2
    v_mfma_f32_32x32x16_bf16 v[128:143], v[40:43], a[4:7], v[128:143]
    v_cvt_pk_bf16_f32 v51, v70, v71
    v_cvt_pk_bf16_f32 v52, v72, v73
    v_mfma_f32_32x32x16_bf16 v[144:159], v[40:43], a[132:135], v[144:159]
    s_waitcnt lgkmcnt(4)
    ds_read_b64_tr_b16 v[40:41], v8 offset:6144
    ds_read_b64_tr_b16 v[42:43], v8 offset:6656
    v_cvt_pk_bf16_f32 v53, v74, v75
    s_mov_b32 s33, 0
    buffer_load_dwordx4 v[4:7], v2, s[64:67], s33 offen
    v_mfma_f32_32x32x16_bf16 v[160:175], v[44:47], a[4:7], v[160:175]
    v_cvt_pk_bf16_f32 v54, v76, v77
    v_cvt_pk_bf16_f32 v55, v78, v79
    v_mfma_f32_32x32x16_bf16 v[176:191], v[44:47], a[132:135], v[176:191]
    s_waitcnt lgkmcnt(4)
    ds_read_b64_tr_b16 v[44:45], v9 offset:6144
    ds_read_b64_tr_b16 v[46:47], v9 offset:6656
    buffer_store_dwordx4 v[48:51], v27, s[12:15], s60 offen offset:0
    v_mfma_f32_32x32x16_bf16 v[128:143], v[32:35], a[8:11], v[128:143]
    buffer_store_dwordx4 v[52:55], v27, s[12:15], s60 offen offset:1024
    s_mov_b32 s33, 32768
    buffer_load_dwordx4 v[4:7], v2, s[64:67], s33 offen
    v_mfma_f32_32x32x16_bf16 v[144:159], v[32:35], a[136:139], v[144:159]
    s_waitcnt lgkmcnt(4)
    ds_read_b64_tr_b16 v[32:33], v8 offset:8192
    ds_read_b64_tr_b16 v[34:35], v8 offset:8704
    v_cvt_pk_bf16_f32 v56, v80, v81
    v_cvt_pk_bf16_f32 v57, v82, v83
    v_mfma_f32_32x32x16_bf16 v[160:175], v[36:39], a[8:11], v[160:175]
    v_cvt_pk_bf16_f32 v58, v84, v85
    v_mfma_f32_32x32x16_bf16 v[176:191], v[36:39], a[136:139], v[176:191]
    s_waitcnt lgkmcnt(4)
    ds_read_b64_tr_b16 v[36:37], v9 offset:8192
    ds_read_b64_tr_b16 v[38:39], v9 offset:8704
    v_cvt_pk_bf16_f32 v59, v86, v87
    v_cvt_pk_bf16_f32 v60, v88, v89
    s_mov_b32 s33, 65536
    buffer_load_dwordx4 v[4:7], v2, s[64:67], s33 offen
    v_mfma_f32_32x32x16_bf16 v[128:143], v[40:43], a[12:15], v[128:143]
    v_cvt_pk_bf16_f32 v61, v90, v91
    v_mfma_f32_32x32x16_bf16 v[144:159], v[40:43], a[140:143], v[144:159]
    s_waitcnt lgkmcnt(4)
    ds_read_b64_tr_b16 v[40:41], v8 offset:10240
    ds_read_b64_tr_b16 v[42:43], v8 offset:10752
    v_cvt_pk_bf16_f32 v62, v92, v93
    v_cvt_pk_bf16_f32 v63, v94, v95
    v_mfma_f32_32x32x16_bf16 v[160:175], v[44:47], a[12:15], v[160:175]
    buffer_store_dwordx4 v[56:59], v27, s[12:15], s60 offen offset:512
    s_mov_b32 s33, 98304
    buffer_load_dwordx4 v[4:7], v2, s[64:67], s33 offen
    v_mfma_f32_32x32x16_bf16 v[176:191], v[44:47], a[140:143], v[176:191]
    s_waitcnt lgkmcnt(4)
    ds_read_b64_tr_b16 v[44:45], v9 offset:10240
    ds_read_b64_tr_b16 v[46:47], v9 offset:10752
    buffer_store_dwordx4 v[60:63], v27, s[12:15], s60 offen offset:1536
    v_mfma_f32_32x32x16_bf16 v[128:143], v[32:35], a[16:19], v[128:143]
    v_cvt_pk_bf16_f32 v48, v96, v97
    v_cvt_pk_bf16_f32 v49, v98, v99
    v_mfma_f32_32x32x16_bf16 v[144:159], v[32:35], a[144:147], v[144:159]
    s_waitcnt lgkmcnt(4)
    ds_read_b64_tr_b16 v[32:33], v8 offset:12288
    ds_read_b64_tr_b16 v[34:35], v8 offset:12800
    v_cvt_pk_bf16_f32 v50, v100, v101
    s_mov_b32 s33, 0
    buffer_load_dwordx4 v[4:7], v2, s[68:71], s33 offen
    v_mfma_f32_32x32x16_bf16 v[160:175], v[36:39], a[16:19], v[160:175]
    v_cvt_pk_bf16_f32 v51, v102, v103
    v_cvt_pk_bf16_f32 v52, v104, v105
    v_mfma_f32_32x32x16_bf16 v[176:191], v[36:39], a[144:147], v[176:191]
    s_waitcnt lgkmcnt(4)
    ds_read_b64_tr_b16 v[36:37], v9 offset:12288
    ds_read_b64_tr_b16 v[38:39], v9 offset:12800
    v_cvt_pk_bf16_f32 v53, v106, v107
    v_mfma_f32_32x32x16_bf16 v[128:143], v[40:43], a[20:23], v[128:143]
    v_cvt_pk_bf16_f32 v54, v108, v109
    v_cvt_pk_bf16_f32 v55, v110, v111
    s_mov_b32 s33, 32768
    buffer_load_dwordx4 v[4:7], v2, s[68:71], s33 offen
    v_mfma_f32_32x32x16_bf16 v[144:159], v[40:43], a[148:151], v[144:159]
    s_waitcnt lgkmcnt(4)
    ds_read_b64_tr_b16 v[40:41], v8 offset:14336
    ds_read_b64_tr_b16 v[42:43], v8 offset:14848
    buffer_store_dwordx4 v[48:51], v28, s[12:15], s60 offen offset:0
    v_mfma_f32_32x32x16_bf16 v[160:175], v[44:47], a[20:23], v[160:175]
    buffer_store_dwordx4 v[52:55], v28, s[12:15], s60 offen offset:1024
    v_mfma_f32_32x32x16_bf16 v[176:191], v[44:47], a[148:151], v[176:191]
    s_waitcnt lgkmcnt(4)
    ds_read_b64_tr_b16 v[44:45], v9 offset:14336
    ds_read_b64_tr_b16 v[46:47], v9 offset:14848
    v_cvt_pk_bf16_f32 v56, v112, v113
    v_cvt_pk_bf16_f32 v57, v114, v115
    s_mov_b32 s33, 65536
    buffer_load_dwordx4 v[4:7], v2, s[68:71], s33 offen
    v_mfma_f32_32x32x16_bf16 v[128:143], v[32:35], a[24:27], v[128:143]
    v_cvt_pk_bf16_f32 v58, v116, v117
    v_mfma_f32_32x32x16_bf16 v[144:159], v[32:35], a[152:155], v[144:159]
    s_waitcnt lgkmcnt(4)
    ds_read_b64_tr_b16 v[32:33], v8 offset:16384
    ds_read_b64_tr_b16 v[34:35], v8 offset:16896
    v_cvt_pk_bf16_f32 v59, v118, v119
    v_cvt_pk_bf16_f32 v60, v120, v121
    v_mfma_f32_32x32x16_bf16 v[160:175], v[36:39], a[24:27], v[160:175]
    v_cvt_pk_bf16_f32 v61, v122, v123
    s_mov_b32 s33, 98304
    buffer_load_dwordx4 v[4:7], v2, s[68:71], s33 offen
    v_mfma_f32_32x32x16_bf16 v[176:191], v[36:39], a[152:155], v[176:191]
    s_waitcnt lgkmcnt(4)
    ds_read_b64_tr_b16 v[36:37], v9 offset:16384
    ds_read_b64_tr_b16 v[38:39], v9 offset:16896
    v_cvt_pk_bf16_f32 v62, v124, v125
    v_cvt_pk_bf16_f32 v63, v126, v127
    v_mfma_f32_32x32x16_bf16 v[128:143], v[40:43], a[28:31], v[128:143]
    buffer_store_dwordx4 v[56:59], v28, s[12:15], s60 offen offset:512
    v_mfma_f32_32x32x16_bf16 v[144:159], v[40:43], a[156:159], v[144:159]
    s_waitcnt lgkmcnt(4)
    ds_read_b64_tr_b16 v[40:41], v8 offset:18432
    ds_read_b64_tr_b16 v[42:43], v8 offset:18944
    buffer_store_dwordx4 v[60:63], v28, s[12:15], s60 offen offset:1536
    v_mfma_f32_32x32x16_bf16 v[160:175], v[44:47], a[28:31], v[160:175]
    v_mfma_f32_32x32x16_bf16 v[176:191], v[44:47], a[156:159], v[176:191]
    s_waitcnt vmcnt(44)
    s_barrier
    s_waitcnt lgkmcnt(4)
    ds_read_b64_tr_b16 v[44:45], v9 offset:18432
    ds_read_b64_tr_b16 v[46:47], v9 offset:18944
    v_mfma_f32_32x32x16_bf16 v[128:143], v[32:35], a[32:35], v[128:143]
    v_mfma_f32_32x32x16_bf16 v[144:159], v[32:35], a[160:163], v[144:159]
    s_waitcnt lgkmcnt(4)
    ds_read_b64_tr_b16 v[32:33], v8 offset:20480
    ds_read_b64_tr_b16 v[34:35], v8 offset:20992
    s_add_u32 m0, s40, 0
    s_nop 0
    buffer_load_dwordx4 v14, s[64:67], s44 offen lds
    v_mfma_f32_32x32x16_bf16 v[160:175], v[36:39], a[32:35], v[160:175]
    v_mfma_f32_32x32x16_bf16 v[176:191], v[36:39], a[160:163], v[176:191]
    s_waitcnt lgkmcnt(4)
    ds_read_b64_tr_b16 v[36:37], v9 offset:20480
    ds_read_b64_tr_b16 v[38:39], v9 offset:20992
    v_mfma_f32_32x32x16_bf16 v[128:143], v[40:43], a[36:39], v[128:143]
    s_add_u32 m0, s40, 1024
    s_nop 0
    buffer_load_dwordx4 v14, s[64:67], s45 offen lds
    v_mfma_f32_32x32x16_bf16 v[144:159], v[40:43], a[164:167], v[144:159]
    s_waitcnt lgkmcnt(4)
    ds_read_b64_tr_b16 v[40:41], v8 offset:22528
    ds_read_b64_tr_b16 v[42:43], v8 offset:23040
    v_mfma_f32_32x32x16_bf16 v[160:175], v[44:47], a[36:39], v[160:175]
    v_mfma_f32_32x32x16_bf16 v[176:191], v[44:47], a[164:167], v[176:191]
    s_waitcnt lgkmcnt(4)
    ds_read_b64_tr_b16 v[44:45], v9 offset:22528
    ds_read_b64_tr_b16 v[46:47], v9 offset:23040
    s_add_u32 m0, s40, 2048
    s_nop 0
    buffer_load_dwordx4 v14, s[64:67], s46 offen lds
    v_mfma_f32_32x32x16_bf16 v[128:143], v[32:35], a[40:43], v[128:143]
    v_mfma_f32_32x32x16_bf16 v[144:159], v[32:35], a[168:171], v[144:159]
    s_waitcnt lgkmcnt(4)
    ds_read_b64_tr_b16 v[32:33], v8 offset:24576
    ds_read_b64_tr_b16 v[34:35], v8 offset:25088
    v_mfma_f32_32x32x16_bf16 v[160:175], v[36:39], a[40:43], v[160:175]
    s_add_u32 m0, s40, 3072
    s_nop 0
    buffer_load_dwordx4 v14, s[64:67], s47 offen lds
    v_mfma_f32_32x32x16_bf16 v[176:191], v[36:39], a[168:171], v[176:191]
    s_waitcnt lgkmcnt(4)
    ds_read_b64_tr_b16 v[36:37], v9 offset:24576
    ds_read_b64_tr_b16 v[38:39], v9 offset:25088
    v_mfma_f32_32x32x16_bf16 v[128:143], v[40:43], a[44:47], v[128:143]
    v_mfma_f32_32x32x16_bf16 v[144:159], v[40:43], a[172:175], v[144:159]
    s_waitcnt lgkmcnt(4)
    ds_read_b64_tr_b16 v[40:41], v8 offset:26624
    ds_read_b64_tr_b16 v[42:43], v8 offset:27136
    s_add_u32 m0, s40, 4096
    s_nop 0
    buffer_load_dwordx4 v14, s[64:67], s48 offen lds
    v_mfma_f32_32x32x16_bf16 v[160:175], v[44:47], a[44:47], v[160:175]
    v_mfma_f32_32x32x16_bf16 v[176:191], v[44:47], a[172:175], v[176:191]
    s_waitcnt lgkmcnt(4)
    ds_read_b64_tr_b16 v[44:45], v9 offset:26624
    ds_read_b64_tr_b16 v[46:47], v9 offset:27136
    v_mfma_f32_32x32x16_bf16 v[128:143], v[32:35], a[48:51], v[128:143]
    s_add_u32 m0, s40, 5120
    s_nop 0
    buffer_load_dwordx4 v14, s[64:67], s49 offen lds
    v_mfma_f32_32x32x16_bf16 v[144:159], v[32:35], a[176:179], v[144:159]
    s_waitcnt lgkmcnt(4)
    ds_read_b64_tr_b16 v[32:33], v8 offset:28672
    ds_read_b64_tr_b16 v[34:35], v8 offset:29184
    v_mfma_f32_32x32x16_bf16 v[160:175], v[36:39], a[48:51], v[160:175]
    v_mfma_f32_32x32x16_bf16 v[176:191], v[36:39], a[176:179], v[176:191]
    s_waitcnt lgkmcnt(4)
    ds_read_b64_tr_b16 v[36:37], v9 offset:28672
    ds_read_b64_tr_b16 v[38:39], v9 offset:29184
    s_add_u32 m0, s40, 6144
    s_nop 0
    buffer_load_dwordx4 v14, s[64:67], s50 offen lds
    v_mfma_f32_32x32x16_bf16 v[128:143], v[40:43], a[52:55], v[128:143]
    v_mfma_f32_32x32x16_bf16 v[144:159], v[40:43], a[180:183], v[144:159]
    s_waitcnt lgkmcnt(4)
    ds_read_b64_tr_b16 v[40:41], v8 offset:30720
    ds_read_b64_tr_b16 v[42:43], v8 offset:31232
    v_mfma_f32_32x32x16_bf16 v[160:175], v[44:47], a[52:55], v[160:175]
    s_add_u32 m0, s40, 7168
    s_nop 0
    buffer_load_dwordx4 v14, s[64:67], s51 offen lds
    v_mfma_f32_32x32x16_bf16 v[176:191], v[44:47], a[180:183], v[176:191]
    s_waitcnt lgkmcnt(4)
    ds_read_b64_tr_b16 v[44:45], v9 offset:30720
    ds_read_b64_tr_b16 v[46:47], v9 offset:31232
    v_mfma_f32_32x32x16_bf16 v[128:143], v[32:35], a[56:59], v[128:143]
    v_mfma_f32_32x32x16_bf16 v[144:159], v[32:35], a[184:187], v[144:159]
    s_waitcnt lgkmcnt(4)
    ds_read_b64_tr_b16 v[32:33], v10 offset:0
    ds_read_b64_tr_b16 v[34:35], v10 offset:512
    v_add_u32 v14, 4292870272, v14
    s_add_u32 s41, s41, 32768
    s_and_b32 s41, s41, 0x1ffff
    s_add_u32 s40, s41, s42
    v_mfma_f32_32x32x16_bf16 v[160:175], v[36:39], a[56:59], v[160:175]
    v_mfma_f32_32x32x16_bf16 v[176:191], v[36:39], a[184:187], v[176:191]
    s_waitcnt lgkmcnt(4)
    ds_read_b64_tr_b16 v[36:37], v11 offset:0
    ds_read_b64_tr_b16 v[38:39], v11 offset:512
    v_mfma_f32_32x32x16_bf16 v[128:143], v[40:43], a[60:63], v[128:143]
    v_mfma_f32_32x32x16_bf16 v[144:159], v[40:43], a[188:191], v[144:159]
    s_waitcnt lgkmcnt(4)
    ds_read_b64_tr_b16 v[40:41], v10 offset:2048
    ds_read_b64_tr_b16 v[42:43], v10 offset:2560
    v_mfma_f32_32x32x16_bf16 v[160:175], v[44:47], a[60:63], v[160:175]
    v_mfma_f32_32x32x16_bf16 v[176:191], v[44:47], a[188:191], v[176:191]
    v_mov_b32 v8, v10
    v_mov_b32 v9, v11
    s_add_u32 s43, s43, 32768
    s_and_b32 s43, s43, 0x1ffff
    v_add_u32 v10, s43, v12
    v_add_u32 v11, s43, v13
    s_waitcnt lgkmcnt(4)
    ds_read_b64_tr_b16 v[44:45], v9 offset:2048
    ds_read_b64_tr_b16 v[46:47], v9 offset:2560
    v_mfma_f32_32x32x16_bf16 v[128:143], v[32:35], a[64:67], v[128:143]
    v_mfma_f32_32x32x16_bf16 v[144:159], v[32:35], a[192:195], v[144:159]
    s_waitcnt lgkmcnt(4)
    ds_read_b64_tr_b16 v[32:33], v8 offset:4096
    ds_read_b64_tr_b16 v[34:35], v8 offset:4608
    v_mfma_f32_32x32x16_bf16 v[160:175], v[36:39], a[64:67], v[160:175]
    v_mfma_f32_32x32x16_bf16 v[176:191], v[36:39], a[192:195], v[176:191]
    s_waitcnt lgkmcnt(4)
    ds_read_b64_tr_b16 v[36:37], v9 offset:4096
    ds_read_b64_tr_b16 v[38:39], v9 offset:4608
    v_mfma_f32_32x32x16_bf16 v[128:143], v[40:43], a[68:71], v[128:143]
    v_mfma_f32_32x32x16_bf16 v[144:159], v[40:43], a[196:199], v[144:159]
    s_waitcnt lgkmcnt(4)
    ds_read_b64_tr_b16 v[40:41], v8 offset:6144
    ds_read_b64_tr_b16 v[42:43], v8 offset:6656
    v_mfma_f32_32x32x16_bf16 v[160:175], v[44:47], a[68:71], v[160:175]
    v_mfma_f32_32x32x16_bf16 v[176:191], v[44:47], a[196:199], v[176:191]
    s_waitcnt lgkmcnt(4)
    ds_read_b64_tr_b16 v[44:45], v9 offset:6144
    ds_read_b64_tr_b16 v[46:47], v9 offset:6656
    v_mfma_f32_32x32x16_bf16 v[128:143], v[32:35], a[72:75], v[128:143]
    v_mfma_f32_32x32x16_bf16 v[144:159], v[32:35], a[200:203], v[144:159]
    s_waitcnt lgkmcnt(4)
    ds_read_b64_tr_b16 v[32:33], v8 offset:8192
    ds_read_b64_tr_b16 v[34:35], v8 offset:8704
    v_mfma_f32_32x32x16_bf16 v[160:175], v[36:39], a[72:75], v[160:175]
    v_mfma_f32_32x32x16_bf16 v[176:191], v[36:39], a[200:203], v[176:191]
    s_waitcnt lgkmcnt(4)
    ds_read_b64_tr_b16 v[36:37], v9 offset:8192
    ds_read_b64_tr_b16 v[38:39], v9 offset:8704
    v_mfma_f32_32x32x16_bf16 v[128:143], v[40:43], a[76:79], v[128:143]
    v_mfma_f32_32x32x16_bf16 v[144:159], v[40:43], a[204:207], v[144:159]
    s_waitcnt lgkmcnt(4)
    ds_read_b64_tr_b16 v[40:41], v8 offset:10240
    ds_read_b64_tr_b16 v[42:43], v8 offset:10752
    v_mfma_f32_32x32x16_bf16 v[160:175], v[44:47], a[76:79], v[160:175]
    v_mfma_f32_32x32x16_bf16 v[176:191], v[44:47], a[204:207], v[176:191]
    s_waitcnt lgkmcnt(4)
    ds_read_b64_tr_b16 v[44:45], v9 offset:10240
    ds_read_b64_tr_b16 v[46:47], v9 offset:10752
    v_mfma_f32_32x32x16_bf16 v[128:143], v[32:35], a[80:83], v[128:143]
    v_mfma_f32_32x32x16_bf16 v[144:159], v[32:35], a[208:211], v[144:159]
    s_waitcnt lgkmcnt(4)
    ds_read_b64_tr_b16 v[32:33], v8 offset:12288
    ds_read_b64_tr_b16 v[34:35], v8 offset:12800
    v_mfma_f32_32x32x16_bf16 v[160:175], v[36:39], a[80:83], v[160:175]
    v_mfma_f32_32x32x16_bf16 v[176:191], v[36:39], a[208:211], v[176:191]
    s_waitcnt lgkmcnt(4)
    ds_read_b64_tr_b16 v[36:37], v9 offset:12288
    ds_read_b64_tr_b16 v[38:39], v9 offset:12800
    v_mfma_f32_32x32x16_bf16 v[128:143], v[40:43], a[84:87], v[128:143]
    v_mfma_f32_32x32x16_bf16 v[144:159], v[40:43], a[212:215], v[144:159]
    s_waitcnt lgkmcnt(4)
    ds_read_b64_tr_b16 v[40:41], v8 offset:14336
    ds_read_b64_tr_b16 v[42:43], v8 offset:14848
    v_mfma_f32_32x32x16_bf16 v[160:175], v[44:47], a[84:87], v[160:175]
    v_mfma_f32_32x32x16_bf16 v[176:191], v[44:47], a[212:215], v[176:191]
    s_waitcnt lgkmcnt(4)
    ds_read_b64_tr_b16 v[44:45], v9 offset:14336
    ds_read_b64_tr_b16 v[46:47], v9 offset:14848
    v_mfma_f32_32x32x16_bf16 v[128:143], v[32:35], a[88:91], v[128:143]
    v_mfma_f32_32x32x16_bf16 v[144:159], v[32:35], a[216:219], v[144:159]
    s_waitcnt lgkmcnt(4)
    ds_read_b64_tr_b16 v[32:33], v8 offset:16384
    ds_read_b64_tr_b16 v[34:35], v8 offset:16896
    v_mfma_f32_32x32x16_bf16 v[160:175], v[36:39], a[88:91], v[160:175]
    v_mfma_f32_32x32x16_bf16 v[176:191], v[36:39], a[216:219], v[176:191]
    s_waitcnt lgkmcnt(4)
    ds_read_b64_tr_b16 v[36:37], v9 offset:16384
    ds_read_b64_tr_b16 v[38:39], v9 offset:16896
    v_mfma_f32_32x32x16_bf16 v[128:143], v[40:43], a[92:95], v[128:143]
    v_mfma_f32_32x32x16_bf16 v[144:159], v[40:43], a[220:223], v[144:159]
    s_waitcnt lgkmcnt(4)
    ds_read_b64_tr_b16 v[40:41], v8 offset:18432
    ds_read_b64_tr_b16 v[42:43], v8 offset:18944
    v_mfma_f32_32x32x16_bf16 v[160:175], v[44:47], a[92:95], v[160:175]
    v_mfma_f32_32x32x16_bf16 v[176:191], v[44:47], a[220:223], v[176:191]
    s_waitcnt vmcnt(24)
    s_barrier
    s_waitcnt lgkmcnt(4)
    ds_read_b64_tr_b16 v[44:45], v9 offset:18432
    ds_read_b64_tr_b16 v[46:47], v9 offset:18944
    v_mfma_f32_32x32x16_bf16 v[128:143], v[32:35], a[96:99], v[128:143]
    v_mfma_f32_32x32x16_bf16 v[144:159], v[32:35], a[224:227], v[144:159]
    s_waitcnt lgkmcnt(4)
    ds_read_b64_tr_b16 v[32:33], v8 offset:20480
    ds_read_b64_tr_b16 v[34:35], v8 offset:20992
    s_add_u32 m0, s40, 0
    s_nop 0
    buffer_load_dwordx4 v14, s[64:67], s44 offen lds
    v_mfma_f32_32x32x16_bf16 v[160:175], v[36:39], a[96:99], v[160:175]
    v_mfma_f32_32x32x16_bf16 v[176:191], v[36:39], a[224:227], v[176:191]
    s_waitcnt lgkmcnt(4)
    ds_read_b64_tr_b16 v[36:37], v9 offset:20480
    ds_read_b64_tr_b16 v[38:39], v9 offset:20992
    v_mfma_f32_32x32x16_bf16 v[128:143], v[40:43], a[100:103], v[128:143]
    s_add_u32 m0, s40, 1024
    s_nop 0
    buffer_load_dwordx4 v14, s[64:67], s45 offen lds
    v_mfma_f32_32x32x16_bf16 v[144:159], v[40:43], a[228:231], v[144:159]
    s_waitcnt lgkmcnt(4)
    ds_read_b64_tr_b16 v[40:41], v8 offset:22528
    ds_read_b64_tr_b16 v[42:43], v8 offset:23040
    v_mfma_f32_32x32x16_bf16 v[160:175], v[44:47], a[100:103], v[160:175]
    v_mfma_f32_32x32x16_bf16 v[176:191], v[44:47], a[228:231], v[176:191]
    s_waitcnt lgkmcnt(4)
    ds_read_b64_tr_b16 v[44:45], v9 offset:22528
    ds_read_b64_tr_b16 v[46:47], v9 offset:23040
    s_add_u32 m0, s40, 2048
    s_nop 0
    buffer_load_dwordx4 v14, s[64:67], s46 offen lds
    v_mfma_f32_32x32x16_bf16 v[128:143], v[32:35], a[104:107], v[128:143]
    v_mfma_f32_32x32x16_bf16 v[144:159], v[32:35], a[232:235], v[144:159]
    s_waitcnt lgkmcnt(4)
    ds_read_b64_tr_b16 v[32:33], v8 offset:24576
    ds_read_b64_tr_b16 v[34:35], v8 offset:25088
    v_mfma_f32_32x32x16_bf16 v[160:175], v[36:39], a[104:107], v[160:175]
    s_add_u32 m0, s40, 3072
    s_nop 0
    buffer_load_dwordx4 v14, s[64:67], s47 offen lds
    v_mfma_f32_32x32x16_bf16 v[176:191], v[36:39], a[232:235], v[176:191]
    s_waitcnt lgkmcnt(4)
    ds_read_b64_tr_b16 v[36:37], v9 offset:24576
    ds_read_b64_tr_b16 v[38:39], v9 offset:25088
    v_mfma_f32_32x32x16_bf16 v[128:143], v[40:43], a[108:111], v[128:143]
    v_mfma_f32_32x32x16_bf16 v[144:159], v[40:43], a[236:239], v[144:159]
    s_waitcnt lgkmcnt(4)
    ds_read_b64_tr_b16 v[40:41], v8 offset:26624
    ds_read_b64_tr_b16 v[42:43], v8 offset:27136
    s_add_u32 m0, s40, 4096
    s_nop 0
    buffer_load_dwordx4 v14, s[64:67], s48 offen lds
    v_mfma_f32_32x32x16_bf16 v[160:175], v[44:47], a[108:111], v[160:175]
    v_mfma_f32_32x32x16_bf16 v[176:191], v[44:47], a[236:239], v[176:191]
    s_waitcnt lgkmcnt(4)
    ds_read_b64_tr_b16 v[44:45], v9 offset:26624
    ds_read_b64_tr_b16 v[46:47], v9 offset:27136
    v_mfma_f32_32x32x16_bf16 v[128:143], v[32:35], a[112:115], v[128:143]
    s_add_u32 m0, s40, 5120
    s_nop 0
    buffer_load_dwordx4 v14, s[64:67], s49 offen lds
    v_mfma_f32_32x32x16_bf16 v[144:159], v[32:35], a[240:243], v[144:159]
    s_waitcnt lgkmcnt(4)
    ds_read_b64_tr_b16 v[32:33], v8 offset:28672
    ds_read_b64_tr_b16 v[34:35], v8 offset:29184
    v_mfma_f32_32x32x16_bf16 v[160:175], v[36:39], a[112:115], v[160:175]
    v_mfma_f32_32x32x16_bf16 v[176:191], v[36:39], a[240:243], v[176:191]
    s_waitcnt lgkmcnt(4)
    ds_read_b64_tr_b16 v[36:37], v9 offset:28672
    ds_read_b64_tr_b16 v[38:39], v9 offset:29184
    s_add_u32 m0, s40, 6144
    s_nop 0
    buffer_load_dwordx4 v14, s[64:67], s50 offen lds
    v_mfma_f32_32x32x16_bf16 v[128:143], v[40:43], a[116:119], v[128:143]
    v_mfma_f32_32x32x16_bf16 v[144:159], v[40:43], a[244:247], v[144:159]
    s_waitcnt lgkmcnt(4)
    ds_read_b64_tr_b16 v[40:41], v8 offset:30720
    ds_read_b64_tr_b16 v[42:43], v8 offset:31232
    v_mfma_f32_32x32x16_bf16 v[160:175], v[44:47], a[116:119], v[160:175]
    s_add_u32 m0, s40, 7168
    s_nop 0
    buffer_load_dwordx4 v14, s[64:67], s51 offen lds
    v_mfma_f32_32x32x16_bf16 v[176:191], v[44:47], a[244:247], v[176:191]
    s_waitcnt lgkmcnt(4)
    ds_read_b64_tr_b16 v[44:45], v9 offset:30720
    ds_read_b64_tr_b16 v[46:47], v9 offset:31232
    v_mfma_f32_32x32x16_bf16 v[128:143], v[32:35], a[120:123], v[128:143]
    v_mfma_f32_32x32x16_bf16 v[144:159], v[32:35], a[248:251], v[144:159]
    s_waitcnt lgkmcnt(4)
    ds_read_b64_tr_b16 v[32:33], v10 offset:0
    ds_read_b64_tr_b16 v[34:35], v10 offset:512
    v_add_u32 v14, 2097152, v14
    s_add_u32 s41, s41, 32768
    s_and_b32 s41, s41, 0x1ffff
    s_add_u32 s40, s41, s42
    v_mfma_f32_32x32x16_bf16 v[160:175], v[36:39], a[120:123], v[160:175]
    v_mfma_f32_32x32x16_bf16 v[176:191], v[36:39], a[248:251], v[176:191]
    s_waitcnt lgkmcnt(4)
    ds_read_b64_tr_b16 v[36:37], v11 offset:0
    ds_read_b64_tr_b16 v[38:39], v11 offset:512
    v_mfma_f32_32x32x16_bf16 v[128:143], v[40:43], a[124:127], v[128:143]
    v_mfma_f32_32x32x16_bf16 v[144:159], v[40:43], a[252:255], v[144:159]
    s_waitcnt lgkmcnt(4)
    ds_read_b64_tr_b16 v[40:41], v10 offset:2048
    ds_read_b64_tr_b16 v[42:43], v10 offset:2560
    v_mfma_f32_32x32x16_bf16 v[160:175], v[44:47], a[124:127], v[160:175]
    v_mfma_f32_32x32x16_bf16 v[176:191], v[44:47], a[252:255], v[176:191]
    v_mov_b32 v8, v10
    v_mov_b32 v9, v11
    s_add_u32 s43, s43, 32768
    s_and_b32 s43, s43, 0x1ffff
    v_add_u32 v10, s43, v12
    v_add_u32 v11, s43, v13
    s_waitcnt lgkmcnt(4)
    ds_read_b64_tr_b16 v[44:45], v9 offset:2048
    ds_read_b64_tr_b16 v[46:47], v9 offset:2560
    v_mfma_f32_32x32x16_bf16 v[64:79], a[0:3], v[32:35], 0
    v_mfma_f32_32x32x16_bf16 v[80:95], a[128:131], v[32:35], 0
    s_waitcnt lgkmcnt(4)
    ds_read_b64_tr_b16 v[32:33], v8 offset:4096
    ds_read_b64_tr_b16 v[34:35], v8 offset:4608
    v_mfma_f32_32x32x16_bf16 v[96:111], a[0:3], v[36:39], 0
    v_cvt_pk_bf16_f32 v48, v128, v129
    v_cvt_pk_bf16_f32 v49, v130, v131
    v_mfma_f32_32x32x16_bf16 v[112:127], a[128:131], v[36:39], 0
    s_waitcnt lgkmcnt(4)
    ds_read_b64_tr_b16 v[36:37], v9 offset:4096
    ds_read_b64_tr_b16 v[38:39], v9 offset:4608
    v_cvt_pk_bf16_f32 v50, v132, v133
    v_mfma_f32_32x32x16_bf16 v[64:79], a[4:7], v[40:43], v[64:79]
    v_cvt_pk_bf16_f32 v51, v134, v135
    v_cvt_pk_bf16_f32 v52, v136, v137
    v_mfma_f32_32x32x16_bf16 v[80:95], a[132:135], v[40:43], v[80:95]
    s_waitcnt lgkmcnt(4)
    ds_read_b64_tr_b16 v[40:41], v8 offset:6144
    ds_read_b64_tr_b16 v[42:43], v8 offset:6656
    v_cvt_pk_bf16_f32 v53, v138, v139
    v_mfma_f32_32x32x16_bf16 v[96:111], a[4:7], v[44:47], v[96:111]
    v_cvt_pk_bf16_f32 v54, v140, v141
    v_cvt_pk_bf16_f32 v55, v142, v143
    v_mfma_f32_32x32x16_bf16 v[112:127], a[132:135], v[44:47], v[112:127]
    s_waitcnt lgkmcnt(4)
    ds_read_b64_tr_b16 v[44:45], v9 offset:6144
    ds_read_b64_tr_b16 v[46:47], v9 offset:6656
    buffer_store_dwordx4 v[48:51], v27, s[12:15], s63 offen offset:0
    v_mfma_f32_32x32x16_bf16 v[64:79], a[8:11], v[32:35], v[64:79]
    buffer_store_dwordx4 v[52:55], v27, s[12:15], s63 offen offset:1024
    v_mfma_f32_32x32x16_bf16 v[80:95], a[136:139], v[32:35], v[80:95]
    s_waitcnt lgkmcnt(4)
    ds_read_b64_tr_b16 v[32:33], v8 offset:8192
    ds_read_b64_tr_b16 v[34:35], v8 offset:8704
    v_cvt_pk_bf16_f32 v56, v144, v145
    v_cvt_pk_bf16_f32 v57, v146, v147
    v_mfma_f32_32x32x16_bf16 v[96:111], a[8:11], v[36:39], v[96:111]
    v_cvt_pk_bf16_f32 v58, v148, v149
    v_mfma_f32_32x32x16_bf16 v[112:127], a[136:139], v[36:39], v[112:127]
    s_waitcnt lgkmcnt(4)
    ds_read_b64_tr_b16 v[36:37], v9 offset:8192
    ds_read_b64_tr_b16 v[38:39], v9 offset:8704
    v_cvt_pk_bf16_f32 v59, v150, v151
    v_cvt_pk_bf16_f32 v60, v152, v153
    v_mfma_f32_32x32x16_bf16 v[64:79], a[12:15], v[40:43], v[64:79]
    v_cvt_pk_bf16_f32 v61, v154, v155
    v_mfma_f32_32x32x16_bf16 v[80:95], a[140:143], v[40:43], v[80:95]
    s_waitcnt lgkmcnt(4)
    ds_read_b64_tr_b16 v[40:41], v8 offset:10240
    ds_read_b64_tr_b16 v[42:43], v8 offset:10752
    v_cvt_pk_bf16_f32 v62, v156, v157
    v_cvt_pk_bf16_f32 v63, v158, v159
    v_mfma_f32_32x32x16_bf16 v[96:111], a[12:15], v[44:47], v[96:111]
    buffer_store_dwordx4 v[56:59], v27, s[12:15], s63 offen offset:512
    v_mfma_f32_32x32x16_bf16 v[112:127], a[140:143], v[44:47], v[112:127]
    s_waitcnt lgkmcnt(4)
    ds_read_b64_tr_b16 v[44:45], v9 offset:10240
    ds_read_b64_tr_b16 v[46:47], v9 offset:10752
    buffer_store_dwordx4 v[60:63], v27, s[12:15], s63 offen offset:1536
    v_mfma_f32_32x32x16_bf16 v[64:79], a[16:19], v[32:35], v[64:79]
    v_cvt_pk_bf16_f32 v48, v160, v161
    v_cvt_pk_bf16_f32 v49, v162, v163
    v_mfma_f32_32x32x16_bf16 v[80:95], a[144:147], v[32:35], v[80:95]
    s_waitcnt lgkmcnt(4)
    ds_read_b64_tr_b16 v[32:33], v8 offset:12288
    ds_read_b64_tr_b16 v[34:35], v8 offset:12800
    v_cvt_pk_bf16_f32 v50, v164, v165
    v_mfma_f32_32x32x16_bf16 v[96:111], a[16:19], v[36:39], v[96:111]
    v_cvt_pk_bf16_f32 v51, v166, v167
    v_cvt_pk_bf16_f32 v52, v168, v169
    v_mfma_f32_32x32x16_bf16 v[112:127], a[144:147], v[36:39], v[112:127]
    s_waitcnt lgkmcnt(4)
    ds_read_b64_tr_b16 v[36:37], v9 offset:12288
    ds_read_b64_tr_b16 v[38:39], v9 offset:12800
    v_cvt_pk_bf16_f32 v53, v170, v171
    v_mfma_f32_32x32x16_bf16 v[64:79], a[20:23], v[40:43], v[64:79]
    v_cvt_pk_bf16_f32 v54, v172, v173
    v_cvt_pk_bf16_f32 v55, v174, v175
    v_mfma_f32_32x32x16_bf16 v[80:95], a[148:151], v[40:43], v[80:95]
    s_waitcnt lgkmcnt(4)
    ds_read_b64_tr_b16 v[40:41], v8 offset:14336
    ds_read_b64_tr_b16 v[42:43], v8 offset:14848
    buffer_store_dwordx4 v[48:51], v28, s[12:15], s63 offen offset:0
    v_mfma_f32_32x32x16_bf16 v[96:111], a[20:23], v[44:47], v[96:111]
    buffer_store_dwordx4 v[52:55], v28, s[12:15], s63 offen offset:1024
    v_mfma_f32_32x32x16_bf16 v[112:127], a[148:151], v[44:47], v[112:127]
    s_waitcnt lgkmcnt(4)
    ds_read_b64_tr_b16 v[44:45], v9 offset:14336
    ds_read_b64_tr_b16 v[46:47], v9 offset:14848
    v_cvt_pk_bf16_f32 v56, v176, v177
    v_cvt_pk_bf16_f32 v57, v178, v179
    v_mfma_f32_32x32x16_bf16 v[64:79], a[24:27], v[32:35], v[64:79]
    v_cvt_pk_bf16_f32 v58, v180, v181
    v_mfma_f32_32x32x16_bf16 v[80:95], a[152:155], v[32:35], v[80:95]
    s_waitcnt lgkmcnt(4)
    ds_read_b64_tr_b16 v[32:33], v8 offset:16384
    ds_read_b64_tr_b16 v[34:35], v8 offset:16896
    v_cvt_pk_bf16_f32 v59, v182, v183
    v_cvt_pk_bf16_f32 v60, v184, v185
    v_mfma_f32_32x32x16_bf16 v[96:111], a[24:27], v[36:39], v[96:111]
    v_cvt_pk_bf16_f32 v61, v186, v187
    v_mfma_f32_32x32x16_bf16 v[112:127], a[152:155], v[36:39], v[112:127]
    s_waitcnt lgkmcnt(4)
    ds_read_b64_tr_b16 v[36:37], v9 offset:16384
    ds_read_b64_tr_b16 v[38:39], v9 offset:16896
    v_cvt_pk_bf16_f32 v62, v188, v189
    v_cvt_pk_bf16_f32 v63, v190, v191
    v_mfma_f32_32x32x16_bf16 v[64:79], a[28:31], v[40:43], v[64:79]
    buffer_store_dwordx4 v[56:59], v28, s[12:15], s63 offen offset:512
    v_mfma_f32_32x32x16_bf16 v[80:95], a[156:159], v[40:43], v[80:95]
    s_waitcnt lgkmcnt(4)
    ds_read_b64_tr_b16 v[40:41], v8 offset:18432
    ds_read_b64_tr_b16 v[42:43], v8 offset:18944
    buffer_store_dwordx4 v[60:63], v28, s[12:15], s63 offen offset:1536
    v_mfma_f32_32x32x16_bf16 v[96:111], a[28:31], v[44:47], v[96:111]
    v_mfma_f32_32x32x16_bf16 v[112:127], a[156:159], v[44:47], v[112:127]
    s_waitcnt vmcnt(16)
    s_barrier
    s_waitcnt lgkmcnt(4)
    ds_read_b64_tr_b16 v[44:45], v9 offset:18432
    ds_read_b64_tr_b16 v[46:47], v9 offset:18944
    v_mfma_f32_32x32x16_bf16 v[64:79], a[32:35], v[32:35], v[64:79]
    v_mfma_f32_32x32x16_bf16 v[80:95], a[160:163], v[32:35], v[80:95]
    s_waitcnt lgkmcnt(4)
    ds_read_b64_tr_b16 v[32:33], v8 offset:20480
    ds_read_b64_tr_b16 v[34:35], v8 offset:20992
    s_add_u32 m0, s40, 0
    s_nop 0
    buffer_load_dwordx4 v14, s[64:67], s44 offen lds
    v_mfma_f32_32x32x16_bf16 v[96:111], a[32:35], v[36:39], v[96:111]
    v_mfma_f32_32x32x16_bf16 v[112:127], a[160:163], v[36:39], v[112:127]
    s_waitcnt lgkmcnt(4)
    ds_read_b64_tr_b16 v[36:37], v9 offset:20480
    ds_read_b64_tr_b16 v[38:39], v9 offset:20992
    v_mfma_f32_32x32x16_bf16 v[64:79], a[36:39], v[40:43], v[64:79]
    s_add_u32 m0, s40, 1024
    s_nop 0
    buffer_load_dwordx4 v14, s[64:67], s45 offen lds
    v_mfma_f32_32x32x16_bf16 v[80:95], a[164:167], v[40:43], v[80:95]
    s_waitcnt lgkmcnt(4)
    ds_read_b64_tr_b16 v[40:41], v8 offset:22528
    ds_read_b64_tr_b16 v[42:43], v8 offset:23040
    v_mfma_f32_32x32x16_bf16 v[96:111], a[36:39], v[44:47], v[96:111]
    v_mfma_f32_32x32x16_bf16 v[112:127], a[164:167], v[44:47], v[112:127]
    s_waitcnt lgkmcnt(4)
    ds_read_b64_tr_b16 v[44:45], v9 offset:22528
    ds_read_b64_tr_b16 v[46:47], v9 offset:23040
    s_add_u32 m0, s40, 2048
    s_nop 0
    buffer_load_dwordx4 v14, s[64:67], s46 offen lds
    v_mfma_f32_32x32x16_bf16 v[64:79], a[40:43], v[32:35], v[64:79]
    v_mfma_f32_32x32x16_bf16 v[80:95], a[168:171], v[32:35], v[80:95]
    s_waitcnt lgkmcnt(4)
    ds_read_b64_tr_b16 v[32:33], v8 offset:24576
    ds_read_b64_tr_b16 v[34:35], v8 offset:25088
    v_mfma_f32_32x32x16_bf16 v[96:111], a[40:43], v[36:39], v[96:111]
    s_add_u32 m0, s40, 3072
    s_nop 0
    buffer_load_dwordx4 v14, s[64:67], s47 offen lds
    v_mfma_f32_32x32x16_bf16 v[112:127], a[168:171], v[36:39], v[112:127]
    s_waitcnt lgkmcnt(4)
    ds_read_b64_tr_b16 v[36:37], v9 offset:24576
    ds_read_b64_tr_b16 v[38:39], v9 offset:25088
    v_mfma_f32_32x32x16_bf16 v[64:79], a[44:47], v[40:43], v[64:79]
    v_mfma_f32_32x32x16_bf16 v[80:95], a[172:175], v[40:43], v[80:95]
    s_waitcnt lgkmcnt(4)
    ds_read_b64_tr_b16 v[40:41], v8 offset:26624
    ds_read_b64_tr_b16 v[42:43], v8 offset:27136
    s_add_u32 m0, s40, 4096
    s_nop 0
    buffer_load_dwordx4 v14, s[64:67], s48 offen lds
    v_mfma_f32_32x32x16_bf16 v[96:111], a[44:47], v[44:47], v[96:111]
    v_mfma_f32_32x32x16_bf16 v[112:127], a[172:175], v[44:47], v[112:127]
    s_waitcnt lgkmcnt(4)
    ds_read_b64_tr_b16 v[44:45], v9 offset:26624
    ds_read_b64_tr_b16 v[46:47], v9 offset:27136
    v_mfma_f32_32x32x16_bf16 v[64:79], a[48:51], v[32:35], v[64:79]
    s_add_u32 m0, s40, 5120
    s_nop 0
    buffer_load_dwordx4 v14, s[64:67], s49 offen lds
    v_mfma_f32_32x32x16_bf16 v[80:95], a[176:179], v[32:35], v[80:95]
    s_waitcnt lgkmcnt(4)
    ds_read_b64_tr_b16 v[32:33], v8 offset:28672
    ds_read_b64_tr_b16 v[34:35], v8 offset:29184
    v_mfma_f32_32x32x16_bf16 v[96:111], a[48:51], v[36:39], v[96:111]
    v_mfma_f32_32x32x16_bf16 v[112:127], a[176:179], v[36:39], v[112:127]
    s_waitcnt lgkmcnt(4)
    ds_read_b64_tr_b16 v[36:37], v9 offset:28672
    ds_read_b64_tr_b16 v[38:39], v9 offset:29184
    s_add_u32 m0, s40, 6144
    s_nop 0
    buffer_load_dwordx4 v14, s[64:67], s50 offen lds
    v_mfma_f32_32x32x16_bf16 v[64:79], a[52:55], v[40:43], v[64:79]
    v_mfma_f32_32x32x16_bf16 v[80:95], a[180:183], v[40:43], v[80:95]
    s_waitcnt lgkmcnt(4)
    ds_read_b64_tr_b16 v[40:41], v8 offset:30720
    ds_read_b64_tr_b16 v[42:43], v8 offset:31232
    v_mfma_f32_32x32x16_bf16 v[96:111], a[52:55], v[44:47], v[96:111]
    s_add_u32 m0, s40, 7168
    s_nop 0
    buffer_load_dwordx4 v14, s[64:67], s51 offen lds
    v_mfma_f32_32x32x16_bf16 v[112:127], a[180:183], v[44:47], v[112:127]
    s_waitcnt lgkmcnt(4)
    ds_read_b64_tr_b16 v[44:45], v9 offset:30720
    ds_read_b64_tr_b16 v[46:47], v9 offset:31232
    v_mfma_f32_32x32x16_bf16 v[64:79], a[56:59], v[32:35], v[64:79]
    v_mfma_f32_32x32x16_bf16 v[80:95], a[184:187], v[32:35], v[80:95]
    s_waitcnt lgkmcnt(4)
    ds_read_b64_tr_b16 v[32:33], v10 offset:0
    ds_read_b64_tr_b16 v[34:35], v10 offset:512
    v_add_u32 v14, 4292870016, v14
    s_add_u32 s41, s41, 32768
    s_and_b32 s41, s41, 0x1ffff
    s_add_u32 s40, s41, s42
    v_mfma_f32_32x32x16_bf16 v[96:111], a[56:59], v[36:39], v[96:111]
    v_mfma_f32_32x32x16_bf16 v[112:127], a[184:187], v[36:39], v[112:127]
    s_waitcnt lgkmcnt(4)
    ds_read_b64_tr_b16 v[36:37], v11 offset:0
    ds_read_b64_tr_b16 v[38:39], v11 offset:512
    v_mfma_f32_32x32x16_bf16 v[64:79], a[60:63], v[40:43], v[64:79]
    v_mfma_f32_32x32x16_bf16 v[80:95], a[188:191], v[40:43], v[80:95]
    s_waitcnt lgkmcnt(4)
    ds_read_b64_tr_b16 v[40:41], v10 offset:2048
    ds_read_b64_tr_b16 v[42:43], v10 offset:2560
    v_mfma_f32_32x32x16_bf16 v[96:111], a[60:63], v[44:47], v[96:111]
    v_mfma_f32_32x32x16_bf16 v[112:127], a[188:191], v[44:47], v[112:127]
    v_mov_b32 v8, v10
    v_mov_b32 v9, v11
    s_add_u32 s43, s43, 32768
    s_and_b32 s43, s43, 0x1ffff
    v_add_u32 v10, s43, v12
    v_add_u32 v11, s43, v13
    s_waitcnt lgkmcnt(4)
    ds_read_b64_tr_b16 v[44:45], v9 offset:2048
    ds_read_b64_tr_b16 v[46:47], v9 offset:2560
    v_mfma_f32_32x32x16_bf16 v[64:79], a[64:67], v[32:35], v[64:79]
    v_mfma_f32_32x32x16_bf16 v[80:95], a[192:195], v[32:35], v[80:95]
    s_waitcnt lgkmcnt(4)
    ds_read_b64_tr_b16 v[32:33], v8 offset:4096
    ds_read_b64_tr_b16 v[34:35], v8 offset:4608
    v_mfma_f32_32x32x16_bf16 v[96:111], a[64:67], v[36:39], v[96:111]
    v_mfma_f32_32x32x16_bf16 v[112:127], a[192:195], v[36:39], v[112:127]
    s_waitcnt lgkmcnt(4)
    ds_read_b64_tr_b16 v[36:37], v9 offset:4096
    ds_read_b64_tr_b16 v[38:39], v9 offset:4608
    v_mfma_f32_32x32x16_bf16 v[64:79], a[68:71], v[40:43], v[64:79]
    v_mfma_f32_32x32x16_bf16 v[80:95], a[196:199], v[40:43], v[80:95]
    s_waitcnt lgkmcnt(4)
    ds_read_b64_tr_b16 v[40:41], v8 offset:6144
    ds_read_b64_tr_b16 v[42:43], v8 offset:6656
    v_mfma_f32_32x32x16_bf16 v[96:111], a[68:71], v[44:47], v[96:111]
    v_mfma_f32_32x32x16_bf16 v[112:127], a[196:199], v[44:47], v[112:127]
    s_waitcnt lgkmcnt(4)
    ds_read_b64_tr_b16 v[44:45], v9 offset:6144
    ds_read_b64_tr_b16 v[46:47], v9 offset:6656
    v_mfma_f32_32x32x16_bf16 v[64:79], a[72:75], v[32:35], v[64:79]
    v_mfma_f32_32x32x16_bf16 v[80:95], a[200:203], v[32:35], v[80:95]
    s_waitcnt lgkmcnt(4)
    ds_read_b64_tr_b16 v[32:33], v8 offset:8192
    ds_read_b64_tr_b16 v[34:35], v8 offset:8704
    v_mfma_f32_32x32x16_bf16 v[96:111], a[72:75], v[36:39], v[96:111]
    v_mfma_f32_32x32x16_bf16 v[112:127], a[200:203], v[36:39], v[112:127]
    s_waitcnt lgkmcnt(4)
    ds_read_b64_tr_b16 v[36:37], v9 offset:8192
    ds_read_b64_tr_b16 v[38:39], v9 offset:8704
    v_mfma_f32_32x32x16_bf16 v[64:79], a[76:79], v[40:43], v[64:79]
    v_mfma_f32_32x32x16_bf16 v[80:95], a[204:207], v[40:43], v[80:95]
    s_waitcnt lgkmcnt(4)
    ds_read_b64_tr_b16 v[40:41], v8 offset:10240
    ds_read_b64_tr_b16 v[42:43], v8 offset:10752
    v_mfma_f32_32x32x16_bf16 v[96:111], a[76:79], v[44:47], v[96:111]
    v_mfma_f32_32x32x16_bf16 v[112:127], a[204:207], v[44:47], v[112:127]
    s_waitcnt lgkmcnt(4)
    ds_read_b64_tr_b16 v[44:45], v9 offset:10240
    ds_read_b64_tr_b16 v[46:47], v9 offset:10752
    v_mfma_f32_32x32x16_bf16 v[64:79], a[80:83], v[32:35], v[64:79]
    v_mfma_f32_32x32x16_bf16 v[80:95], a[208:211], v[32:35], v[80:95]
    s_waitcnt lgkmcnt(4)
    ds_read_b64_tr_b16 v[32:33], v8 offset:12288
    ds_read_b64_tr_b16 v[34:35], v8 offset:12800
    v_mfma_f32_32x32x16_bf16 v[96:111], a[80:83], v[36:39], v[96:111]
    v_mfma_f32_32x32x16_bf16 v[112:127], a[208:211], v[36:39], v[112:127]
    s_waitcnt lgkmcnt(4)
    ds_read_b64_tr_b16 v[36:37], v9 offset:12288
    ds_read_b64_tr_b16 v[38:39], v9 offset:12800
    v_mfma_f32_32x32x16_bf16 v[64:79], a[84:87], v[40:43], v[64:79]
    v_mfma_f32_32x32x16_bf16 v[80:95], a[212:215], v[40:43], v[80:95]
    s_waitcnt lgkmcnt(4)
    ds_read_b64_tr_b16 v[40:41], v8 offset:14336
    ds_read_b64_tr_b16 v[42:43], v8 offset:14848
    v_mfma_f32_32x32x16_bf16 v[96:111], a[84:87], v[44:47], v[96:111]
    v_mfma_f32_32x32x16_bf16 v[112:127], a[212:215], v[44:47], v[112:127]
    s_waitcnt lgkmcnt(4)
    ds_read_b64_tr_b16 v[44:45], v9 offset:14336
    ds_read_b64_tr_b16 v[46:47], v9 offset:14848
    v_mfma_f32_32x32x16_bf16 v[64:79], a[88:91], v[32:35], v[64:79]
    v_mfma_f32_32x32x16_bf16 v[80:95], a[216:219], v[32:35], v[80:95]
    s_waitcnt lgkmcnt(4)
    ds_read_b64_tr_b16 v[32:33], v8 offset:16384
    ds_read_b64_tr_b16 v[34:35], v8 offset:16896
    v_mfma_f32_32x32x16_bf16 v[96:111], a[88:91], v[36:39], v[96:111]
    v_mfma_f32_32x32x16_bf16 v[112:127], a[216:219], v[36:39], v[112:127]
    s_waitcnt lgkmcnt(4)
    ds_read_b64_tr_b16 v[36:37], v9 offset:16384
    ds_read_b64_tr_b16 v[38:39], v9 offset:16896
    v_mfma_f32_32x32x16_bf16 v[64:79], a[92:95], v[40:43], v[64:79]
    v_mfma_f32_32x32x16_bf16 v[80:95], a[220:223], v[40:43], v[80:95]
    s_waitcnt lgkmcnt(4)
    ds_read_b64_tr_b16 v[40:41], v8 offset:18432
    ds_read_b64_tr_b16 v[42:43], v8 offset:18944
    v_mfma_f32_32x32x16_bf16 v[96:111], a[92:95], v[44:47], v[96:111]
    v_mfma_f32_32x32x16_bf16 v[112:127], a[220:223], v[44:47], v[112:127]
    s_waitcnt vmcnt(16)
    s_barrier
    s_waitcnt lgkmcnt(4)
    ds_read_b64_tr_b16 v[44:45], v9 offset:18432
    ds_read_b64_tr_b16 v[46:47], v9 offset:18944
    v_mfma_f32_32x32x16_bf16 v[64:79], a[96:99], v[32:35], v[64:79]
    v_mfma_f32_32x32x16_bf16 v[80:95], a[224:227], v[32:35], v[80:95]
    s_waitcnt lgkmcnt(4)
    ds_read_b64_tr_b16 v[32:33], v8 offset:20480
    ds_read_b64_tr_b16 v[34:35], v8 offset:20992
    s_add_u32 m0, s40, 0
    s_nop 0
    buffer_load_dwordx4 v14, s[68:71], s44 offen lds
    v_mfma_f32_32x32x16_bf16 v[96:111], a[96:99], v[36:39], v[96:111]
    v_mfma_f32_32x32x16_bf16 v[112:127], a[224:227], v[36:39], v[112:127]
    s_waitcnt lgkmcnt(4)
    ds_read_b64_tr_b16 v[36:37], v9 offset:20480
    ds_read_b64_tr_b16 v[38:39], v9 offset:20992
    v_mfma_f32_32x32x16_bf16 v[64:79], a[100:103], v[40:43], v[64:79]
    s_add_u32 m0, s40, 1024
    s_nop 0
    buffer_load_dwordx4 v14, s[68:71], s45 offen lds
    v_mfma_f32_32x32x16_bf16 v[80:95], a[228:231], v[40:43], v[80:95]
    s_waitcnt lgkmcnt(4)
    ds_read_b64_tr_b16 v[40:41], v8 offset:22528
    ds_read_b64_tr_b16 v[42:43], v8 offset:23040
    v_mfma_f32_32x32x16_bf16 v[96:111], a[100:103], v[44:47], v[96:111]
    v_mfma_f32_32x32x16_bf16 v[112:127], a[228:231], v[44:47], v[112:127]
    s_waitcnt lgkmcnt(4)
    ds_read_b64_tr_b16 v[44:45], v9 offset:22528
    ds_read_b64_tr_b16 v[46:47], v9 offset:23040
    s_lshl_b32 s33, s59, 2
    v_mov_b32 v26, s33
    buffer_load_dword v25, v26, s[52:55], 0 offen sc1
    s_add_u32 m0, s40, 2048
    s_nop 0
    buffer_load_dwordx4 v14, s[68:71], s46 offen lds
    v_mfma_f32_32x32x16_bf16 v[64:79], a[104:107], v[32:35], v[64:79]
    v_mfma_f32_32x32x16_bf16 v[80:95], a[232:235], v[32:35], v[80:95]
    s_waitcnt lgkmcnt(4)
    ds_read_b64_tr_b16 v[32:33], v8 offset:24576
    ds_read_b64_tr_b16 v[34:35], v8 offset:25088
    v_mfma_f32_32x32x16_bf16 v[96:111], a[104:107], v[36:39], v[96:111]
    s_add_u32 m0, s40, 3072
    s_nop 0
    buffer_load_dwordx4 v14, s[68:71], s47 offen lds
    v_mfma_f32_32x32x16_bf16 v[112:127], a[232:235], v[36:39], v[112:127]
    s_waitcnt lgkmcnt(4)
    ds_read_b64_tr_b16 v[36:37], v9 offset:24576
    ds_read_b64_tr_b16 v[38:39], v9 offset:25088
    v_mfma_f32_32x32x16_bf16 v[64:79], a[108:111], v[40:43], v[64:79]
    v_mfma_f32_32x32x16_bf16 v[80:95], a[236:239], v[40:43], v[80:95]
    s_waitcnt lgkmcnt(4)
    ds_read_b64_tr_b16 v[40:41], v8 offset:26624
    ds_read_b64_tr_b16 v[42:43], v8 offset:27136
    s_add_u32 m0, s40, 4096
    s_nop 0
    buffer_load_dwordx4 v14, s[68:71], s48 offen lds
    v_mfma_f32_32x32x16_bf16 v[96:111], a[108:111], v[44:47], v[96:111]
    v_mfma_f32_32x32x16_bf16 v[112:127], a[236:239], v[44:47], v[112:127]
    s_waitcnt lgkmcnt(4)
    ds_read_b64_tr_b16 v[44:45], v9 offset:26624
    ds_read_b64_tr_b16 v[46:47], v9 offset:27136
    v_mfma_f32_32x32x16_bf16 v[64:79], a[112:115], v[32:35], v[64:79]
    s_add_u32 m0, s40, 5120
    s_nop 0
    buffer_load_dwordx4 v14, s[68:71], s49 offen lds
    v_mfma_f32_32x32x16_bf16 v[80:95], a[240:243], v[32:35], v[80:95]
    s_waitcnt lgkmcnt(4)
    ds_read_b64_tr_b16 v[32:33], v8 offset:28672
    ds_read_b64_tr_b16 v[34:35], v8 offset:29184
    v_mfma_f32_32x32x16_bf16 v[96:111], a[112:115], v[36:39], v[96:111]
    v_mfma_f32_32x32x16_bf16 v[112:127], a[240:243], v[36:39], v[112:127]
    s_waitcnt lgkmcnt(4)
    ds_read_b64_tr_b16 v[36:37], v9 offset:28672
    ds_read_b64_tr_b16 v[38:39], v9 offset:29184
    s_add_u32 m0, s40, 6144
    s_nop 0
    buffer_load_dwordx4 v14, s[68:71], s50 offen lds
    v_mfma_f32_32x32x16_bf16 v[64:79], a[116:119], v[40:43], v[64:79]
    v_mfma_f32_32x32x16_bf16 v[80:95], a[244:247], v[40:43], v[80:95]
    s_waitcnt lgkmcnt(4)
    ds_read_b64_tr_b16 v[40:41], v8 offset:30720
    ds_read_b64_tr_b16 v[42:43], v8 offset:31232
    v_mfma_f32_32x32x16_bf16 v[96:111], a[116:119], v[44:47], v[96:111]
    s_add_u32 m0, s40, 7168
    s_nop 0
    buffer_load_dwordx4 v14, s[68:71], s51 offen lds
    v_mfma_f32_32x32x16_bf16 v[112:127], a[244:247], v[44:47], v[112:127]
    s_waitcnt lgkmcnt(4)
    ds_read_b64_tr_b16 v[44:45], v9 offset:30720
    ds_read_b64_tr_b16 v[46:47], v9 offset:31232
    v_mfma_f32_32x32x16_bf16 v[64:79], a[120:123], v[32:35], v[64:79]
    v_mfma_f32_32x32x16_bf16 v[80:95], a[248:251], v[32:35], v[80:95]
    s_waitcnt lgkmcnt(4)
    ds_read_b64_tr_b16 v[32:33], v10 offset:0
    ds_read_b64_tr_b16 v[34:35], v10 offset:512
    v_add_u32 v14, 2097152, v14
    s_add_u32 s41, s41, 32768
    s_and_b32 s41, s41, 0x1ffff
    s_add_u32 s40, s41, s42
    v_mfma_f32_32x32x16_bf16 v[96:111], a[120:123], v[36:39], v[96:111]
    v_mfma_f32_32x32x16_bf16 v[112:127], a[248:251], v[36:39], v[112:127]
    s_waitcnt lgkmcnt(4)
    ds_read_b64_tr_b16 v[36:37], v11 offset:0
    ds_read_b64_tr_b16 v[38:39], v11 offset:512
    v_mfma_f32_32x32x16_bf16 v[64:79], a[124:127], v[40:43], v[64:79]
    v_mfma_f32_32x32x16_bf16 v[80:95], a[252:255], v[40:43], v[80:95]
    s_waitcnt lgkmcnt(4)
    ds_read_b64_tr_b16 v[40:41], v10 offset:2048
    ds_read_b64_tr_b16 v[42:43], v10 offset:2560
    v_mfma_f32_32x32x16_bf16 v[96:111], a[124:127], v[44:47], v[96:111]
    v_mfma_f32_32x32x16_bf16 v[112:127], a[252:255], v[44:47], v[112:127]
    v_mov_b32 v8, v10
    v_mov_b32 v9, v11
    s_add_u32 s43, s43, 32768
    s_and_b32 s43, s43, 0x1ffff
    v_add_u32 v10, s43, v12
    v_add_u32 v11, s43, v13
    s_waitcnt lgkmcnt(4)
    ds_read_b64_tr_b16 v[44:45], v9 offset:2048
    ds_read_b64_tr_b16 v[46:47], v9 offset:2560
    v_mfma_f32_32x32x16_bf16 v[128:143], a[0:3], v[32:35], 0
    v_mfma_f32_32x32x16_bf16 v[144:159], a[128:131], v[32:35], 0
    s_waitcnt lgkmcnt(4)
    ds_read_b64_tr_b16 v[32:33], v8 offset:4096
    ds_read_b64_tr_b16 v[34:35], v8 offset:4608
    v_mfma_f32_32x32x16_bf16 v[160:175], a[0:3], v[36:39], 0
    v_cvt_pk_bf16_f32 v48, v64, v65
    v_cvt_pk_bf16_f32 v49, v66, v67
    v_mfma_f32_32x32x16_bf16 v[176:191], a[128:131], v[36:39], 0
    s_waitcnt lgkmcnt(4)
    ds_read_b64_tr_b16 v[36:37], v9 offset:4096
    ds_read_b64_tr_b16 v[38:39], v9 offset:4608
    v_cvt_pk_bf16_f32 v50, v68, v69
    v_mfma_f32_32x32x16_bf16 v[128:143], a[4:7], v[40:43], v[128:143]
    v_cvt_pk_bf16_f32 v51, v70, v71
    v_cvt_pk_bf16_f32 v52, v72, v73
    v_mfma_f32_32x32x16_bf16 v[144:159], a[132:135], v[40:43], v[144:159]
    s_waitcnt lgkmcnt(4)
    ds_read_b64_tr_b16 v[40:41], v8 offset:6144
    ds_read_b64_tr_b16 v[42:43], v8 offset:6656
    v_cvt_pk_bf16_f32 v53, v74, v75
    v_mfma_f32_32x32x16_bf16 v[160:175], a[4:7], v[44:47], v[160:175]
    v_cvt_pk_bf16_f32 v54, v76, v77
    v_cvt_pk_bf16_f32 v55, v78, v79
    v_mfma_f32_32x32x16_bf16 v[176:191], a[132:135], v[44:47], v[176:191]
    s_waitcnt lgkmcnt(4)
    ds_read_b64_tr_b16 v[44:45], v9 offset:6144
    ds_read_b64_tr_b16 v[46:47], v9 offset:6656
    buffer_store_dwordx4 v[48:51], v20, s[72:75], s60 offen offset:0
    v_mfma_f32_32x32x16_bf16 v[128:143], a[8:11], v[32:35], v[128:143]
    buffer_store_dwordx4 v[52:55], v21, s[72:75], s60 offen offset:0
    v_mfma_f32_32x32x16_bf16 v[144:159], a[136:139], v[32:35], v[144:159]
    s_waitcnt lgkmcnt(4)
    ds_read_b64_tr_b16 v[32:33], v8 offset:8192
    ds_read_b64_tr_b16 v[34:35], v8 offset:8704
    v_cvt_pk_bf16_f32 v56, v80, v81
    v_cvt_pk_bf16_f32 v57, v82, v83
    v_mfma_f32_32x32x16_bf16 v[160:175], a[8:11], v[36:39], v[160:175]
    v_cvt_pk_bf16_f32 v58, v84, v85
    v_mfma_f32_32x32x16_bf16 v[176:191], a[136:139], v[36:39], v[176:191]
    s_waitcnt lgkmcnt(4)
    ds_read_b64_tr_b16 v[36:37], v9 offset:8192
    ds_read_b64_tr_b16 v[38:39], v9 offset:8704
    v_cvt_pk_bf16_f32 v59, v86, v87
    v_cvt_pk_bf16_f32 v60, v88, v89
    v_mfma_f32_32x32x16_bf16 v[128:143], a[12:15], v[40:43], v[128:143]
    v_cvt_pk_bf16_f32 v61, v90, v91
    v_mfma_f32_32x32x16_bf16 v[144:159], a[140:143], v[40:43], v[144:159]
    s_waitcnt lgkmcnt(4)
    ds_read_b64_tr_b16 v[40:41], v8 offset:10240
    ds_read_b64_tr_b16 v[42:43], v8 offset:10752
    v_cvt_pk_bf16_f32 v62, v92, v93
    v_cvt_pk_bf16_f32 v63, v94, v95
    v_mfma_f32_32x32x16_bf16 v[160:175], a[12:15], v[44:47], v[160:175]
    buffer_store_dwordx4 v[56:59], v22, s[72:75], s60 offen offset:0
    v_mfma_f32_32x32x16_bf16 v[176:191], a[140:143], v[44:47], v[176:191]
    s_waitcnt lgkmcnt(4)
    ds_read_b64_tr_b16 v[44:45], v9 offset:10240
    ds_read_b64_tr_b16 v[46:47], v9 offset:10752
    buffer_store_dwordx4 v[60:63], v23, s[72:75], s60 offen offset:0
    v_mfma_f32_32x32x16_bf16 v[128:143], a[16:19], v[32:35], v[128:143]
    v_cvt_pk_bf16_f32 v48, v96, v97
    v_cvt_pk_bf16_f32 v49, v98, v99
    v_mfma_f32_32x32x16_bf16 v[144:159], a[144:147], v[32:35], v[144:159]
    s_waitcnt lgkmcnt(4)
    ds_read_b64_tr_b16 v[32:33], v8 offset:12288
    ds_read_b64_tr_b16 v[34:35], v8 offset:12800
    v_cvt_pk_bf16_f32 v50, v100, v101
    v_mfma_f32_32x32x16_bf16 v[160:175], a[16:19], v[36:39], v[160:175]
    v_cvt_pk_bf16_f32 v51, v102, v103
    v_cvt_pk_bf16_f32 v52, v104, v105
    v_mfma_f32_32x32x16_bf16 v[176:191], a[144:147], v[36:39], v[176:191]
    s_waitcnt lgkmcnt(4)
    ds_read_b64_tr_b16 v[36:37], v9 offset:12288
    ds_read_b64_tr_b16 v[38:39], v9 offset:12800
    v_cvt_pk_bf16_f32 v53, v106, v107
    v_mfma_f32_32x32x16_bf16 v[128:143], a[20:23], v[40:43], v[128:143]
    v_cvt_pk_bf16_f32 v54, v108, v109
    v_cvt_pk_bf16_f32 v55, v110, v111
    v_mfma_f32_32x32x16_bf16 v[144:159], a[148:151], v[40:43], v[144:159]
    s_waitcnt lgkmcnt(4)
    ds_read_b64_tr_b16 v[40:41], v8 offset:14336
    ds_read_b64_tr_b16 v[42:43], v8 offset:14848
    buffer_store_dwordx4 v[48:51], v20, s[72:75], s60 offen offset:512
    v_mfma_f32_32x32x16_bf16 v[160:175], a[20:23], v[44:47], v[160:175]
    buffer_store_dwordx4 v[52:55], v21, s[72:75], s60 offen offset:512
    v_mfma_f32_32x32x16_bf16 v[176:191], a[148:151], v[44:47], v[176:191]
    s_waitcnt lgkmcnt(4)
    ds_read_b64_tr_b16 v[44:45], v9 offset:14336
    ds_read_b64_tr_b16 v[46:47], v9 offset:14848
    v_cvt_pk_bf16_f32 v56, v112, v113
    v_cvt_pk_bf16_f32 v57, v114, v115
    v_mfma_f32_32x32x16_bf16 v[128:143], a[24:27], v[32:35], v[128:143]
    v_cvt_pk_bf16_f32 v58, v116, v117
    v_mfma_f32_32x32x16_bf16 v[144:159], a[152:155], v[32:35], v[144:159]
    s_waitcnt lgkmcnt(4)
    ds_read_b64_tr_b16 v[32:33], v8 offset:16384
    ds_read_b64_tr_b16 v[34:35], v8 offset:16896
    v_cvt_pk_bf16_f32 v59, v118, v119
    v_cvt_pk_bf16_f32 v60, v120, v121
    v_mfma_f32_32x32x16_bf16 v[160:175], a[24:27], v[36:39], v[160:175]
    v_cvt_pk_bf16_f32 v61, v122, v123
    v_mfma_f32_32x32x16_bf16 v[176:191], a[152:155], v[36:39], v[176:191]
    s_waitcnt lgkmcnt(4)
    ds_read_b64_tr_b16 v[36:37], v9 offset:16384
    ds_read_b64_tr_b16 v[38:39], v9 offset:16896
    v_cvt_pk_bf16_f32 v62, v124, v125
    v_cvt_pk_bf16_f32 v63, v126, v127
    v_mfma_f32_32x32x16_bf16 v[128:143], a[28:31], v[40:43], v[128:143]
    buffer_store_dwordx4 v[56:59], v22, s[72:75], s60 offen offset:512
    v_mfma_f32_32x32x16_bf16 v[144:159], a[156:159], v[40:43], v[144:159]
    s_waitcnt lgkmcnt(4)
    ds_read_b64_tr_b16 v[40:41], v8 offset:18432
    ds_read_b64_tr_b16 v[42:43], v8 offset:18944
    buffer_store_dwordx4 v[60:63], v23, s[72:75], s60 offen offset:512
    v_mfma_f32_32x32x16_bf16 v[160:175], a[28:31], v[44:47], v[160:175]
    v_mfma_f32_32x32x16_bf16 v[176:191], a[156:159], v[44:47], v[176:191]
    s_waitcnt vmcnt(17)
    s_barrier
    s_waitcnt lgkmcnt(4)
    ds_read_b64_tr_b16 v[44:45], v9 offset:18432
    ds_read_b64_tr_b16 v[46:47], v9 offset:18944
    v_mfma_f32_32x32x16_bf16 v[128:143], a[32:35], v[32:35], v[128:143]
    v_mfma_f32_32x32x16_bf16 v[144:159], a[160:163], v[32:35], v[144:159]
    s_waitcnt lgkmcnt(4)
    ds_read_b64_tr_b16 v[32:33], v8 offset:20480
    ds_read_b64_tr_b16 v[34:35], v8 offset:20992
    s_add_u32 m0, s40, 0
    s_nop 0
    buffer_load_dwordx4 v14, s[68:71], s44 offen lds
    v_mfma_f32_32x32x16_bf16 v[160:175], a[32:35], v[36:39], v[160:175]
    v_mfma_f32_32x32x16_bf16 v[176:191], a[160:163], v[36:39], v[176:191]
    s_waitcnt lgkmcnt(4)
    ds_read_b64_tr_b16 v[36:37], v9 offset:20480
    ds_read_b64_tr_b16 v[38:39], v9 offset:20992
    v_mfma_f32_32x32x16_bf16 v[128:143], a[36:39], v[40:43], v[128:143]
    s_add_u32 m0, s40, 1024
    s_nop 0
    buffer_load_dwordx4 v14, s[68:71], s45 offen lds
    v_mfma_f32_32x32x16_bf16 v[144:159], a[164:167], v[40:43], v[144:159]
    s_waitcnt lgkmcnt(4)
    ds_read_b64_tr_b16 v[40:41], v8 offset:22528
    ds_read_b64_tr_b16 v[42:43], v8 offset:23040
    v_mfma_f32_32x32x16_bf16 v[160:175], a[36:39], v[44:47], v[160:175]
    v_mfma_f32_32x32x16_bf16 v[176:191], a[164:167], v[44:47], v[176:191]
    s_waitcnt lgkmcnt(4)
    ds_read_b64_tr_b16 v[44:45], v9 offset:22528
    ds_read_b64_tr_b16 v[46:47], v9 offset:23040
    s_add_u32 m0, s40, 2048
    s_nop 0
    buffer_load_dwordx4 v14, s[68:71], s46 offen lds
    v_mfma_f32_32x32x16_bf16 v[128:143], a[40:43], v[32:35], v[128:143]
    v_mfma_f32_32x32x16_bf16 v[144:159], a[168:171], v[32:35], v[144:159]
    s_waitcnt lgkmcnt(4)
    ds_read_b64_tr_b16 v[32:33], v8 offset:24576
    ds_read_b64_tr_b16 v[34:35], v8 offset:25088
    v_mfma_f32_32x32x16_bf16 v[160:175], a[40:43], v[36:39], v[160:175]
    s_add_u32 m0, s40, 3072
    s_nop 0
    buffer_load_dwordx4 v14, s[68:71], s47 offen lds
    v_mfma_f32_32x32x16_bf16 v[176:191], a[168:171], v[36:39], v[176:191]
    s_waitcnt lgkmcnt(4)
    ds_read_b64_tr_b16 v[36:37], v9 offset:24576
    ds_read_b64_tr_b16 v[38:39], v9 offset:25088
    v_mfma_f32_32x32x16_bf16 v[128:143], a[44:47], v[40:43], v[128:143]
    v_mfma_f32_32x32x16_bf16 v[144:159], a[172:175], v[40:43], v[144:159]
    s_waitcnt lgkmcnt(4)
    ds_read_b64_tr_b16 v[40:41], v8 offset:26624
    ds_read_b64_tr_b16 v[42:43], v8 offset:27136
    s_add_u32 m0, s40, 4096
    s_nop 0
    buffer_load_dwordx4 v14, s[68:71], s48 offen lds
    v_mfma_f32_32x32x16_bf16 v[160:175], a[44:47], v[44:47], v[160:175]
    v_mfma_f32_32x32x16_bf16 v[176:191], a[172:175], v[44:47], v[176:191]
    s_waitcnt lgkmcnt(4)
    ds_read_b64_tr_b16 v[44:45], v9 offset:26624
    ds_read_b64_tr_b16 v[46:47], v9 offset:27136
    v_mfma_f32_32x32x16_bf16 v[128:143], a[48:51], v[32:35], v[128:143]
    s_add_u32 m0, s40, 5120
    s_nop 0
    buffer_load_dwordx4 v14, s[68:71], s49 offen lds
    v_mfma_f32_32x32x16_bf16 v[144:159], a[176:179], v[32:35], v[144:159]
    s_waitcnt lgkmcnt(4)
    ds_read_b64_tr_b16 v[32:33], v8 offset:28672
    ds_read_b64_tr_b16 v[34:35], v8 offset:29184
    v_mfma_f32_32x32x16_bf16 v[160:175], a[48:51], v[36:39], v[160:175]
    v_mfma_f32_32x32x16_bf16 v[176:191], a[176:179], v[36:39], v[176:191]
    s_waitcnt lgkmcnt(4)
    ds_read_b64_tr_b16 v[36:37], v9 offset:28672
    ds_read_b64_tr_b16 v[38:39], v9 offset:29184
    s_add_u32 m0, s40, 6144
    s_nop 0
    buffer_load_dwordx4 v14, s[68:71], s50 offen lds
    v_mfma_f32_32x32x16_bf16 v[128:143], a[52:55], v[40:43], v[128:143]
    v_mfma_f32_32x32x16_bf16 v[144:159], a[180:183], v[40:43], v[144:159]
    s_waitcnt lgkmcnt(4)
    ds_read_b64_tr_b16 v[40:41], v8 offset:30720
    ds_read_b64_tr_b16 v[42:43], v8 offset:31232
    v_mfma_f32_32x32x16_bf16 v[160:175], a[52:55], v[44:47], v[160:175]
    s_add_u32 m0, s40, 7168
    s_nop 0
    buffer_load_dwordx4 v14, s[68:71], s51 offen lds
    v_mfma_f32_32x32x16_bf16 v[176:191], a[180:183], v[44:47], v[176:191]
    s_waitcnt lgkmcnt(4)
    ds_read_b64_tr_b16 v[44:45], v9 offset:30720
    ds_read_b64_tr_b16 v[46:47], v9 offset:31232
    v_mfma_f32_32x32x16_bf16 v[128:143], a[56:59], v[32:35], v[128:143]
    v_mfma_f32_32x32x16_bf16 v[144:159], a[184:187], v[32:35], v[144:159]
    s_waitcnt lgkmcnt(4)
    ds_read_b64_tr_b16 v[32:33], v10 offset:0
    ds_read_b64_tr_b16 v[34:35], v10 offset:512
    v_add_u32 v14, 4292870272, v14
    s_add_u32 s41, s41, 32768
    s_and_b32 s41, s41, 0x1ffff
    s_add_u32 s40, s41, s42
    v_mfma_f32_32x32x16_bf16 v[160:175], a[56:59], v[36:39], v[160:175]
    v_mfma_f32_32x32x16_bf16 v[176:191], a[184:187], v[36:39], v[176:191]
    s_waitcnt lgkmcnt(4)
    ds_read_b64_tr_b16 v[36:37], v11 offset:0
    ds_read_b64_tr_b16 v[38:39], v11 offset:512
    v_mfma_f32_32x32x16_bf16 v[128:143], a[60:63], v[40:43], v[128:143]
    v_mfma_f32_32x32x16_bf16 v[144:159], a[188:191], v[40:43], v[144:159]
    s_waitcnt lgkmcnt(4)
    ds_read_b64_tr_b16 v[40:41], v10 offset:2048
    ds_read_b64_tr_b16 v[42:43], v10 offset:2560
    v_mfma_f32_32x32x16_bf16 v[160:175], a[60:63], v[44:47], v[160:175]
    v_mfma_f32_32x32x16_bf16 v[176:191], a[188:191], v[44:47], v[176:191]
    v_mov_b32 v8, v10
    v_mov_b32 v9, v11
    s_add_u32 s43, s43, 32768
    s_and_b32 s43, s43, 0x1ffff
    v_add_u32 v10, s43, v12
    v_add_u32 v11, s43, v13
    s_waitcnt lgkmcnt(4)
    ds_read_b64_tr_b16 v[44:45], v9 offset:2048
    ds_read_b64_tr_b16 v[46:47], v9 offset:2560
    v_mfma_f32_32x32x16_bf16 v[128:143], a[64:67], v[32:35], v[128:143]
    v_mfma_f32_32x32x16_bf16 v[144:159], a[192:195], v[32:35], v[144:159]
    s_waitcnt lgkmcnt(4)
    ds_read_b64_tr_b16 v[32:33], v8 offset:4096
    ds_read_b64_tr_b16 v[34:35], v8 offset:4608
    s_waitcnt vmcnt(22)
    v_readfirstlane_b32 s33, v25
    s_nop 0
    s_cmp_ge_u32 s33, 32
    s_cbranch_scc1 L_pollok1
    s_mov_b32 s34, 0
L_poll1:
    buffer_load_dword v25, v26, s[52:55], 0 offen sc1
    s_waitcnt vmcnt(0)
    v_readfirstlane_b32 s33, v25
    s_nop 0
    s_cmp_ge_u32 s33, 32
    s_cbranch_scc1 L_pollok1
    s_sleep 2
    s_add_u32 s34, s34, 1
    s_cmp_lt_u32 s34, 0x40000
    s_cbranch_scc1 L_poll1
L_pollok1:
    v_mfma_f32_32x32x16_bf16 v[160:175], a[64:67], v[36:39], v[160:175]
    v_mfma_f32_32x32x16_bf16 v[176:191], a[192:195], v[36:39], v[176:191]
    s_waitcnt lgkmcnt(4)
    ds_read_b64_tr_b16 v[36:37], v9 offset:4096
    ds_read_b64_tr_b16 v[38:39], v9 offset:4608
    s_mov_b32 s30, 0
    buffer_load_dwordx4 a[0:3], v19, s[80:83], s30 offen offset:0 sc1
    buffer_load_dwordx4 a[128:131], v19, s[80:83], s30 offen offset:512 sc1
    v_mfma_f32_32x32x16_bf16 v[128:143], a[68:71], v[40:43], v[128:143]
    v_mfma_f32_32x32x16_bf16 v[144:159], a[196:199], v[40:43], v[144:159]
    s_waitcnt lgkmcnt(4)
    ds_read_b64_tr_b16 v[40:41], v8 offset:6144
    ds_read_b64_tr_b16 v[42:43], v8 offset:6656
    v_mfma_f32_32x32x16_bf16 v[160:175], a[68:71], v[44:47], v[160:175]
    v_mfma_f32_32x32x16_bf16 v[176:191], a[196:199], v[44:47], v[176:191]
    s_waitcnt lgkmcnt(4)
    ds_read_b64_tr_b16 v[44:45], v9 offset:6144
    ds_read_b64_tr_b16 v[46:47], v9 offset:6656
    v_mfma_f32_32x32x16_bf16 v[128:143], a[72:75], v[32:35], v[128:143]
    v_mfma_f32_32x32x16_bf16 v[144:159], a[200:203], v[32:35], v[144:159]
    s_waitcnt lgkmcnt(4)
    ds_read_b64_tr_b16 v[32:33], v8 offset:8192
    ds_read_b64_tr_b16 v[34:35], v8 offset:8704
    v_mfma_f32_32x32x16_bf16 v[160:175], a[72:75], v[36:39], v[160:175]
    s_mov_b32 s30, 65536
    buffer_load_dwordx4 a[4:7], v19, s[80:83], s30 offen offset:0 sc1
    buffer_load_dwordx4 a[132:135], v19, s[80:83], s30 offen offset:512 sc1
    v_mfma_f32_32x32x16_bf16 v[176:191], a[200:203], v[36:39], v[176:191]
    s_waitcnt lgkmcnt(4)
    ds_read_b64_tr_b16 v[36:37], v9 offset:8192
    ds_read_b64_tr_b16 v[38:39], v9 offset:8704
    v_mfma_f32_32x32x16_bf16 v[128:143], a[76:79], v[40:43], v[128:143]
    v_mfma_f32_32x32x16_bf16 v[144:159], a[204:207], v[40:43], v[144:159]
    s_waitcnt lgkmcnt(4)
    ds_read_b64_tr_b16 v[40:41], v8 offset:10240
    ds_read_b64_tr_b16 v[42:43], v8 offset:10752
    v_mfma_f32_32x32x16_bf16 v[160:175], a[76:79], v[44:47], v[160:175]
    v_mfma_f32_32x32x16_bf16 v[176:191], a[204:207], v[44:47], v[176:191]
    s_waitcnt lgkmcnt(4)
    ds_read_b64_tr_b16 v[44:45], v9 offset:10240
    ds_read_b64_tr_b16 v[46:47], v9 offset:10752
    v_mfma_f32_32x32x16_bf16 v[128:143], a[80:83], v[32:35], v[128:143]
    v_mfma_f32_32x32x16_bf16 v[144:159], a[208:211], v[32:35], v[144:159]
    s_waitcnt lgkmcnt(4)
    ds_read_b64_tr_b16 v[32:33], v8 offset:12288
    ds_read_b64_tr_b16 v[34:35], v8 offset:12800
    s_mov_b32 s30, 131072
    buffer_load_dwordx4 a[8:11], v19, s[80:83], s30 offen offset:0 sc1
    buffer_load_dwordx4 a[136:139], v19, s[80:83], s30 offen offset:512 sc1
    v_mfma_f32_32x32x16_bf16 v[160:175], a[80:83], v[36:39], v[160:175]
    v_mfma_f32_32x32x16_bf16 v[176:191], a[208:211], v[36:39], v[176:191]
    s_waitcnt lgkmcnt(4)
    ds_read_b64_tr_b16 v[36:37], v9 offset:12288
    ds_read_b64_tr_b16 v[38:39], v9 offset:12800
    v_mfma_f32_32x32x16_bf16 v[128:143], a[84:87], v[40:43], v[128:143]
    v_mfma_f32_32x32x16_bf16 v[144:159], a[212:215], v[40:43], v[144:159]
    s_waitcnt lgkmcnt(4)
    ds_read_b64_tr_b16 v[40:41], v8 offset:14336
    ds_read_b64_tr_b16 v[42:43], v8 offset:14848
    v_mfma_f32_32x32x16_bf16 v[160:175], a[84:87], v[44:47], v[160:175]
    v_mfma_f32_32x32x16_bf16 v[176:191], a[212:215], v[44:47], v[176:191]
    s_waitcnt lgkmcnt(4)
    ds_read_b64_tr_b16 v[44:45], v9 offset:14336
    ds_read_b64_tr_b16 v[46:47], v9 offset:14848
    v_mfma_f32_32x32x16_bf16 v[128:143], a[88:91], v[32:35], v[128:143]
    s_mov_b32 s30, 196608
    buffer_load_dwordx4 a[12:15], v19, s[80:83], s30 offen offset:0 sc1
    buffer_load_dwordx4 a[140:143], v19, s[80:83], s30 offen offset:512 sc1
    v_mfma_f32_32x32x16_bf16 v[144:159], a[216:219], v[32:35], v[144:159]
    s_waitcnt lgkmcnt(4)
    ds_read_b64_tr_b16 v[32:33], v8 offset:16384
    ds_read_b64_tr_b16 v[34:35], v8 offset:16896
    v_mfma_f32_32x32x16_bf16 v[160:175], a[88:91], v[36:39], v[160:175]
    v_mfma_f32_32x32x16_bf16 v[176:191], a[216:219], v[36:39], v[176:191]
    s_waitcnt lgkmcnt(4)
    ds_read_b64_tr_b16 v[36:37], v9 offset:16384
    ds_read_b64_tr_b16 v[38:39], v9 offset:16896
    v_mfma_f32_32x32x16_bf16 v[128:143], a[92:95], v[40:43], v[128:143]
    v_mfma_f32_32x32x16_bf16 v[144:159], a[220:223], v[40:43], v[144:159]
    s_waitcnt lgkmcnt(4)
    ds_read_b64_tr_b16 v[40:41], v8 offset:18432
    ds_read_b64_tr_b16 v[42:43], v8 offset:18944
    v_mfma_f32_32x32x16_bf16 v[160:175], a[92:95], v[44:47], v[160:175]
    v_mfma_f32_32x32x16_bf16 v[176:191], a[220:223], v[44:47], v[176:191]
    s_waitcnt vmcnt(24)
    s_barrier
    s_waitcnt lgkmcnt(4)
    ds_read_b64_tr_b16 v[44:45], v9 offset:18432
    ds_read_b64_tr_b16 v[46:47], v9 offset:18944
    s_mov_b32 s30, 262144
    buffer_load_dwordx4 a[16:19], v19, s[80:83], s30 offen offset:0 sc1
    buffer_load_dwordx4 a[144:147], v19, s[80:83], s30 offen offset:512 sc1
    v_mfma_f32_32x32x16_bf16 v[128:143], a[96:99], v[32:35], v[128:143]
    v_mfma_f32_32x32x16_bf16 v[144:159], a[224:227], v[32:35], v[144:159]
    s_waitcnt lgkmcnt(4)
    ds_read_b64_tr_b16 v[32:33], v8 offset:20480
    ds_read_b64_tr_b16 v[34:35], v8 offset:20992
    s_add_u32 m0, s40, 0
    s_nop 0
    buffer_load_dwordx4 v14, s[68:71], s44 offen lds
    v_mfma_f32_32x32x16_bf16 v[160:175], a[96:99], v[36:39], v[160:175]
    v_mfma_f32_32x32x16_bf16 v[176:191], a[224:227], v[36:39], v[176:191]
    s_waitcnt lgkmcnt(4)
    ds_read_b64_tr_b16 v[36:37], v9 offset:20480
    ds_read_b64_tr_b16 v[38:39], v9 offset:20992
    v_mfma_f32_32x32x16_bf16 v[128:143], a[100:103], v[40:43], v[128:143]
    s_add_u32 m0, s40, 1024
    s_nop 0
    buffer_load_dwordx4 v14, s[68:71], s45 offen lds
    v_mfma_f32_32x32x16_bf16 v[144:159], a[228:231], v[40:43], v[144:159]
    s_waitcnt lgkmcnt(4)
    ds_read_b64_tr_b16 v[40:41], v8 offset:22528
    ds_read_b64_tr_b16 v[42:43], v8 offset:23040
    v_mfma_f32_32x32x16_bf16 v[160:175], a[100:103], v[44:47], v[160:175]
    s_mov_b32 s30, 327680
    buffer_load_dwordx4 a[20:23], v19, s[80:83], s30 offen offset:0 sc1
    buffer_load_dwordx4 a[148:151], v19, s[80:83], s30 offen offset:512 sc1
    v_mfma_f32_32x32x16_bf16 v[176:191], a[228:231], v[44:47], v[176:191]
    s_waitcnt lgkmcnt(4)
    ds_read_b64_tr_b16 v[44:45], v9 offset:22528
    ds_read_b64_tr_b16 v[46:47], v9 offset:23040
    s_add_u32 m0, s40, 2048
    s_nop 0
    buffer_load_dwordx4 v14, s[68:71], s46 offen lds
    v_mfma_f32_32x32x16_bf16 v[128:143], a[104:107], v[32:35], v[128:143]
    v_mfma_f32_32x32x16_bf16 v[144:159], a[232:235], v[32:35], v[144:159]
    s_waitcnt lgkmcnt(4)
    ds_read_b64_tr_b16 v[32:33], v8 offset:24576
    ds_read_b64_tr_b16 v[34:35], v8 offset:25088
    v_mfma_f32_32x32x16_bf16 v[160:175], a[104:107], v[36:39], v[160:175]
    s_add_u32 m0, s40, 3072
    s_nop 0
    buffer_load_dwordx4 v14, s[68:71], s47 offen lds
    v_mfma_f32_32x32x16_bf16 v[176:191], a[232:235], v[36:39], v[176:191]
    s_waitcnt lgkmcnt(4)
    ds_read_b64_tr_b16 v[36:37], v9 offset:24576
    ds_read_b64_tr_b16 v[38:39], v9 offset:25088
    v_mfma_f32_32x32x16_bf16 v[128:143], a[108:111], v[40:43], v[128:143]
    v_mfma_f32_32x32x16_bf16 v[144:159], a[236:239], v[40:43], v[144:159]
    s_waitcnt lgkmcnt(4)
    ds_read_b64_tr_b16 v[40:41], v8 offset:26624
    ds_read_b64_tr_b16 v[42:43], v8 offset:27136
    s_mov_b32 s30, 393216
    buffer_load_dwordx4 a[24:27], v19, s[80:83], s30 offen offset:0 sc1
    buffer_load_dwordx4 a[152:155], v19, s[80:83], s30 offen offset:512 sc1
    s_add_u32 m0, s40, 4096
    s_nop 0
    buffer_load_dwordx4 v14, s[68:71], s48 offen lds
    v_mfma_f32_32x32x16_bf16 v[160:175], a[108:111], v[44:47], v[160:175]
    v_mfma_f32_32x32x16_bf16 v[176:191], a[236:239], v[44:47], v[176:191]
    s_waitcnt lgkmcnt(4)
    ds_read_b64_tr_b16 v[44:45], v9 offset:26624
    ds_read_b64_tr_b16 v[46:47], v9 offset:27136
    v_mfma_f32_32x32x16_bf16 v[128:143], a[112:115], v[32:35], v[128:143]
    s_add_u32 m0, s40, 5120
    s_nop 0
    buffer_load_dwordx4 v14, s[68:71], s49 offen lds
    v_mfma_f32_32x32x16_bf16 v[144:159], a[240:243], v[32:35], v[144:159]
    s_waitcnt lgkmcnt(4)
    ds_read_b64_tr_b16 v[32:33], v8 offset:28672
    ds_read_b64_tr_b16 v[34:35], v8 offset:29184
    v_mfma_f32_32x32x16_bf16 v[160:175], a[112:115], v[36:39], v[160:175]
    v_mfma_f32_32x32x16_bf16 v[176:191], a[240:243], v[36:39], v[176:191]
    s_waitcnt lgkmcnt(4)
    ds_read_b64_tr_b16 v[36:37], v9 offset:28672
    ds_read_b64_tr_b16 v[38:39], v9 offset:29184
    s_add_u32 m0, s40, 6144
    s_nop 0
    buffer_load_dwordx4 v14, s[68:71], s50 offen lds
    v_mfma_f32_32x32x16_bf16 v[128:143], a[116:119], v[40:43], v[128:143]
    s_mov_b32 s30, 458752
    buffer_load_dwordx4 a[28:31], v19, s[80:83], s30 offen offset:0 sc1
    buffer_load_dwordx4 a[156:159], v19, s[80:83], s30 offen offset:512 sc1
    v_mfma_f32_32x32x16_bf16 v[144:159], a[244:247], v[40:43], v[144:159]
    s_waitcnt lgkmcnt(4)
    ds_read_b64_tr_b16 v[40:41], v8 offset:30720
    ds_read_b64_tr_b16 v[42:43], v8 offset:31232
    v_mfma_f32_32x32x16_bf16 v[160:175], a[116:119], v[44:47], v[160:175]
    s_add_u32 m0, s40, 7168
    s_nop 0
    buffer_load_dwordx4 v14, s[68:71], s51 offen lds
    v_mfma_f32_32x32x16_bf16 v[176:191], a[244:247], v[44:47], v[176:191]
    s_waitcnt lgkmcnt(4)
    ds_read_b64_tr_b16 v[44:45], v9 offset:30720
    ds_read_b64_tr_b16 v[46:47], v9 offset:31232
    v_mfma_f32_32x32x16_bf16 v[128:143], a[120:123], v[32:35], v[128:143]
    v_mfma_f32_32x32x16_bf16 v[144:159], a[248:251], v[32:35], v[144:159]
    s_waitcnt lgkmcnt(4)
    ds_read_b64_tr_b16 v[32:33], v10 offset:0
    ds_read_b64_tr_b16 v[34:35], v10 offset:512
    v_add_u32 v14, 2097152, v14
    s_add_u32 s41, s41, 32768
    s_and_b32 s41, s41, 0x1ffff
    s_add_u32 s40, s41, s42
    v_mfma_f32_32x32x16_bf16 v[160:175], a[120:123], v[36:39], v[160:175]
    v_mfma_f32_32x32x16_bf16 v[176:191], a[248:251], v[36:39], v[176:191]
    s_waitcnt lgkmcnt(4)
    ds_read_b64_tr_b16 v[36:37], v11 offset:0
    ds_read_b64_tr_b16 v[38:39], v11 offset:512
    v_mfma_f32_32x32x16_bf16 v[128:143], a[124:127], v[40:43], v[128:143]
    v_mfma_f32_32x32x16_bf16 v[144:159], a[252:255], v[40:43], v[144:159]
    s_waitcnt lgkmcnt(4)
    ds_read_b64_tr_b16 v[40:41], v10 offset:2048
    ds_read_b64_tr_b16 v[42:43], v10 offset:2560
    v_mfma_f32_32x32x16_bf16 v[160:175], a[124:127], v[44:47], v[160:175]
    v_mfma_f32_32x32x16_bf16 v[176:191], a[252:255], v[44:47], v[176:191]
    v_mov_b32 v8, v10
    v_mov_b32 v9, v11
    s_add_u32 s43, s43, 32768
    s_and_b32 s43, s43, 0x1ffff
    v_add_u32 v10, s43, v12
    v_add_u32 v11, s43, v13
    s_waitcnt lgkmcnt(4)
    ds_read_b64_tr_b16 v[44:45], v9 offset:2048
    ds_read_b64_tr_b16 v[46:47], v9 offset:2560
    s_mov_b32 s30, 524288
    buffer_load_dwordx4 a[32:35], v19, s[80:83], s30 offen offset:0 sc1
    buffer_load_dwordx4 a[160:163], v19, s[80:83], s30 offen offset:512 sc1
    s_waitcnt vmcnt(24)
    v_mfma_f32_32x32x16_bf16 v[64:79], v[32:35], a[0:3], 0
    v_mfma_f32_32x32x16_bf16 v[80:95], v[32:35], a[128:131], 0
    s_waitcnt lgkmcnt(4)
    ds_read_b64_tr_b16 v[32:33], v8 offset:4096
    ds_read_b64_tr_b16 v[34:35], v8 offset:4608
    v_mfma_f32_32x32x16_bf16 v[96:111], v[36:39], a[0:3], 0
    v_cvt_pk_bf16_f32 v48, v128, v129
    v_cvt_pk_bf16_f32 v49, v130, v131
    v_mfma_f32_32x32x16_bf16 v[112:127], v[36:39], a[128:131], 0
    s_waitcnt lgkmcnt(4)
    ds_read_b64_tr_b16 v[36:37], v9 offset:4096
    ds_read_b64_tr_b16 v[38:39], v9 offset:4608
    s_mov_b32 s30, 589824
    buffer_load_dwordx4 a[36:39], v19, s[80:83], s30 offen offset:0 sc1
    buffer_load_dwordx4 a[164:167], v19, s[80:83], s30 offen offset:512 sc1
    s_waitcnt vmcnt(24)
    v_cvt_pk_bf16_f32 v50, v132, v133
    v_mfma_f32_32x32x16_bf16 v[64:79], v[40:43], a[4:7], v[64:79]
    v_cvt_pk_bf16_f32 v51, v134, v135
    v_cvt_pk_bf16_f32 v52, v136, v137
    v_mfma_f32_32x32x16_bf16 v[80:95], v[40:43], a[132:135], v[80:95]
    s_waitcnt lgkmcnt(4)
    ds_read_b64_tr_b16 v[40:41], v8 offset:6144
    ds_read_b64_tr_b16 v[42:43], v8 offset:6656
    v_cvt_pk_bf16_f32 v53, v138, v139
    v_mfma_f32_32x32x16_bf16 v[96:111], v[44:47], a[4:7], v[96:111]
    v_cvt_pk_bf16_f32 v54, v140, v141
    v_cvt_pk_bf16_f32 v55, v142, v143
    v_mfma_f32_32x32x16_bf16 v[112:127], v[44:47], a[132:135], v[112:127]
    s_waitcnt lgkmcnt(4)
    ds_read_b64_tr_b16 v[44:45], v9 offset:6144
    ds_read_b64_tr_b16 v[46:47], v9 offset:6656
    s_mov_b32 s30, 655360
    buffer_load_dwordx4 a[40:43], v19, s[80:83], s30 offen offset:0 sc1
    buffer_load_dwordx4 a[168:171], v19, s[80:83], s30 offen offset:512 sc1
    s_waitcnt vmcnt(24)
    buffer_store_dwordx4 v[48:51], v20, s[72:75], s60 offen offset:1024
    v_mfma_f32_32x32x16_bf16 v[64:79], v[32:35], a[8:11], v[64:79]
    buffer_store_dwordx4 v[52:55], v21, s[72:75], s60 offen offset:1024
    v_mfma_f32_32x32x16_bf16 v[80:95], v[32:35], a[136:139], v[80:95]
    s_waitcnt lgkmcnt(4)
    ds_read_b64_tr_b16 v[32:33], v8 offset:8192
    ds_read_b64_tr_b16 v[34:35], v8 offset:8704
    v_cvt_pk_bf16_f32 v56, v144, v145
    v_cvt_pk_bf16_f32 v57, v146, v147
    v_mfma_f32_32x32x16_bf16 v[96:111], v[36:39], a[8:11], v[96:111]
    v_cvt_pk_bf16_f32 v58, v148, v149
    v_mfma_f32_32x32x16_bf16 v[112:127], v[36:39], a[136:139], v[112:127]
    s_waitcnt lgkmcnt(4)
    ds_read_b64_tr_b16 v[36:37], v9 offset:8192
    ds_read_b64_tr_b16 v[38:39], v9 offset:8704
    s_mov_b32 s30, 720896
    buffer_load_dwordx4 a[44:47], v19, s[80:83], s30 offen offset:0 sc1
    buffer_load_dwordx4 a[172:175], v19, s[80:83], s30 offen offset:512 sc1
    s_waitcnt vmcnt(26)
    v_cvt_pk_bf16_f32 v59, v150, v151
    v_cvt_pk_bf16_f32 v60, v152, v153
    v_mfma_f32_32x32x16_bf16 v[64:79], v[40:43], a[12:15], v[64:79]
    v_cvt_pk_bf16_f32 v61, v154, v155
    v_mfma_f32_32x32x16_bf16 v[80:95], v[40:43], a[140:143], v[80:95]
    s_waitcnt lgkmcnt(4)
    ds_read_b64_tr_b16 v[40:41], v8 offset:10240
    ds_read_b64_tr_b16 v[42:43], v8 offset:10752
    v_cvt_pk_bf16_f32 v62, v156, v157
    v_cvt_pk_bf16_f32 v63, v158, v159
    v_mfma_f32_32x32x16_bf16 v[96:111], v[44:47], a[12:15], v[96:111]
    buffer_store_dwordx4 v[56:59], v22, s[72:75], s60 offen offset:1024
    v_mfma_f32_32x32x16_bf16 v[112:127], v[44:47], a[140:143], v[112:127]
    s_waitcnt lgkmcnt(4)
    ds_read_b64_tr_b16 v[44:45], v9 offset:10240
    ds_read_b64_tr_b16 v[46:47], v9 offset:10752
    s_mov_b32 s30, 786432
    buffer_load_dwordx4 a[48:51], v19, s[80:83], s30 offen offset:0 sc1
    buffer_load_dwordx4 a[176:179], v19, s[80:83], s30 offen offset:512 sc1
    s_waitcnt vmcnt(27)
    buffer_store_dwordx4 v[60:63], v23, s[72:75], s60 offen offset:1024
    v_mfma_f32_32x32x16_bf16 v[64:79], v[32:35], a[16:19], v[64:79]
    v_cvt_pk_bf16_f32 v48, v160, v161
    v_cvt_pk_bf16_f32 v49, v162, v163
    v_mfma_f32_32x32x16_bf16 v[80:95], v[32:35], a[144:147], v[80:95]
    s_waitcnt lgkmcnt(4)
    ds_read_b64_tr_b16 v[32:33], v8 offset:12288
    ds_read_b64_tr_b16 v[34:35], v8 offset:12800
    v_cvt_pk_bf16_f32 v50, v164, v165
    v_mfma_f32_32x32x16_bf16 v[96:111], v[36:39], a[16:19], v[96:111]
    v_cvt_pk_bf16_f32 v51, v166, v167
    v_cvt_pk_bf16_f32 v52, v168, v169
    v_mfma_f32_32x32x16_bf16 v[112:127], v[36:39], a[144:147], v[112:127]
    s_waitcnt lgkmcnt(4)
    ds_read_b64_tr_b16 v[36:37], v9 offset:12288
    ds_read_b64_tr_b16 v[38:39], v9 offset:12800
    s_mov_b32 s30, 851968
    buffer_load_dwordx4 a[52:55], v19, s[80:83], s30 offen offset:0 sc1
    buffer_load_dwordx4 a[180:183], v19, s[80:83], s30 offen offset:512 sc1
    s_waitcnt vmcnt(26)
    v_cvt_pk_bf16_f32 v53, v170, v171
    v_mfma_f32_32x32x16_bf16 v[64:79], v[40:43], a[20:23], v[64:79]
    v_cvt_pk_bf16_f32 v54, v172, v173
    v_cvt_pk_bf16_f32 v55, v174, v175
    v_mfma_f32_32x32x16_bf16 v[80:95], v[40:43], a[148:151], v[80:95]
    s_waitcnt lgkmcnt(4)
    ds_read_b64_tr_b16 v[40:41], v8 offset:14336
    ds_read_b64_tr_b16 v[42:43], v8 offset:14848
    buffer_store_dwordx4 v[48:51], v20, s[72:75], s60 offen offset:1536
    v_mfma_f32_32x32x16_bf16 v[96:111], v[44:47], a[20:23], v[96:111]
    buffer_store_dwordx4 v[52:55], v21, s[72:75], s60 offen offset:1536
    v_mfma_f32_32x32x16_bf16 v[112:127], v[44:47], a[148:151], v[112:127]
    s_waitcnt lgkmcnt(4)
    ds_read_b64_tr_b16 v[44:45], v9 offset:14336
    ds_read_b64_tr_b16 v[46:47], v9 offset:14848
    s_mov_b32 s30, 917504
    buffer_load_dwordx4 a[56:59], v19, s[80:83], s30 offen offset:0 sc1
    buffer_load_dwordx4 a[184:187], v19, s[80:83], s30 offen offset:512 sc1
    s_waitcnt vmcnt(26)
    v_cvt_pk_bf16_f32 v56, v176, v177
    v_cvt_pk_bf16_f32 v57, v178, v179
    v_mfma_f32_32x32x16_bf16 v[64:79], v[32:35], a[24:27], v[64:79]
    v_cvt_pk_bf16_f32 v58, v180, v181
    v_mfma_f32_32x32x16_bf16 v[80:95], v[32:35], a[152:155], v[80:95]
    s_waitcnt lgkmcnt(4)
    ds_read_b64_tr_b16 v[32:33], v8 offset:16384
    ds_read_b64_tr_b16 v[34:35], v8 offset:16896
    v_cvt_pk_bf16_f32 v59, v182, v183
    v_cvt_pk_bf16_f32 v60, v184, v185
    v_mfma_f32_32x32x16_bf16 v[96:111], v[36:39], a[24:27], v[96:111]
    v_cvt_pk_bf16_f32 v61, v186, v187
    v_mfma_f32_32x32x16_bf16 v[112:127], v[36:39], a[152:155], v[112:127]
    s_waitcnt lgkmcnt(4)
    ds_read_b64_tr_b16 v[36:37], v9 offset:16384
    ds_read_b64_tr_b16 v[38:39], v9 offset:16896
    s_mov_b32 s30, 983040
    buffer_load_dwordx4 a[60:63], v19, s[80:83], s30 offen offset:0 sc1
    buffer_load_dwordx4 a[188:191], v19, s[80:83], s30 offen offset:512 sc1
    s_waitcnt vmcnt(23)
    v_cvt_pk_bf16_f32 v62, v188, v189
    v_cvt_pk_bf16_f32 v63, v190, v191
    v_mfma_f32_32x32x16_bf16 v[64:79], v[40:43], a[28:31], v[64:79]
    buffer_store_dwordx4 v[56:59], v22, s[72:75], s60 offen offset:1536
    v_mfma_f32_32x32x16_bf16 v[80:95], v[40:43], a[156:159], v[80:95]
    s_waitcnt lgkmcnt(4)
    ds_read_b64_tr_b16 v[40:41], v8 offset:18432
    ds_read_b64_tr_b16 v[42:43], v8 offset:18944
    buffer_store_dwordx4 v[60:63], v23, s[72:75], s60 offen offset:1536
    v_mfma_f32_32x32x16_bf16 v[96:111], v[44:47], a[28:31], v[96:111]
    v_mfma_f32_32x32x16_bf16 v[112:127], v[44:47], a[156:159], v[112:127]
    s_waitcnt vmcnt(48)
    s_barrier
    s_waitcnt lgkmcnt(4)
    ds_read_b64_tr_b16 v[44:45], v9 offset:18432
    ds_read_b64_tr_b16 v[46:47], v9 offset:18944
    s_mov_b32 s30, 1048576
    buffer_load_dwordx4 a[64:67], v19, s[80:83], s30 offen offset:0 sc1
    buffer_load_dwordx4 a[192:195], v19, s[80:83], s30 offen offset:512 sc1
    s_waitcnt vmcnt(24)
    v_mfma_f32_32x32x16_bf16 v[64:79], v[32:35], a[32:35], v[64:79]
    v_mfma_f32_32x32x16_bf16 v[80:95], v[32:35], a[160:163], v[80:95]
    s_waitcnt lgkmcnt(4)
    ds_read_b64_tr_b16 v[32:33], v8 offset:20480
    ds_read_b64_tr_b16 v[34:35], v8 offset:20992
    s_add_u32 m0, s40, 0
    s_nop 0
    buffer_load_dwordx4 v14, s[68:71], s44 offen lds
    v_mfma_f32_32x32x16_bf16 v[96:111], v[36:39], a[32:35], v[96:111]
    v_mfma_f32_32x32x16_bf16 v[112:127], v[36:39], a[160:163], v[112:127]
    s_waitcnt lgkmcnt(4)
    ds_read_b64_tr_b16 v[36:37], v9 offset:20480
    ds_read_b64_tr_b16 v[38:39], v9 offset:20992
    s_mov_b32 s30, 1114112
    buffer_load_dwordx4 a[68:71], v19, s[80:83], s30 offen offset:0 sc1
    buffer_load_dwordx4 a[196:199], v19, s[80:83], s30 offen offset:512 sc1
    s_waitcnt vmcnt(25)
    v_mfma_f32_32x32x16_bf16 v[64:79], v[40:43], a[36:39], v[64:79]
    s_add_u32 m0, s40, 1024
    s_nop 0
    buffer_load_dwordx4 v14, s[68:71], s45 offen lds
    v_mfma_f32_32x32x16_bf16 v[80:95], v[40:43], a[164:167], v[80:95]
    s_waitcnt lgkmcnt(4)
    ds_read_b64_tr_b16 v[40:41], v8 offset:22528
    ds_read_b64_tr_b16 v[42:43], v8 offset:23040
    v_mfma_f32_32x32x16_bf16 v[96:111], v[44:47], a[36:39], v[96:111]
    v_mfma_f32_32x32x16_bf16 v[112:127], v[44:47], a[164:167], v[112:127]
    s_waitcnt lgkmcnt(4)
    ds_read_b64_tr_b16 v[44:45], v9 offset:22528
    ds_read_b64_tr_b16 v[46:47], v9 offset:23040
    s_mov_b32 s30, 1179648
    buffer_load_dwordx4 a[72:75], v19, s[80:83], s30 offen offset:0 sc1
    buffer_load_dwordx4 a[200:203], v19, s[80:83], s30 offen offset:512 sc1
    s_waitcnt vmcnt(26)
    s_add_u32 m0, s40, 2048
    s_nop 0
    buffer_load_dwordx4 v14, s[68:71], s46 offen lds
    v_mfma_f32_32x32x16_bf16 v[64:79], v[32:35], a[40:43], v[64:79]
    v_mfma_f32_32x32x16_bf16 v[80:95], v[32:35], a[168:171], v[80:95]
    s_waitcnt lgkmcnt(4)
    ds_read_b64_tr_b16 v[32:33], v8 offset:24576
    ds_read_b64_tr_b16 v[34:35], v8 offset:25088
    v_mfma_f32_32x32x16_bf16 v[96:111], v[36:39], a[40:43], v[96:111]
    s_add_u32 m0, s40, 3072
    s_nop 0
    buffer_load_dwordx4 v14, s[68:71], s47 offen lds
    v_mfma_f32_32x32x16_bf16 v[112:127], v[36:39], a[168:171], v[112:127]
    s_waitcnt lgkmcnt(4)
    ds_read_b64_tr_b16 v[36:37], v9 offset:24576
    ds_read_b64_tr_b16 v[38:39], v9 offset:25088
    s_mov_b32 s30, 1245184
    buffer_load_dwordx4 a[76:79], v19, s[80:83], s30 offen offset:0 sc1
    buffer_load_dwordx4 a[204:207], v19, s[80:83], s30 offen offset:512 sc1
    s_waitcnt vmcnt(26)
    v_mfma_f32_32x32x16_bf16 v[64:79], v[40:43], a[44:47], v[64:79]
    v_mfma_f32_32x32x16_bf16 v[80:95], v[40:43], a[172:175], v[80:95]
    s_waitcnt lgkmcnt(4)
    ds_read_b64_tr_b16 v[40:41], v8 offset:26624
    ds_read_b64_tr_b16 v[42:43], v8 offset:27136
    s_add_u32 m0, s40, 4096
    s_nop 0
    buffer_load_dwordx4 v14, s[68:71], s48 offen lds
    v_mfma_f32_32x32x16_bf16 v[96:111], v[44:47], a[44:47], v[96:111]
    v_mfma_f32_32x32x16_bf16 v[112:127], v[44:47], a[172:175], v[112:127]
    s_waitcnt lgkmcnt(4)
    ds_read_b64_tr_b16 v[44:45], v9 offset:26624
    ds_read_b64_tr_b16 v[46:47], v9 offset:27136
    s_mov_b32 s30, 1310720
    buffer_load_dwordx4 a[80:83], v19, s[80:83], s30 offen offset:0 sc1
    buffer_load_dwordx4 a[208:211], v19, s[80:83], s30 offen offset:512 sc1
    s_waitcnt vmcnt(26)
    v_mfma_f32_32x32x16_bf16 v[64:79], v[32:35], a[48:51], v[64:79]
    s_add_u32 m0, s40, 5120
    s_nop 0
    buffer_load_dwordx4 v14, s[68:71], s49 offen lds
    v_mfma_f32_32x32x16_bf16 v[80:95], v[32:35], a[176:179], v[80:95]
    s_waitcnt lgkmcnt(4)
    ds_read_b64_tr_b16 v[32:33], v8 offset:28672
    ds_read_b64_tr_b16 v[34:35], v8 offset:29184
    v_mfma_f32_32x32x16_bf16 v[96:111], v[36:39], a[48:51], v[96:111]
    v_mfma_f32_32x32x16_bf16 v[112:127], v[36:39], a[176:179], v[112:127]
    s_waitcnt lgkmcnt(4)
    ds_read_b64_tr_b16 v[36:37], v9 offset:28672
    ds_read_b64_tr_b16 v[38:39], v9 offset:29184
    s_mov_b32 s30, 1376256
    buffer_load_dwordx4 a[84:87], v19, s[80:83], s30 offen offset:0 sc1
    buffer_load_dwordx4 a[212:215], v19, s[80:83], s30 offen offset:512 sc1
    s_waitcnt vmcnt(26)
    s_add_u32 m0, s40, 6144
    s_nop 0
    buffer_load_dwordx4 v14, s[68:71], s50 offen lds
    v_mfma_f32_32x32x16_bf16 v[64:79], v[40:43], a[52:55], v[64:79]
    v_mfma_f32_32x32x16_bf16 v[80:95], v[40:43], a[180:183], v[80:95]
    s_waitcnt lgkmcnt(4)
    ds_read_b64_tr_b16 v[40:41], v8 offset:30720
    ds_read_b64_tr_b16 v[42:43], v8 offset:31232
    v_mfma_f32_32x32x16_bf16 v[96:111], v[44:47], a[52:55], v[96:111]
    s_add_u32 m0, s40, 7168
    s_nop 0
    buffer_load_dwordx4 v14, s[68:71], s51 offen lds
    v_mfma_f32_32x32x16_bf16 v[112:127], v[44:47], a[180:183], v[112:127]
    s_waitcnt lgkmcnt(4)
    ds_read_b64_tr_b16 v[44:45], v9 offset:30720
    ds_read_b64_tr_b16 v[46:47], v9 offset:31232
    s_mov_b32 s30, 1441792
    buffer_load_dwordx4 a[88:91], v19, s[80:83], s30 offen offset:0 sc1
    buffer_load_dwordx4 a[216:219], v19, s[80:83], s30 offen offset:512 sc1
    s_waitcnt vmcnt(26)
    v_mfma_f32_32x32x16_bf16 v[64:79], v[32:35], a[56:59], v[64:79]
    v_mfma_f32_32x32x16_bf16 v[80:95], v[32:35], a[184:187], v[80:95]
    s_waitcnt lgkmcnt(4)
    ds_read_b64_tr_b16 v[32:33], v10 offset:0
    ds_read_b64_tr_b16 v[34:35], v10 offset:512
    v_add_u32 v14, 4292870016, v14
    s_add_u32 s41, s41, 32768
    s_and_b32 s41, s41, 0x1ffff
    s_add_u32 s40, s41, s42
    v_mfma_f32_32x32x16_bf16 v[96:111], v[36:39], a[56:59], v[96:111]
    v_mfma_f32_32x32x16_bf16 v[112:127], v[36:39], a[184:187], v[112:127]
    s_waitcnt lgkmcnt(4)
    ds_read_b64_tr_b16 v[36:37], v11 offset:0
    ds_read_b64_tr_b16 v[38:39], v11 offset:512
    s_mov_b32 s30, 1507328
    buffer_load_dwordx4 a[92:95], v19, s[80:83], s30 offen offset:0 sc1
    buffer_load_dwordx4 a[220:223], v19, s[80:83], s30 offen offset:512 sc1
    s_waitcnt vmcnt(26)
    v_mfma_f32_32x32x16_bf16 v[64:79], v[40:43], a[60:63], v[64:79]
    v_mfma_f32_32x32x16_bf16 v[80:95], v[40:43], a[188:191], v[80:95]
    s_waitcnt lgkmcnt(4)
    ds_read_b64_tr_b16 v[40:41], v10 offset:2048
    ds_read_b64_tr_b16 v[42:43], v10 offset:2560
    v_mfma_f32_32x32x16_bf16 v[96:111], v[44:47], a[60:63], v[96:111]
    v_mfma_f32_32x32x16_bf16 v[112:127], v[44:47], a[188:191], v[112:127]
    v_mov_b32 v8, v10
    v_mov_b32 v9, v11
    s_add_u32 s43, s43, 32768
    s_and_b32 s43, s43, 0x1ffff
    v_add_u32 v10, s43, v12
    v_add_u32 v11, s43, v13
    s_waitcnt lgkmcnt(4)
    ds_read_b64_tr_b16 v[44:45], v9 offset:2048
    ds_read_b64_tr_b16 v[46:47], v9 offset:2560
    s_mov_b32 s30, 1572864
    buffer_load_dwordx4 a[96:99], v19, s[80:83], s30 offen offset:0 sc1
    buffer_load_dwordx4 a[224:227], v19, s[80:83], s30 offen offset:512 sc1
    s_waitcnt vmcnt(24)
    v_mfma_f32_32x32x16_bf16 v[64:79], v[32:35], a[64:67], v[64:79]
    v_mfma_f32_32x32x16_bf16 v[80:95], v[32:35], a[192:195], v[80:95]
    s_waitcnt lgkmcnt(4)
    ds_read_b64_tr_b16 v[32:33], v8 offset:4096
    ds_read_b64_tr_b16 v[34:35], v8 offset:4608
    v_mfma_f32_32x32x16_bf16 v[96:111], v[36:39], a[64:67], v[96:111]
    v_mfma_f32_32x32x16_bf16 v[112:127], v[36:39], a[192:195], v[112:127]
    s_waitcnt lgkmcnt(4)
    ds_read_b64_tr_b16 v[36:37], v9 offset:4096
    ds_read_b64_tr_b16 v[38:39], v9 offset:4608
    s_mov_b32 s30, 1638400
    buffer_load_dwordx4 a[100:103], v19, s[80:83], s30 offen offset:0 sc1
    buffer_load_dwordx4 a[228:231], v19, s[80:83], s30 offen offset:512 sc1
    s_waitcnt vmcnt(23)
    v_mfma_f32_32x32x16_bf16 v[64:79], v[40:43], a[68:71], v[64:79]
    v_mfma_f32_32x32x16_bf16 v[80:95], v[40:43], a[196:199], v[80:95]
    s_waitcnt lgkmcnt(4)
    ds_read_b64_tr_b16 v[40:41], v8 offset:6144
    ds_read_b64_tr_b16 v[42:43], v8 offset:6656
    v_mfma_f32_32x32x16_bf16 v[96:111], v[44:47], a[68:71], v[96:111]
    v_mfma_f32_32x32x16_bf16 v[112:127], v[44:47], a[196:199], v[112:127]
    s_waitcnt lgkmcnt(4)
    ds_read_b64_tr_b16 v[44:45], v9 offset:6144
    ds_read_b64_tr_b16 v[46:47], v9 offset:6656
    s_mov_b32 s30, 1703936
    buffer_load_dwordx4 a[104:107], v19, s[80:83], s30 offen offset:0 sc1
    buffer_load_dwordx4 a[232:235], v19, s[80:83], s30 offen offset:512 sc1
    s_waitcnt vmcnt(22)
    v_mfma_f32_32x32x16_bf16 v[64:79], v[32:35], a[72:75], v[64:79]
    v_mfma_f32_32x32x16_bf16 v[80:95], v[32:35], a[200:203], v[80:95]
    s_waitcnt lgkmcnt(4)
    ds_read_b64_tr_b16 v[32:33], v8 offset:8192
    ds_read_b64_tr_b16 v[34:35], v8 offset:8704
    v_mfma_f32_32x32x16_bf16 v[96:111], v[36:39], a[72:75], v[96:111]
    v_mfma_f32_32x32x16_bf16 v[112:127], v[36:39], a[200:203], v[112:127]
    s_waitcnt lgkmcnt(4)
    ds_read_b64_tr_b16 v[36:37], v9 offset:8192
    ds_read_b64_tr_b16 v[38:39], v9 offset:8704
    s_mov_b32 s30, 1769472
    buffer_load_dwordx4 a[108:111], v19, s[80:83], s30 offen offset:0 sc1
    buffer_load_dwordx4 a[236:239], v19, s[80:83], s30 offen offset:512 sc1
    s_waitcnt vmcnt(20)
    v_mfma_f32_32x32x16_bf16 v[64:79], v[40:43], a[76:79], v[64:79]
    v_mfma_f32_32x32x16_bf16 v[80:95], v[40:43], a[204:207], v[80:95]
    s_waitcnt lgkmcnt(4)
    ds_read_b64_tr_b16 v[40:41], v8 offset:10240
    ds_read_b64_tr_b16 v[42:43], v8 offset:10752
    v_mfma_f32_32x32x16_bf16 v[96:111], v[44:47], a[76:79], v[96:111]
    v_mfma_f32_32x32x16_bf16 v[112:127], v[44:47], a[204:207], v[112:127]
    s_waitcnt lgkmcnt(4)
    ds_read_b64_tr_b16 v[44:45], v9 offset:10240
    ds_read_b64_tr_b16 v[46:47], v9 offset:10752
    s_mov_b32 s30, 1835008
    buffer_load_dwordx4 a[112:115], v19, s[80:83], s30 offen offset:0 sc1
    buffer_load_dwordx4 a[240:243], v19, s[80:83], s30 offen offset:512 sc1
    s_waitcnt vmcnt(19)
    v_mfma_f32_32x32x16_bf16 v[64:79], v[32:35], a[80:83], v[64:79]
    v_mfma_f32_32x32x16_bf16 v[80:95], v[32:35], a[208:211], v[80:95]
    s_waitcnt lgkmcnt(4)
    ds_read_b64_tr_b16 v[32:33], v8 offset:12288
    ds_read_b64_tr_b16 v[34:35], v8 offset:12800
    v_mfma_f32_32x32x16_bf16 v[96:111], v[36:39], a[80:83], v[96:111]
    v_mfma_f32_32x32x16_bf16 v[112:127], v[36:39], a[208:211], v[112:127]
    s_waitcnt lgkmcnt(4)
    ds_read_b64_tr_b16 v[36:37], v9 offset:12288
    ds_read_b64_tr_b16 v[38:39], v9 offset:12800
    s_mov_b32 s30, 1900544
    buffer_load_dwordx4 a[116:119], v19, s[80:83], s30 offen offset:0 sc1
    buffer_load_dwordx4 a[244:247], v19, s[80:83], s30 offen offset:512 sc1
    s_waitcnt vmcnt(18)
    v_mfma_f32_32x32x16_bf16 v[64:79], v[40:43], a[84:87], v[64:79]
    v_mfma_f32_32x32x16_bf16 v[80:95], v[40:43], a[212:215], v[80:95]
    s_waitcnt lgkmcnt(4)
    ds_read_b64_tr_b16 v[40:41], v8 offset:14336
    ds_read_b64_tr_b16 v[42:43], v8 offset:14848
    v_mfma_f32_32x32x16_bf16 v[96:111], v[44:47], a[84:87], v[96:111]
    v_mfma_f32_32x32x16_bf16 v[112:127], v[44:47], a[212:215], v[112:127]
    s_waitcnt lgkmcnt(4)
    ds_read_b64_tr_b16 v[44:45], v9 offset:14336
    ds_read_b64_tr_b16 v[46:47], v9 offset:14848
    s_mov_b32 s30, 1966080
    buffer_load_dwordx4 a[120:123], v19, s[80:83], s30 offen offset:0 sc1
    buffer_load_dwordx4 a[248:251], v19, s[80:83], s30 offen offset:512 sc1
    s_waitcnt vmcnt(16)
    v_mfma_f32_32x32x16_bf16 v[64:79], v[32:35], a[88:91], v[64:79]
    v_mfma_f32_32x32x16_bf16 v[80:95], v[32:35], a[216:219], v[80:95]
    s_waitcnt lgkmcnt(4)
    ds_read_b64_tr_b16 v[32:33], v8 offset:16384
    ds_read_b64_tr_b16 v[34:35], v8 offset:16896
    v_mfma_f32_32x32x16_bf16 v[96:111], v[36:39], a[88:91], v[96:111]
    v_mfma_f32_32x32x16_bf16 v[112:127], v[36:39], a[216:219], v[112:127]
    s_waitcnt lgkmcnt(4)
    ds_read_b64_tr_b16 v[36:37], v9 offset:16384
    ds_read_b64_tr_b16 v[38:39], v9 offset:16896
    s_mov_b32 s30, 2031616
    buffer_load_dwordx4 a[124:127], v19, s[80:83], s30 offen offset:0 sc1
    buffer_load_dwordx4 a[252:255], v19, s[80:83], s30 offen offset:512 sc1
    s_waitcnt vmcnt(16)
    v_mfma_f32_32x32x16_bf16 v[64:79], v[40:43], a[92:95], v[64:79]
    v_mfma_f32_32x32x16_bf16 v[80:95], v[40:43], a[220:223], v[80:95]
    s_waitcnt lgkmcnt(4)
    ds_read_b64_tr_b16 v[40:41], v8 offset:18432
    ds_read_b64_tr_b16 v[42:43], v8 offset:18944
    v_mfma_f32_32x32x16_bf16 v[96:111], v[44:47], a[92:95], v[96:111]
    v_mfma_f32_32x32x16_bf16 v[112:127], v[44:47], a[220:223], v[112:127]
    s_waitcnt vmcnt(63)
    s_barrier
    s_waitcnt lgkmcnt(4)
    ds_read_b64_tr_b16 v[44:45], v9 offset:18432
    ds_read_b64_tr_b16 v[46:47], v9 offset:18944
    s_waitcnt vmcnt(14)
    v_mfma_f32_32x32x16_bf16 v[64:79], v[32:35], a[96:99], v[64:79]
    v_mfma_f32_32x32x16_bf16 v[80:95], v[32:35], a[224:227], v[80:95]
    s_waitcnt lgkmcnt(4)
    ds_read_b64_tr_b16 v[32:33], v8 offset:20480
    ds_read_b64_tr_b16 v[34:35], v8 offset:20992
    v_mfma_f32_32x32x16_bf16 v[96:111], v[36:39], a[96:99], v[96:111]
    v_mfma_f32_32x32x16_bf16 v[112:127], v[36:39], a[224:227], v[112:127]
    s_waitcnt lgkmcnt(4)
    ds_read_b64_tr_b16 v[36:37], v9 offset:20480
    ds_read_b64_tr_b16 v[38:39], v9 offset:20992
    s_waitcnt vmcnt(12)
    v_mfma_f32_32x32x16_bf16 v[64:79], v[40:43], a[100:103], v[64:79]
    v_mfma_f32_32x32x16_bf16 v[80:95], v[40:43], a[228:231], v[80:95]
    s_waitcnt lgkmcnt(4)
    ds_read_b64_tr_b16 v[40:41], v8 offset:22528
    ds_read_b64_tr_b16 v[42:43], v8 offset:23040
    v_mfma_f32_32x32x16_bf16 v[96:111], v[44:47], a[100:103], v[96:111]
    v_mfma_f32_32x32x16_bf16 v[112:127], v[44:47], a[228:231], v[112:127]
    s_waitcnt lgkmcnt(4)
    ds_read_b64_tr_b16 v[44:45], v9 offset:22528
    ds_read_b64_tr_b16 v[46:47], v9 offset:23040
    s_waitcnt vmcnt(10)
    v_mfma_f32_32x32x16_bf16 v[64:79], v[32:35], a[104:107], v[64:79]
    v_mfma_f32_32x32x16_bf16 v[80:95], v[32:35], a[232:235], v[80:95]
    s_waitcnt lgkmcnt(4)
    ds_read_b64_tr_b16 v[32:33], v8 offset:24576
    ds_read_b64_tr_b16 v[34:35], v8 offset:25088
    v_mfma_f32_32x32x16_bf16 v[96:111], v[36:39], a[104:107], v[96:111]
    v_mfma_f32_32x32x16_bf16 v[112:127], v[36:39], a[232:235], v[112:127]
    s_waitcnt lgkmcnt(4)
    ds_read_b64_tr_b16 v[36:37], v9 offset:24576
    ds_read_b64_tr_b16 v[38:39], v9 offset:25088
    s_waitcnt vmcnt(8)
    v_mfma_f32_32x32x16_bf16 v[64:79], v[40:43], a[108:111], v[64:79]
    v_mfma_f32_32x32x16_bf16 v[80:95], v[40:43], a[236:239], v[80:95]
    s_waitcnt lgkmcnt(4)
    ds_read_b64_tr_b16 v[40:41], v8 offset:26624
    ds_read_b64_tr_b16 v[42:43], v8 offset:27136
    v_mfma_f32_32x32x16_bf16 v[96:111], v[44:47], a[108:111], v[96:111]
    v_mfma_f32_32x32x16_bf16 v[112:127], v[44:47], a[236:239], v[112:127]
    s_waitcnt lgkmcnt(4)
    ds_read_b64_tr_b16 v[44:45], v9 offset:26624
    ds_read_b64_tr_b16 v[46:47], v9 offset:27136
    s_waitcnt vmcnt(6)
    v_mfma_f32_32x32x16_bf16 v[64:79], v[32:35], a[112:115], v[64:79]
    v_mfma_f32_32x32x16_bf16 v[80:95], v[32:35], a[240:243], v[80:95]
    s_waitcnt lgkmcnt(4)
    ds_read_b64_tr_b16 v[32:33], v8 offset:28672
    ds_read_b64_tr_b16 v[34:35], v8 offset:29184
    v_mfma_f32_32x32x16_bf16 v[96:111], v[36:39], a[112:115], v[96:111]
    v_mfma_f32_32x32x16_bf16 v[112:127], v[36:39], a[240:243], v[112:127]
    s_waitcnt lgkmcnt(4)
    ds_read_b64_tr_b16 v[36:37], v9 offset:28672
    ds_read_b64_tr_b16 v[38:39], v9 offset:29184
    s_waitcnt vmcnt(4)
    v_mfma_f32_32x32x16_bf16 v[64:79], v[40:43], a[116:119], v[64:79]
    v_mfma_f32_32x32x16_bf16 v[80:95], v[40:43], a[244:247], v[80:95]
    s_waitcnt lgkmcnt(4)
    ds_read_b64_tr_b16 v[40:41], v8 offset:30720
    ds_read_b64_tr_b16 v[42:43], v8 offset:31232
    v_mfma_f32_32x32x16_bf16 v[96:111], v[44:47], a[116:119], v[96:111]
    v_mfma_f32_32x32x16_bf16 v[112:127], v[44:47], a[244:247], v[112:127]
    s_waitcnt lgkmcnt(4)
    ds_read_b64_tr_b16 v[44:45], v9 offset:30720
    ds_read_b64_tr_b16 v[46:47], v9 offset:31232
    s_waitcnt vmcnt(2)
    v_mfma_f32_32x32x16_bf16 v[64:79], v[32:35], a[120:123], v[64:79]
    v_mfma_f32_32x32x16_bf16 v[80:95], v[32:35], a[248:251], v[80:95]
    s_waitcnt lgkmcnt(4)
    ds_read_b64_tr_b16 v[32:33], v10 offset:0
    ds_read_b64_tr_b16 v[34:35], v10 offset:512
    v_mfma_f32_32x32x16_bf16 v[96:111], v[36:39], a[120:123], v[96:111]
    v_mfma_f32_32x32x16_bf16 v[112:127], v[36:39], a[248:251], v[112:127]
    s_waitcnt lgkmcnt(4)
    ds_read_b64_tr_b16 v[36:37], v11 offset:0
    ds_read_b64_tr_b16 v[38:39], v11 offset:512
    s_waitcnt vmcnt(0)
    v_mfma_f32_32x32x16_bf16 v[64:79], v[40:43], a[124:127], v[64:79]
    v_mfma_f32_32x32x16_bf16 v[80:95], v[40:43], a[252:255], v[80:95]
    s_waitcnt lgkmcnt(4)
    ds_read_b64_tr_b16 v[40:41], v10 offset:2048
    ds_read_b64_tr_b16 v[42:43], v10 offset:2560
    v_mfma_f32_32x32x16_bf16 v[96:111], v[44:47], a[124:127], v[96:111]
    v_mfma_f32_32x32x16_bf16 v[112:127], v[44:47], a[252:255], v[112:127]
    v_mov_b32 v8, v10
    v_mov_b32 v9, v11
    s_add_u32 s43, s43, 32768
    s_and_b32 s43, s43, 0x1ffff
    v_add_u32 v10, s43, v12
    v_add_u32 v11, s43, v13
    s_waitcnt lgkmcnt(4)
    ds_read_b64_tr_b16 v[44:45], v9 offset:2048
    ds_read_b64_tr_b16 v[46:47], v9 offset:2560
    v_mfma_f32_32x32x16_bf16 v[128:143], v[32:35], a[0:3], 0
    v_mfma_f32_32x32x16_bf16 v[144:159], v[32:35], a[128:131], 0
    s_waitcnt lgkmcnt(4)
    ds_read_b64_tr_b16 v[32:33], v8 offset:4096
    ds_read_b64_tr_b16 v[34:35], v8 offset:4608
    v_mfma_f32_32x32x16_bf16 v[160:175], v[36:39], a[0:3], 0
    v_mul_f32 v64, s61, v64
    v_mul_f32 v65, s61, v65
    v_cvt_pk_bf16_f32 v48, v64, v65
    v_mul_f32 v66, s61, v66
    v_mfma_f32_32x32x16_bf16 v[176:191], v[36:39], a[128:131], 0
    s_waitcnt lgkmcnt(4)
    ds_read_b64_tr_b16 v[36:37], v9 offset:4096
    ds_read_b64_tr_b16 v[38:39], v9 offset:4608
    v_mul_f32 v67, s61, v67
    v_cvt_pk_bf16_f32 v49, v66, v67
    v_mul_f32 v68, s61, v68
    v_mul_f32 v69, s61, v69
    v_mfma_f32_32x32x16_bf16 v[128:143], v[40:43], a[4:7], v[128:143]
    v_cvt_pk_bf16_f32 v50, v68, v69
    v_mul_f32 v70, s61, v70
    v_mul_f32 v71, s61, v71
    v_cvt_pk_bf16_f32 v51, v70, v71
    v_mfma_f32_32x32x16_bf16 v[144:159], v[40:43], a[132:135], v[144:159]
    s_waitcnt lgkmcnt(4)
    ds_read_b64_tr_b16 v[40:41], v8 offset:6144
    ds_read_b64_tr_b16 v[42:43], v8 offset:6656
    v_mul_f32 v72, s61, v72
    v_mul_f32 v73, s61, v73
    v_cvt_pk_bf16_f32 v52, v72, v73
    v_mfma_f32_32x32x16_bf16 v[160:175], v[44:47], a[4:7], v[160:175]
    v_mul_f32 v74, s61, v74
    v_mul_f32 v75, s61, v75
    v_cvt_pk_bf16_f32 v53, v74, v75
    v_mul_f32 v76, s61, v76
    v_mfma_f32_32x32x16_bf16 v[176:191], v[44:47], a[132:135], v[176:191]
    s_waitcnt lgkmcnt(4)
    ds_read_b64_tr_b16 v[44:45], v9 offset:6144
    ds_read_b64_tr_b16 v[46:47], v9 offset:6656
    v_mul_f32 v77, s61, v77
    v_cvt_pk_bf16_f32 v54, v76, v77
    v_mul_f32 v78, s61, v78
    v_mul_f32 v79, s61, v79
    v_mfma_f32_32x32x16_bf16 v[128:143], v[32:35], a[8:11], v[128:143]
    v_cvt_pk_bf16_f32 v55, v78, v79
    buffer_store_dwordx4 v[48:51], v15, s[76:79], s60 offen offset:0
    buffer_store_dwordx4 v[52:55], v16, s[76:79], s60 offen offset:0
    v_mfma_f32_32x32x16_bf16 v[144:159], v[32:35], a[136:139], v[144:159]
    s_waitcnt lgkmcnt(4)
    ds_read_b64_tr_b16 v[32:33], v8 offset:8192
    ds_read_b64_tr_b16 v[34:35], v8 offset:8704
    v_mul_f32 v80, s61, v80
    v_mul_f32 v81, s61, v81
    v_cvt_pk_bf16_f32 v56, v80, v81
    v_mul_f32 v82, s61, v82
    v_mfma_f32_32x32x16_bf16 v[160:175], v[36:39], a[8:11], v[160:175]
    v_mul_f32 v83, s61, v83
    v_cvt_pk_bf16_f32 v57, v82, v83
    v_mul_f32 v84, s61, v84
    v_mul_f32 v85, s61, v85
    v_mfma_f32_32x32x16_bf16 v[176:191], v[36:39], a[136:139], v[176:191]
    s_waitcnt lgkmcnt(4)
    ds_read_b64_tr_b16 v[36:37], v9 offset:8192
    ds_read_b64_tr_b16 v[38:39], v9 offset:8704
    v_cvt_pk_bf16_f32 v58, v84, v85
    v_mul_f32 v86, s61, v86
    v_mul_f32 v87, s61, v87
    v_cvt_pk_bf16_f32 v59, v86, v87
    v_mfma_f32_32x32x16_bf16 v[128:143], v[40:43], a[12:15], v[128:143]
    v_mul_f32 v88, s61, v88
    v_mul_f32 v89, s61, v89
    v_cvt_pk_bf16_f32 v60, v88, v89
    v_mfma_f32_32x32x16_bf16 v[144:159], v[40:43], a[140:143], v[144:159]
    s_waitcnt lgkmcnt(4)
    ds_read_b64_tr_b16 v[40:41], v8 offset:10240
    ds_read_b64_tr_b16 v[42:43], v8 offset:10752
    v_mul_f32 v90, s61, v90
    v_mul_f32 v91, s61, v91
    v_cvt_pk_bf16_f32 v61, v90, v91
    v_mul_f32 v92, s61, v92
    v_mfma_f32_32x32x16_bf16 v[160:175], v[44:47], a[12:15], v[160:175]
    v_mul_f32 v93, s61, v93
    v_cvt_pk_bf16_f32 v62, v92, v93
    v_mul_f32 v94, s61, v94
    v_mul_f32 v95, s61, v95
    v_mfma_f32_32x32x16_bf16 v[176:191], v[44:47], a[140:143], v[176:191]
    s_waitcnt lgkmcnt(4)
    ds_read_b64_tr_b16 v[44:45], v9 offset:10240
    ds_read_b64_tr_b16 v[46:47], v9 offset:10752
    v_cvt_pk_bf16_f32 v63, v94, v95
    buffer_store_dwordx4 v[56:59], v15, s[76:79], s60 offen offset:512
    buffer_store_dwordx4 v[60:63], v16, s[76:79], s60 offen offset:512
    v_mfma_f32_32x32x16_bf16 v[128:143], v[32:35], a[16:19], v[128:143]
    v_mul_f32 v96, s61, v96
    v_mul_f32 v97, s61, v97
    v_cvt_pk_bf16_f32 v48, v96, v97
    v_mul_f32 v98, s61, v98
    v_mfma_f32_32x32x16_bf16 v[144:159], v[32:35], a[144:147], v[144:159]
    s_waitcnt lgkmcnt(4)
    ds_read_b64_tr_b16 v[32:33], v8 offset:12288
    ds_read_b64_tr_b16 v[34:35], v8 offset:12800
    v_mul_f32 v99, s61, v99
    v_cvt_pk_bf16_f32 v49, v98, v99
    v_mul_f32 v100, s61, v100
    v_mul_f32 v101, s61, v101
    v_mfma_f32_32x32x16_bf16 v[160:175], v[36:39], a[16:19], v[160:175]
    v_cvt_pk_bf16_f32 v50, v100, v101
    v_mul_f32 v102, s61, v102
    v_mul_f32 v103, s61, v103
    v_cvt_pk_bf16_f32 v51, v102, v103
    v_mfma_f32_32x32x16_bf16 v[176:191], v[36:39], a[144:147], v[176:191]
    s_waitcnt lgkmcnt(4)
    ds_read_b64_tr_b16 v[36:37], v9 offset:12288
    ds_read_b64_tr_b16 v[38:39], v9 offset:12800
    v_mul_f32 v104, s61, v104
    v_mul_f32 v105, s61, v105
    v_cvt_pk_bf16_f32 v52, v104, v105
    v_mfma_f32_32x32x16_bf16 v[128:143], v[40:43], a[20:23], v[128:143]
    v_mul_f32 v106, s61, v106
    v_mul_f32 v107, s61, v107
    v_cvt_pk_bf16_f32 v53, v106, v107
    v_mul_f32 v108, s61, v108
    v_mfma_f32_32x32x16_bf16 v[144:159], v[40:43], a[148:151], v[144:159]
    s_waitcnt lgkmcnt(4)
    ds_read_b64_tr_b16 v[40:41], v8 offset:14336
    ds_read_b64_tr_b16 v[42:43], v8 offset:14848
    v_mul_f32 v109, s61, v109
    v_cvt_pk_bf16_f32 v54, v108, v109
    v_mul_f32 v110, s61, v110
    v_mul_f32 v111, s61, v111
    v_mfma_f32_32x32x16_bf16 v[160:175], v[44:47], a[20:23], v[160:175]
    v_cvt_pk_bf16_f32 v55, v110, v111
    buffer_store_dwordx4 v[48:51], v17, s[76:79], s60 offen offset:0
    buffer_store_dwordx4 v[52:55], v18, s[76:79], s60 offen offset:0
    v_mfma_f32_32x32x16_bf16 v[176:191], v[44:47], a[148:151], v[176:191]
    s_waitcnt lgkmcnt(4)
    ds_read_b64_tr_b16 v[44:45], v9 offset:14336
    ds_read_b64_tr_b16 v[46:47], v9 offset:14848
    v_mul_f32 v112, s61, v112
    v_mul_f32 v113, s61, v113
    v_cvt_pk_bf16_f32 v56, v112, v113
    v_mul_f32 v114, s61, v114
    v_mfma_f32_32x32x16_bf16 v[128:143], v[32:35], a[24:27], v[128:143]
    v_mul_f32 v115, s61, v115
    v_cvt_pk_bf16_f32 v57, v114, v115
    v_mul_f32 v116, s61, v116
    v_mul_f32 v117, s61, v117
    v_mfma_f32_32x32x16_bf16 v[144:159], v[32:35], a[152:155], v[144:159]
    s_waitcnt lgkmcnt(4)
    ds_read_b64_tr_b16 v[32:33], v8 offset:16384
    ds_read_b64_tr_b16 v[34:35], v8 offset:16896
    v_cvt_pk_bf16_f32 v58, v116, v117
    v_mul_f32 v118, s61, v118
    v_mul_f32 v119, s61, v119
    v_cvt_pk_bf16_f32 v59, v118, v119
    v_mfma_f32_32x32x16_bf16 v[160:175], v[36:39], a[24:27], v[160:175]
    v_mul_f32 v120, s61, v120
    v_mul_f32 v121, s61, v121
    v_cvt_pk_bf16_f32 v60, v120, v121
    v_mfma_f32_32x32x16_bf16 v[176:191], v[36:39], a[152:155], v[176:191]
    s_waitcnt lgkmcnt(4)
    ds_read_b64_tr_b16 v[36:37], v9 offset:16384
    ds_read_b64_tr_b16 v[38:39], v9 offset:16896
    v_mul_f32 v122, s61, v122
    v_mul_f32 v123, s61, v123
    v_cvt_pk_bf16_f32 v61, v122, v123
    v_mul_f32 v124, s61, v124
    v_mfma_f32_32x32x16_bf16 v[128:143], v[40:43], a[28:31], v[128:143]
    v_mul_f32 v125, s61, v125
    v_cvt_pk_bf16_f32 v62, v124, v125
    v_mul_f32 v126, s61, v126
    v_mul_f32 v127, s61, v127
    v_mfma_f32_32x32x16_bf16 v[144:159], v[40:43], a[156:159], v[144:159]
    s_waitcnt lgkmcnt(4)
    ds_read_b64_tr_b16 v[40:41], v8 offset:18432
    ds_read_b64_tr_b16 v[42:43], v8 offset:18944
    v_cvt_pk_bf16_f32 v63, v126, v127
    buffer_store_dwordx4 v[56:59], v17, s[76:79], s60 offen offset:512
    buffer_store_dwordx4 v[60:63], v18, s[76:79], s60 offen offset:512
    v_mfma_f32_32x32x16_bf16 v[160:175], v[44:47], a[28:31], v[160:175]
    v_mfma_f32_32x32x16_bf16 v[176:191], v[44:47], a[156:159], v[176:191]
    s_waitcnt vmcnt(28)
    s_barrier
    s_waitcnt lgkmcnt(4)
    ds_read_b64_tr_b16 v[44:45], v9 offset:18432
    ds_read_b64_tr_b16 v[46:47], v9 offset:18944
    v_mfma_f32_32x32x16_bf16 v[128:143], v[32:35], a[32:35], v[128:143]
    v_mfma_f32_32x32x16_bf16 v[144:159], v[32:35], a[160:163], v[144:159]
    s_waitcnt lgkmcnt(4)
    ds_read_b64_tr_b16 v[32:33], v8 offset:20480
    ds_read_b64_tr_b16 v[34:35], v8 offset:20992
    v_mfma_f32_32x32x16_bf16 v[160:175], v[36:39], a[32:35], v[160:175]
    v_mfma_f32_32x32x16_bf16 v[176:191], v[36:39], a[160:163], v[176:191]
    s_waitcnt lgkmcnt(4)
    ds_read_b64_tr_b16 v[36:37], v9 offset:20480
    ds_read_b64_tr_b16 v[38:39], v9 offset:20992
    v_mfma_f32_32x32x16_bf16 v[128:143], v[40:43], a[36:39], v[128:143]
    v_mfma_f32_32x32x16_bf16 v[144:159], v[40:43], a[164:167], v[144:159]
    s_waitcnt lgkmcnt(4)
    ds_read_b64_tr_b16 v[40:41], v8 offset:22528
    ds_read_b64_tr_b16 v[42:43], v8 offset:23040
    v_mfma_f32_32x32x16_bf16 v[160:175], v[44:47], a[36:39], v[160:175]
    v_mfma_f32_32x32x16_bf16 v[176:191], v[44:47], a[164:167], v[176:191]
    s_waitcnt lgkmcnt(4)
    ds_read_b64_tr_b16 v[44:45], v9 offset:22528
    ds_read_b64_tr_b16 v[46:47], v9 offset:23040
    v_mfma_f32_32x32x16_bf16 v[128:143], v[32:35], a[40:43], v[128:143]
    v_mfma_f32_32x32x16_bf16 v[144:159], v[32:35], a[168:171], v[144:159]
    s_waitcnt lgkmcnt(4)
    ds_read_b64_tr_b16 v[32:33], v8 offset:24576
    ds_read_b64_tr_b16 v[34:35], v8 offset:25088
    v_mfma_f32_32x32x16_bf16 v[160:175], v[36:39], a[40:43], v[160:175]
    v_mfma_f32_32x32x16_bf16 v[176:191], v[36:39], a[168:171], v[176:191]
    s_waitcnt lgkmcnt(4)
    ds_read_b64_tr_b16 v[36:37], v9 offset:24576
    ds_read_b64_tr_b16 v[38:39], v9 offset:25088
    v_mfma_f32_32x32x16_bf16 v[128:143], v[40:43], a[44:47], v[128:143]
    v_mfma_f32_32x32x16_bf16 v[144:159], v[40:43], a[172:175], v[144:159]
    s_waitcnt lgkmcnt(4)
    ds_read_b64_tr_b16 v[40:41], v8 offset:26624
    ds_read_b64_tr_b16 v[42:43], v8 offset:27136
    v_mfma_f32_32x32x16_bf16 v[160:175], v[44:47], a[44:47], v[160:175]
    v_mfma_f32_32x32x16_bf16 v[176:191], v[44:47], a[172:175], v[176:191]
    s_waitcnt lgkmcnt(4)
    ds_read_b64_tr_b16 v[44:45], v9 offset:26624
    ds_read_b64_tr_b16 v[46:47], v9 offset:27136
    v_mfma_f32_32x32x16_bf16 v[128:143], v[32:35], a[48:51], v[128:143]
    v_mfma_f32_32x32x16_bf16 v[144:159], v[32:35], a[176:179], v[144:159]
    s_waitcnt lgkmcnt(4)
    ds_read_b64_tr_b16 v[32:33], v8 offset:28672
    ds_read_b64_tr_b16 v[34:35], v8 offset:29184
    v_mfma_f32_32x32x16_bf16 v[160:175], v[36:39], a[48:51], v[160:175]
    v_mfma_f32_32x32x16_bf16 v[176:191], v[36:39], a[176:179], v[176:191]
    s_waitcnt lgkmcnt(4)
    ds_read_b64_tr_b16 v[36:37], v9 offset:28672
    ds_read_b64_tr_b16 v[38:39], v9 offset:29184
    v_mfma_f32_32x32x16_bf16 v[128:143], v[40:43], a[52:55], v[128:143]
    v_mfma_f32_32x32x16_bf16 v[144:159], v[40:43], a[180:183], v[144:159]
    s_waitcnt lgkmcnt(4)
    ds_read_b64_tr_b16 v[40:41], v8 offset:30720
    ds_read_b64_tr_b16 v[42:43], v8 offset:31232
    v_mfma_f32_32x32x16_bf16 v[160:175], v[44:47], a[52:55], v[160:175]
    v_mfma_f32_32x32x16_bf16 v[176:191], v[44:47], a[180:183], v[176:191]
    s_waitcnt lgkmcnt(4)
    ds_read_b64_tr_b16 v[44:45], v9 offset:30720
    ds_read_b64_tr_b16 v[46:47], v9 offset:31232
    v_mfma_f32_32x32x16_bf16 v[128:143], v[32:35], a[56:59], v[128:143]
    v_mfma_f32_32x32x16_bf16 v[144:159], v[32:35], a[184:187], v[144:159]
    s_waitcnt lgkmcnt(4)
    ds_read_b64_tr_b16 v[32:33], v10 offset:0
    ds_read_b64_tr_b16 v[34:35], v10 offset:512
    v_mfma_f32_32x32x16_bf16 v[160:175], v[36:39], a[56:59], v[160:175]
    v_mfma_f32_32x32x16_bf16 v[176:191], v[36:39], a[184:187], v[176:191]
    s_waitcnt lgkmcnt(4)
    ds_read_b64_tr_b16 v[36:37], v11 offset:0
    ds_read_b64_tr_b16 v[38:39], v11 offset:512
    v_mfma_f32_32x32x16_bf16 v[128:143], v[40:43], a[60:63], v[128:143]
    v_mfma_f32_32x32x16_bf16 v[144:159], v[40:43], a[188:191], v[144:159]
    s_waitcnt lgkmcnt(4)
    ds_read_b64_tr_b16 v[40:41], v10 offset:2048
    ds_read_b64_tr_b16 v[42:43], v10 offset:2560
    v_mfma_f32_32x32x16_bf16 v[160:175], v[44:47], a[60:63], v[160:175]
    v_mfma_f32_32x32x16_bf16 v[176:191], v[44:47], a[188:191], v[176:191]
    v_mov_b32 v8, v10
    v_mov_b32 v9, v11
    s_add_u32 s43, s43, 32768
    s_and_b32 s43, s43, 0x1ffff
    v_add_u32 v10, s43, v12
    v_add_u32 v11, s43, v13
    s_waitcnt lgkmcnt(4)
    ds_read_b64_tr_b16 v[44:45], v9 offset:2048
    ds_read_b64_tr_b16 v[46:47], v9 offset:2560
    v_mfma_f32_32x32x16_bf16 v[128:143], v[32:35], a[64:67], v[128:143]
    v_mfma_f32_32x32x16_bf16 v[144:159], v[32:35], a[192:195], v[144:159]
    s_waitcnt lgkmcnt(4)
    ds_read_b64_tr_b16 v[32:33], v8 offset:4096
    ds_read_b64_tr_b16 v[34:35], v8 offset:4608
    v_mfma_f32_32x32x16_bf16 v[160:175], v[36:39], a[64:67], v[160:175]
    v_mfma_f32_32x32x16_bf16 v[176:191], v[36:39], a[192:195], v[176:191]
    s_waitcnt lgkmcnt(4)
    ds_read_b64_tr_b16 v[36:37], v9 offset:4096
    ds_read_b64_tr_b16 v[38:39], v9 offset:4608
    v_mfma_f32_32x32x16_bf16 v[128:143], v[40:43], a[68:71], v[128:143]
    v_mfma_f32_32x32x16_bf16 v[144:159], v[40:43], a[196:199], v[144:159]
    s_waitcnt lgkmcnt(4)
    ds_read_b64_tr_b16 v[40:41], v8 offset:6144
    ds_read_b64_tr_b16 v[42:43], v8 offset:6656
    v_mfma_f32_32x32x16_bf16 v[160:175], v[44:47], a[68:71], v[160:175]
    v_mfma_f32_32x32x16_bf16 v[176:191], v[44:47], a[196:199], v[176:191]
    s_waitcnt lgkmcnt(4)
    ds_read_b64_tr_b16 v[44:45], v9 offset:6144
    ds_read_b64_tr_b16 v[46:47], v9 offset:6656
    v_mfma_f32_32x32x16_bf16 v[128:143], v[32:35], a[72:75], v[128:143]
    v_mfma_f32_32x32x16_bf16 v[144:159], v[32:35], a[200:203], v[144:159]
    s_waitcnt lgkmcnt(4)
    ds_read_b64_tr_b16 v[32:33], v8 offset:8192
    ds_read_b64_tr_b16 v[34:35], v8 offset:8704
    v_mfma_f32_32x32x16_bf16 v[160:175], v[36:39], a[72:75], v[160:175]
    v_mfma_f32_32x32x16_bf16 v[176:191], v[36:39], a[200:203], v[176:191]
    s_waitcnt lgkmcnt(4)
    ds_read_b64_tr_b16 v[36:37], v9 offset:8192
    ds_read_b64_tr_b16 v[38:39], v9 offset:8704
    v_mfma_f32_32x32x16_bf16 v[128:143], v[40:43], a[76:79], v[128:143]
    v_mfma_f32_32x32x16_bf16 v[144:159], v[40:43], a[204:207], v[144:159]
    s_waitcnt lgkmcnt(4)
    ds_read_b64_tr_b16 v[40:41], v8 offset:10240
    ds_read_b64_tr_b16 v[42:43], v8 offset:10752
    v_mfma_f32_32x32x16_bf16 v[160:175], v[44:47], a[76:79], v[160:175]
    v_mfma_f32_32x32x16_bf16 v[176:191], v[44:47], a[204:207], v[176:191]
    s_waitcnt lgkmcnt(4)
    ds_read_b64_tr_b16 v[44:45], v9 offset:10240
    ds_read_b64_tr_b16 v[46:47], v9 offset:10752
    v_mfma_f32_32x32x16_bf16 v[128:143], v[32:35], a[80:83], v[128:143]
    v_mfma_f32_32x32x16_bf16 v[144:159], v[32:35], a[208:211], v[144:159]
    s_waitcnt lgkmcnt(4)
    ds_read_b64_tr_b16 v[32:33], v8 offset:12288
    ds_read_b64_tr_b16 v[34:35], v8 offset:12800
    v_mfma_f32_32x32x16_bf16 v[160:175], v[36:39], a[80:83], v[160:175]
    v_mfma_f32_32x32x16_bf16 v[176:191], v[36:39], a[208:211], v[176:191]
    s_waitcnt lgkmcnt(4)
    ds_read_b64_tr_b16 v[36:37], v9 offset:12288
    ds_read_b64_tr_b16 v[38:39], v9 offset:12800
    v_mfma_f32_32x32x16_bf16 v[128:143], v[40:43], a[84:87], v[128:143]
    v_mfma_f32_32x32x16_bf16 v[144:159], v[40:43], a[212:215], v[144:159]
    s_waitcnt lgkmcnt(4)
    ds_read_b64_tr_b16 v[40:41], v8 offset:14336
    ds_read_b64_tr_b16 v[42:43], v8 offset:14848
    v_mfma_f32_32x32x16_bf16 v[160:175], v[44:47], a[84:87], v[160:175]
    v_mfma_f32_32x32x16_bf16 v[176:191], v[44:47], a[212:215], v[176:191]
    s_waitcnt lgkmcnt(4)
    ds_read_b64_tr_b16 v[44:45], v9 offset:14336
    ds_read_b64_tr_b16 v[46:47], v9 offset:14848
    v_mfma_f32_32x32x16_bf16 v[128:143], v[32:35], a[88:91], v[128:143]
    v_mfma_f32_32x32x16_bf16 v[144:159], v[32:35], a[216:219], v[144:159]
    s_waitcnt lgkmcnt(4)
    ds_read_b64_tr_b16 v[32:33], v8 offset:16384
    ds_read_b64_tr_b16 v[34:35], v8 offset:16896
    v_mfma_f32_32x32x16_bf16 v[160:175], v[36:39], a[88:91], v[160:175]
    v_mfma_f32_32x32x16_bf16 v[176:191], v[36:39], a[216:219], v[176:191]
    s_waitcnt lgkmcnt(4)
    ds_read_b64_tr_b16 v[36:37], v9 offset:16384
    ds_read_b64_tr_b16 v[38:39], v9 offset:16896
    v_mfma_f32_32x32x16_bf16 v[128:143], v[40:43], a[92:95], v[128:143]
    v_mfma_f32_32x32x16_bf16 v[144:159], v[40:43], a[220:223], v[144:159]
    s_waitcnt lgkmcnt(4)
    ds_read_b64_tr_b16 v[40:41], v8 offset:18432
    ds_read_b64_tr_b16 v[42:43], v8 offset:18944
    v_mfma_f32_32x32x16_bf16 v[160:175], v[44:47], a[92:95], v[160:175]
    v_mfma_f32_32x32x16_bf16 v[176:191], v[44:47], a[220:223], v[176:191]
    s_waitcnt vmcnt(28)
    s_barrier
    s_waitcnt lgkmcnt(4)
    ds_read_b64_tr_b16 v[44:45], v9 offset:18432
    ds_read_b64_tr_b16 v[46:47], v9 offset:18944
    v_mfma_f32_32x32x16_bf16 v[128:143], v[32:35], a[96:99], v[128:143]
    v_mfma_f32_32x32x16_bf16 v[144:159], v[32:35], a[224:227], v[144:159]
    s_waitcnt lgkmcnt(4)
    ds_read_b64_tr_b16 v[32:33], v8 offset:20480
    ds_read_b64_tr_b16 v[34:35], v8 offset:20992
    v_mfma_f32_32x32x16_bf16 v[160:175], v[36:39], a[96:99], v[160:175]
    v_mfma_f32_32x32x16_bf16 v[176:191], v[36:39], a[224:227], v[176:191]
    s_waitcnt lgkmcnt(4)
    ds_read_b64_tr_b16 v[36:37], v9 offset:20480
    ds_read_b64_tr_b16 v[38:39], v9 offset:20992
    v_mfma_f32_32x32x16_bf16 v[128:143], v[40:43], a[100:103], v[128:143]
    v_mfma_f32_32x32x16_bf16 v[144:159], v[40:43], a[228:231], v[144:159]
    s_waitcnt lgkmcnt(4)
    ds_read_b64_tr_b16 v[40:41], v8 offset:22528
    ds_read_b64_tr_b16 v[42:43], v8 offset:23040
    v_mfma_f32_32x32x16_bf16 v[160:175], v[44:47], a[100:103], v[160:175]
    v_mfma_f32_32x32x16_bf16 v[176:191], v[44:47], a[228:231], v[176:191]
    s_waitcnt lgkmcnt(4)
    ds_read_b64_tr_b16 v[44:45], v9 offset:22528
    ds_read_b64_tr_b16 v[46:47], v9 offset:23040
    v_mfma_f32_32x32x16_bf16 v[128:143], v[32:35], a[104:107], v[128:143]
    v_mfma_f32_32x32x16_bf16 v[144:159], v[32:35], a[232:235], v[144:159]
    s_waitcnt lgkmcnt(4)
    ds_read_b64_tr_b16 v[32:33], v8 offset:24576
    ds_read_b64_tr_b16 v[34:35], v8 offset:25088
    v_mfma_f32_32x32x16_bf16 v[160:175], v[36:39], a[104:107], v[160:175]
    v_mfma_f32_32x32x16_bf16 v[176:191], v[36:39], a[232:235], v[176:191]
    s_waitcnt lgkmcnt(4)
    ds_read_b64_tr_b16 v[36:37], v9 offset:24576
    ds_read_b64_tr_b16 v[38:39], v9 offset:25088
    v_mfma_f32_32x32x16_bf16 v[128:143], v[40:43], a[108:111], v[128:143]
    v_mfma_f32_32x32x16_bf16 v[144:159], v[40:43], a[236:239], v[144:159]
    s_waitcnt lgkmcnt(4)
    ds_read_b64_tr_b16 v[40:41], v8 offset:26624
    ds_read_b64_tr_b16 v[42:43], v8 offset:27136
    v_mfma_f32_32x32x16_bf16 v[160:175], v[44:47], a[108:111], v[160:175]
    v_mfma_f32_32x32x16_bf16 v[176:191], v[44:47], a[236:239], v[176:191]
    s_waitcnt lgkmcnt(4)
    ds_read_b64_tr_b16 v[44:45], v9 offset:26624
    ds_read_b64_tr_b16 v[46:47], v9 offset:27136
    v_mfma_f32_32x32x16_bf16 v[128:143], v[32:35], a[112:115], v[128:143]
    v_mfma_f32_32x32x16_bf16 v[144:159], v[32:35], a[240:243], v[144:159]
    s_waitcnt lgkmcnt(4)
    ds_read_b64_tr_b16 v[32:33], v8 offset:28672
    ds_read_b64_tr_b16 v[34:35], v8 offset:29184
    v_mfma_f32_32x32x16_bf16 v[160:175], v[36:39], a[112:115], v[160:175]
    v_mfma_f32_32x32x16_bf16 v[176:191], v[36:39], a[240:243], v[176:191]
    s_waitcnt lgkmcnt(4)
    ds_read_b64_tr_b16 v[36:37], v9 offset:28672
    ds_read_b64_tr_b16 v[38:39], v9 offset:29184
    v_mfma_f32_32x32x16_bf16 v[128:143], v[40:43], a[116:119], v[128:143]
    v_mfma_f32_32x32x16_bf16 v[144:159], v[40:43], a[244:247], v[144:159]
    s_waitcnt lgkmcnt(4)
    ds_read_b64_tr_b16 v[40:41], v8 offset:30720
    ds_read_b64_tr_b16 v[42:43], v8 offset:31232
    v_mfma_f32_32x32x16_bf16 v[160:175], v[44:47], a[116:119], v[160:175]
    v_mfma_f32_32x32x16_bf16 v[176:191], v[44:47], a[244:247], v[176:191]
    s_waitcnt lgkmcnt(4)
    ds_read_b64_tr_b16 v[44:45], v9 offset:30720
    ds_read_b64_tr_b16 v[46:47], v9 offset:31232
    v_mfma_f32_32x32x16_bf16 v[128:143], v[32:35], a[120:123], v[128:143]
    v_mfma_f32_32x32x16_bf16 v[144:159], v[32:35], a[248:251], v[144:159]
    s_waitcnt lgkmcnt(4)
    ds_read_b64_tr_b16 v[32:33], v10 offset:0
    ds_read_b64_tr_b16 v[34:35], v10 offset:512
    v_mfma_f32_32x32x16_bf16 v[160:175], v[36:39], a[120:123], v[160:175]
    v_mfma_f32_32x32x16_bf16 v[176:191], v[36:39], a[248:251], v[176:191]
    s_waitcnt lgkmcnt(4)
    ds_read_b64_tr_b16 v[36:37], v11 offset:0
    ds_read_b64_tr_b16 v[38:39], v11 offset:512
    v_mfma_f32_32x32x16_bf16 v[128:143], v[40:43], a[124:127], v[128:143]
    v_mfma_f32_32x32x16_bf16 v[144:159], v[40:43], a[252:255], v[144:159]
    s_waitcnt lgkmcnt(4)
    ds_read_b64_tr_b16 v[40:41], v10 offset:2048
    ds_read_b64_tr_b16 v[42:43], v10 offset:2560
    v_mfma_f32_32x32x16_bf16 v[160:175], v[44:47], a[124:127], v[160:175]
    v_mfma_f32_32x32x16_bf16 v[176:191], v[44:47], a[252:255], v[176:191]
    v_mov_b32 v8, v10
    v_mov_b32 v9, v11
    s_add_u32 s43, s43, 32768
    s_and_b32 s43, s43, 0x1ffff
    v_add_u32 v10, s43, v12
    v_add_u32 v11, s43, v13
    v_mul_f32 v128, s61, v128
    v_mul_f32 v129, s61, v129
    v_cvt_pk_bf16_f32 v48, v128, v129
    v_mul_f32 v130, s61, v130
    v_mul_f32 v131, s61, v131
    v_cvt_pk_bf16_f32 v49, v130, v131
    v_mul_f32 v132, s61, v132
    v_mul_f32 v133, s61, v133
    v_cvt_pk_bf16_f32 v50, v132, v133
    v_mul_f32 v134, s61, v134
    v_mul_f32 v135, s61, v135
    v_cvt_pk_bf16_f32 v51, v134, v135
    v_mul_f32 v136, s61, v136
    v_mul_f32 v137, s61, v137
    v_cvt_pk_bf16_f32 v52, v136, v137
    v_mul_f32 v138, s61, v138
    v_mul_f32 v139, s61, v139
    v_cvt_pk_bf16_f32 v53, v138, v139
    v_mul_f32 v140, s61, v140
    v_mul_f32 v141, s61, v141
    v_cvt_pk_bf16_f32 v54, v140, v141
    v_mul_f32 v142, s61, v142
    v_mul_f32 v143, s61, v143
    v_cvt_pk_bf16_f32 v55, v142, v143
    buffer_store_dwordx4 v[48:51], v15, s[76:79], s62 offen offset:0
    buffer_store_dwordx4 v[52:55], v16, s[76:79], s62 offen offset:0
    v_mul_f32 v144, s61, v144
    v_mul_f32 v145, s61, v145
    v_cvt_pk_bf16_f32 v56, v144, v145
    v_mul_f32 v146, s61, v146
    v_mul_f32 v147, s61, v147
    v_cvt_pk_bf16_f32 v57, v146, v147
    v_mul_f32 v148, s61, v148
    v_mul_f32 v149, s61, v149
    v_cvt_pk_bf16_f32 v58, v148, v149
    v_mul_f32 v150, s61, v150
    v_mul_f32 v151, s61, v151
    v_cvt_pk_bf16_f32 v59, v150, v151
    v_mul_f32 v152, s61, v152
    v_mul_f32 v153, s61, v153
    v_cvt_pk_bf16_f32 v60, v152, v153
    v_mul_f32 v154, s61, v154
    v_mul_f32 v155, s61, v155
    v_cvt_pk_bf16_f32 v61, v154, v155
    v_mul_f32 v156, s61, v156
    v_mul_f32 v157, s61, v157
    v_cvt_pk_bf16_f32 v62, v156, v157
    v_mul_f32 v158, s61, v158
    v_mul_f32 v159, s61, v159
    v_cvt_pk_bf16_f32 v63, v158, v159
    buffer_store_dwordx4 v[56:59], v15, s[76:79], s62 offen offset:512
    buffer_store_dwordx4 v[60:63], v16, s[76:79], s62 offen offset:512
    v_mul_f32 v160, s61, v160
    v_mul_f32 v161, s61, v161
    v_cvt_pk_bf16_f32 v48, v160, v161
    v_mul_f32 v162, s61, v162
    v_mul_f32 v163, s61, v163
    v_cvt_pk_bf16_f32 v49, v162, v163
    v_mul_f32 v164, s61, v164
    v_mul_f32 v165, s61, v165
    v_cvt_pk_bf16_f32 v50, v164, v165
    v_mul_f32 v166, s61, v166
    v_mul_f32 v167, s61, v167
    v_cvt_pk_bf16_f32 v51, v166, v167
    v_mul_f32 v168, s61, v168
    v_mul_f32 v169, s61, v169
    v_cvt_pk_bf16_f32 v52, v168, v169
    v_mul_f32 v170, s61, v170
    v_mul_f32 v171, s61, v171
    v_cvt_pk_bf16_f32 v53, v170, v171
    v_mul_f32 v172, s61, v172
    v_mul_f32 v173, s61, v173
    v_cvt_pk_bf16_f32 v54, v172, v173
    v_mul_f32 v174, s61, v174
    v_mul_f32 v175, s61, v175
    v_cvt_pk_bf16_f32 v55, v174, v175
    buffer_store_dwordx4 v[48:51], v17, s[76:79], s62 offen offset:0
    buffer_store_dwordx4 v[52:55], v18, s[76:79], s62 offen offset:0
    v_mul_f32 v176, s61, v176
    v_mul_f32 v177, s61, v177
    v_cvt_pk_bf16_f32 v56, v176, v177
    v_mul_f32 v178, s61, v178
    v_mul_f32 v179, s61, v179
    v_cvt_pk_bf16_f32 v57, v178, v179
    v_mul_f32 v180, s61, v180
    v_mul_f32 v181, s61, v181
    v_cvt_pk_bf16_f32 v58, v180, v181
    v_mul_f32 v182, s61, v182
    v_mul_f32 v183, s61, v183
    v_cvt_pk_bf16_f32 v59, v182, v183
    v_mul_f32 v184, s61, v184
    v_mul_f32 v185, s61, v185
    v_cvt_pk_bf16_f32 v60, v184, v185
    v_mul_f32 v186, s61, v186
    v_mul_f32 v187, s61, v187
    v_cvt_pk_bf16_f32 v61, v186, v187
    v_mul_f32 v188, s61, v188
    v_mul_f32 v189, s61, v189
    v_cvt_pk_bf16_f32 v62, v188, v189
    v_mul_f32 v190, s61, v190
    v_mul_f32 v191, s61, v191
    v_cvt_pk_bf16_f32 v63, v190, v191
    buffer_store_dwordx4 v[56:59], v17, s[76:79], s62 offen offset:512
    buffer_store_dwordx4 v[60:63], v18, s[76:79], s62 offen offset:512
    s_waitcnt vmcnt(0) lgkmcnt(0)
L_qkv_end:
    s_endpgm
.globl attn_kernel
.p2align 8
.type attn_kernel,@function
attn_kernel:
    s_cmp_ge_u32 s2, 256
    s_cbranch_scc1 L_at8_end
    s_load_dwordx2 s[24:25], s[0:1], 112
    s_load_dwordx2 s[64:65], s[0:1], 40
    s_load_dwordx2 s[66:67], s[0:1], 56
    s_load_dwordx2 s[68:69], s[0:1], 64
    s_load_dwordx2 s[70:71], s[0:1], 72
    v_and_b32 v1, 63, v0
    v_lshrrev_b32 v2, 6, v0
    s_nop 0
    v_readfirstlane_b32 s38, v2
    s_nop 0
    s_and_b32 s39, s38, 3
    s_lshr_b32 s40, s38, 2
    s_and_b32 s30, s2, 7
    s_lshl_b32 s30, s30, 2
    s_lshr_b32 s31, s2, 3
    s_and_b32 s32, s31, 3
    s_add_u32 s41, s30, s32
    s_lshr_b32 s42, s31, 2
    s_lshl_b32 s43, s41, 19
    v_lshlrev_b32 v21, 4, v1
    v_and_b32 v2, 31, v1
    v_lshrrev_b32 v3, 5, v1
    v_lshlrev_b32 v4, 4, v2
    s_lshl_b32 s57, s40, 16
    v_lshl_add_u32 v8, v3, 10, v4
    v_add_u32 v8, s57, v8
    v_add_u32 v9, 16384, v8
    v_lshl_add_u32 v10, v3, 11, v4
    v_add_u32 v10, s57, v10
    v_add_u32 v10, 32768, v10
    v_add_u32 v11, 16384, v10
    v_lshlrev_b32 v5, 2, v3
    v_sub_u32 v20, v2, v5
    v_mov_b32 v24, 0xff800000
    s_lshl_b32 s53, s39, 12
    s_mov_b32 s55, s53
    s_add_u32 s57, s57, s55
    s_mov_b32 s44, 0
    s_lshl_b32 s63, s39, 5
    s_lshl_b32 s30, s40, 6
    s_sub_i32 s63, s63, s30
    s_waitcnt lgkmcnt(0)
    s_add_u32 s8, s24, 20971520
    s_addc_u32 s9, s25, 0
    s_add_u32 s8, s8, s43
    s_addc_u32 s9, s9, 0
    s_and_b32 s9, s9, 0xffff
    s_mov_b32 s10, 524288
    s_mov_b32 s11, 0x00020000
    s_add_u32 s4, s24, 4194304
    s_addc_u32 s5, s25, 0
    s_add_u32 s4, s4, s43
    s_addc_u32 s5, s5, 0
    s_and_b32 s5, s5, 0xffff
    s_mov_b32 s6, 524288
    s_mov_b32 s7, 0x00020000
    s_add_u32 s12, s24, 37748736
    s_addc_u32 s13, s25, 0
    s_add_u32 s12, s12, s43
    s_addc_u32 s13, s13, 0
    s_and_b32 s13, s13, 0xffff
    s_mov_b32 s14, 524288
    s_mov_b32 s15, 0x00020000
    s_add_u32 s16, s24, 54525952
    s_addc_u32 s17, s25, 0
    s_and_b32 s17, s17, 0xffff
    s_mov_b32 s18, 16777216
    s_mov_b32 s19, 0x00020000
    s_sub_u32 s45, 15, s42
    s_mov_b32 s50, s40
    s_lshl_b32 s52, s50, 14
    s_add_u32 s52, s52, s53
    s_add_u32 m0, s57, 0
    s_nop 0
    buffer_load_dwordx4 v21, s[8:11], s52 offen offset:0 lds
    buffer_load_dwordx4 v21, s[8:11], s52 offen offset:1024 lds
    buffer_load_dwordx4 v21, s[8:11], s52 offen offset:2048 lds
    buffer_load_dwordx4 v21, s[8:11], s52 offen offset:3072 lds
    s_lshl_b32 s30, s45, 7
    s_lshl_b32 s31, s39, 5
    s_add_u32 s30, s30, s31
    v_and_b32 v6, 31, v1
    v_lshrrev_b32 v7, 5, v1
    v_add_u32 v6, s30, v6
    v_lshlrev_b32 v6, 4, v6
    v_lshl_add_u32 v6, v7, 15, v6
    s_mov_b32 s56, 0
    buffer_load_dwordx4 a[0:3], v6, s[4:7], s56 offen
    s_mov_b32 s56, 65536
    buffer_load_dwordx4 a[4:7], v6, s[4:7], s56 offen
    s_mov_b32 s56, 131072
    buffer_load_dwordx4 a[8:11], v6, s[4:7], s56 offen
    s_mov_b32 s56, 196608
    buffer_load_dwordx4 a[12:15], v6, s[4:7], s56 offen
    s_mov_b32 s56, 262144
    buffer_load_dwordx4 a[16:19], v6, s[4:7], s56 offen
    s_mov_b32 s56, 327680
    buffer_load_dwordx4 a[20:23], v6, s[4:7], s56 offen
    s_mov_b32 s56, 393216
    buffer_load_dwordx4 a[24:27], v6, s[4:7], s56 offen
    s_mov_b32 s56, 458752
    buffer_load_dwordx4 a[28:31], v6, s[4:7], s56 offen
    s_add_u32 s50, s40, 2
    s_lshl_b32 s52, s50, 14
    s_add_u32 s52, s52, s53
    s_add_u32 m0, s57, 16384
    s_nop 0
    buffer_load_dwordx4 v21, s[8:11], s52 offen offset:0 lds
    buffer_load_dwordx4 v21, s[8:11], s52 offen offset:1024 lds
    buffer_load_dwordx4 v21, s[8:11], s52 offen offset:2048 lds
    buffer_load_dwordx4 v21, s[8:11], s52 offen offset:3072 lds
L_at8_job:
    s_sub_u32 s45, 15, s42
    s_cmp_eq_u32 s44, 0
    s_cselect_b32 s45, s45, s42
    s_lshl_b32 s46, s45, 7
    s_lshl_b32 s47, s39, 5
    s_add_u32 s46, s46, s47
    s_mov_b32 s48, 0
    s_mov_b32 s51, s40
    s_lshl_b32 s54, s51, 14
    s_add_u32 s54, s54, s55
    s_add_u32 m0, s57, 32768
    s_nop 0
    buffer_load_dwordx4 v21, s[12:15], s54 offen offset:0 lds
    buffer_load_dwordx4 v21, s[12:15], s54 offen offset:1024 lds
    buffer_load_dwordx4 v21, s[12:15], s54 offen offset:2048 lds
    buffer_load_dwordx4 v21, s[12:15], s54 offen offset:3072 lds
    v_and_b32 v2, 31, v1
    v_lshrrev_b32 v3, 5, v1
    v_add_u32 v4, s46, v2
    v_lshlrev_b32 v4, 4, v4
    v_lshl_add_u32 v25, v3, 15, v4
    v_accvgpr_write_b32 a32, 0
    v_accvgpr_write_b32 a33, 0
    v_accvgpr_write_b32 a34, 0
    v_accvgpr_write_b32 a35, 0
    v_accvgpr_write_b32 a36, 0
    v_accvgpr_write_b32 a37, 0
    v_accvgpr_write_b32 a38, 0
    v_accvgpr_write_b32 a39, 0
    v_accvgpr_write_b32 a40, 0
    v_accvgpr_write_b32 a41, 0
    v_accvgpr_write_b32 a42, 0
    v_accvgpr_write_b32 a43, 0
    v_accvgpr_write_b32 a44, 0
    v_accvgpr_write_b32 a45, 0
    v_accvgpr_write_b32 a46, 0
    v_accvgpr_write_b32 a47, 0
    v_accvgpr_write_b32 a48, 0
    v_accvgpr_write_b32 a49, 0
    v_accvgpr_write_b32 a50, 0
    v_accvgpr_write_b32 a51, 0
    v_accvgpr_write_b32 a52, 0
    v_accvgpr_write_b32 a53, 0
    v_accvgpr_write_b32 a54, 0
    v_accvgpr_write_b32 a55, 0
    v_accvgpr_write_b32 a56, 0
    v_accvgpr_write_b32 a57, 0
    v_accvgpr_write_b32 a58, 0
    v_accvgpr_write_b32 a59, 0
    v_accvgpr_write_b32 a60, 0
    v_accvgpr_write_b32 a61, 0
    v_accvgpr_write_b32 a62, 0
    v_accvgpr_write_b32 a63, 0
    v_accvgpr_write_b32 a64, 0
    v_accvgpr_write_b32 a65, 0
    v_accvgpr_write_b32 a66, 0
    v_accvgpr_write_b32 a67, 0
    v_accvgpr_write_b32 a68, 0
    v_accvgpr_write_b32 a69, 0
    v_accvgpr_write_b32 a70, 0
    v_accvgpr_write_b32 a71, 0
    v_accvgpr_write_b32 a72, 0
    v_accvgpr_write_b32 a73, 0
    v_accvgpr_write_b32 a74, 0
    v_accvgpr_write_b32 a75, 0
    v_accvgpr_write_b32 a76, 0
    v_accvgpr_write_b32 a77, 0
    v_accvgpr_write_b32 a78, 0
    v_accvgpr_write_b32 a79, 0
    v_accvgpr_write_b32 a80, 0
    v_accvgpr_write_b32 a81, 0
    v_accvgpr_write_b32 a82, 0
    v_accvgpr_write_b32 a83, 0
    v_accvgpr_write_b32 a84, 0
    v_accvgpr_write_b32 a85, 0
    v_accvgpr_write_b32 a86, 0
    v_accvgpr_write_b32 a87, 0
    v_accvgpr_write_b32 a88, 0
    v_accvgpr_write_b32 a89, 0
    v_accvgpr_write_b32 a90, 0
    v_accvgpr_write_b32 a91, 0
    v_accvgpr_write_b32 a92, 0
    v_accvgpr_write_b32 a93, 0
    v_accvgpr_write_b32 a94, 0
    v_accvgpr_write_b32 a95, 0
    v_mov_b32 v112, 0
    v_mov_b32 v113, 0
    v_mov_b32 v114, 0
    v_mov_b32 v115, 0
    v_mov_b32 v116, 0
    v_mov_b32 v117, 0
    v_mov_b32 v118, 0
    v_mov_b32 v119, 0
    v_mov_b32 v120, 0
    v_mov_b32 v121, 0
    v_mov_b32 v122, 0
    v_mov_b32 v123, 0
    v_mov_b32 v124, 0
    v_mov_b32 v125, 0
    v_mov_b32 v126, 0
    v_mov_b32 v127, 0
    v_mov_b32 v12, 0
    v_mov_b32 v13, 0
    s_waitcnt vmcnt(4)
    s_barrier
    ds_read_b128 a[96:99], v8 offset:0
    ds_read_b128 a[100:103], v8 offset:2048
    ds_read_b128 a[104:107], v8 offset:4096
    s_waitcnt lgkmcnt(2)
    ds_read_b128 a[108:111], v8 offset:6144
    v_mfma_f32_32x32x16_bf16 v[32:47], a[96:99], a[0:3], v[112:127]
    s_waitcnt lgkmcnt(2)
    ds_read_b128 a[96:99], v8 offset:8192
    v_mfma_f32_32x32x16_bf16 v[32:47], a[100:103], a[4:7], v[32:47]
    s_waitcnt lgkmcnt(2)
    ds_read_b128 a[100:103], v8 offset:10240
    v_mfma_f32_32x32x16_bf16 v[32:47], a[104:107], a[8:11], v[32:47]
    s_waitcnt lgkmcnt(2)
    ds_read_b128 a[104:107], v8 offset:12288
    v_mfma_f32_32x32x16_bf16 v[32:47], a[108:111], a[12:15], v[32:47]
    s_waitcnt lgkmcnt(2)
    ds_read_b128 a[108:111], v8 offset:14336
    v_mfma_f32_32x32x16_bf16 v[32:47], a[96:99], a[16:19], v[32:47]
    s_waitcnt lgkmcnt(2)
    ds_read_b128 a[96:99], v8 offset:512
    v_mfma_f32_32x32x16_bf16 v[32:47], a[100:103], a[20:23], v[32:47]
    s_waitcnt lgkmcnt(2)
    ds_read_b128 a[100:103], v8 offset:2560
    v_mfma_f32_32x32x16_bf16 v[32:47], a[104:107], a[24:27], v[32:47]
    s_waitcnt lgkmcnt(2)
    ds_read_b128 a[104:107], v8 offset:4608
    v_mfma_f32_32x32x16_bf16 v[32:47], a[108:111], a[28:31], v[32:47]
    s_waitcnt lgkmcnt(2)
    ds_read_b128 a[108:111], v8 offset:6656
    v_mfma_f32_32x32x16_bf16 v[48:63], a[96:99], a[0:3], v[112:127]
    s_waitcnt lgkmcnt(2)
    ds_read_b128 a[96:99], v8 offset:8704
    v_mfma_f32_32x32x16_bf16 v[48:63], a[100:103], a[4:7], v[48:63]
    s_waitcnt lgkmcnt(2)
    ds_read_b128 a[100:103], v8 offset:10752
    v_mfma_f32_32x32x16_bf16 v[48:63], a[104:107], a[8:11], v[48:63]
    s_waitcnt lgkmcnt(2)
    ds_read_b128 a[104:107], v8 offset:12800
    v_mfma_f32_32x32x16_bf16 v[48:63], a[108:111], a[12:15], v[48:63]
    s_waitcnt lgkmcnt(2)
    ds_read_b128 a[108:111], v8 offset:14848
    v_mfma_f32_32x32x16_bf16 v[48:63], a[96:99], a[16:19], v[48:63]
    s_waitcnt lgkmcnt(2)
    v_mfma_f32_32x32x16_bf16 v[48:63], a[100:103], a[20:23], v[48:63]
    s_waitcnt lgkmcnt(1)
    v_mfma_f32_32x32x16_bf16 v[48:63], a[104:107], a[24:27], v[48:63]
    s_waitcnt lgkmcnt(0)
    v_mfma_f32_32x32x16_bf16 v[48:63], a[108:111], a[28:31], v[48:63]
    s_waitcnt vmcnt(0)
    s_barrier
    ds_read_b128 a[96:99], v9 offset:0
    ds_read_b128 a[100:103], v9 offset:2048
    ds_read_b128 a[104:107], v9 offset:4096
    s_cmp_lg_u32 s44, 0
    s_cbranch_scc1 L_at8_nopf
    v_lshlrev_b32 v2, 4, v0
    s_mov_b32 s72, s64
    s_mov_b32 s73, s65
    s_and_b32 s73, s73, 0xffff
    s_mov_b32 s74, 4194304
    s_mov_b32 s75, 0x00020000
    s_mul_i32 s61, s2, 16384
    buffer_load_dwordx4 v[28:31], v2, s[72:75], s61 offen
    s_add_u32 s61, s61, 8192
    buffer_load_dwordx4 v[28:31], v2, s[72:75], s61 offen
    s_mov_b32 s72, s66
    s_mov_b32 s73, s67
    s_and_b32 s73, s73, 0xffff
    s_mov_b32 s74, 1835008
    s_mov_b32 s75, 0x00020000
    s_mul_i32 s61, s2, 8192
    buffer_load_dwordx4 v[28:31], v2, s[72:75], s61 offen
    s_mov_b32 s72, s68
    s_mov_b32 s73, s69
    s_and_b32 s73, s73, 0xffff
    s_mov_b32 s74, 1835008
    s_mov_b32 s75, 0x00020000
    s_mul_i32 s61, s2, 8192
    buffer_load_dwordx4 v[28:31], v2, s[72:75], s61 offen
    s_mov_b32 s72, s70
    s_mov_b32 s73, s71
    s_and_b32 s73, s73, 0xffff
    s_mov_b32 s74, 1835008
    s_mov_b32 s75, 0x00020000
    s_mul_i32 s61, s2, 8192
    buffer_load_dwordx4 v[28:31], v2, s[72:75], s61 offen
L_at8_nopf:
    s_cmp_eq_u32 s45, 0
    s_cbranch_scc0 L_at8_i1
    v_add_u32 v22, s63, v20
    v_cmp_gt_i32 vcc, 0, v22
    s_nop 1
    v_cndmask_b32 v32, v32, v24, vcc
    v_cmp_gt_i32 vcc, 1, v22
    s_nop 1
    v_cndmask_b32 v33, v33, v24, vcc
    v_cmp_gt_i32 vcc, 2, v22
    s_nop 1
    v_cndmask_b32 v34, v34, v24, vcc
    v_cmp_gt_i32 vcc, 3, v22
    s_nop 1
    v_cndmask_b32 v35, v35, v24, vcc
    v_cmp_gt_i32 vcc, 8, v22
    s_nop 1
    v_cndmask_b32 v36, v36, v24, vcc
    v_cmp_gt_i32 vcc, 9, v22
    s_nop 1
    v_cndmask_b32 v37, v37, v24, vcc
    v_cmp_gt_i32 vcc, 10, v22
    s_nop 1
    v_cndmask_b32 v38, v38, v24, vcc
    v_cmp_gt_i32 vcc, 11, v22
    s_nop 1
    v_cndmask_b32 v39, v39, v24, vcc
    v_cmp_gt_i32 vcc, 16, v22
    s_nop 1
    v_cndmask_b32 v40, v40, v24, vcc
    v_cmp_gt_i32 vcc, 17, v22
    s_nop 1
    v_cndmask_b32 v41, v41, v24, vcc
    v_cmp_gt_i32 vcc, 18, v22
    s_nop 1
    v_cndmask_b32 v42, v42, v24, vcc
    v_cmp_gt_i32 vcc, 19, v22
    s_nop 1
    v_cndmask_b32 v43, v43, v24, vcc
    v_cmp_gt_i32 vcc, 24, v22
    s_nop 1
    v_cndmask_b32 v44, v44, v24, vcc
    v_cmp_gt_i32 vcc, 25, v22
    s_nop 1
    v_cndmask_b32 v45, v45, v24, vcc
    v_cmp_gt_i32 vcc, 26, v22
    s_nop 1
    v_cndmask_b32 v46, v46, v24, vcc
    v_cmp_gt_i32 vcc, 27, v22
    s_nop 1
    v_cndmask_b32 v47, v47, v24, vcc
    v_cmp_gt_i32 vcc, 32, v22
    s_nop 1
    v_cndmask_b32 v48, v48, v24, vcc
    v_cmp_gt_i32 vcc, 33, v22
    s_nop 1
    v_cndmask_b32 v49, v49, v24, vcc
    v_cmp_gt_i32 vcc, 34, v22
    s_nop 1
    v_cndmask_b32 v50, v50, v24, vcc
    v_cmp_gt_i32 vcc, 35, v22
    s_nop 1
    v_cndmask_b32 v51, v51, v24, vcc
    v_cmp_gt_i32 vcc, 40, v22
    s_nop 1
    v_cndmask_b32 v52, v52, v24, vcc
    v_cmp_gt_i32 vcc, 41, v22
    s_nop 1
    v_cndmask_b32 v53, v53, v24, vcc
    v_cmp_gt_i32 vcc, 42, v22
    s_nop 1
    v_cndmask_b32 v54, v54, v24, vcc
    v_cmp_gt_i32 vcc, 43, v22
    s_nop 1
    v_cndmask_b32 v55, v55, v24, vcc
    v_cmp_gt_i32 vcc, 48, v22
    s_nop 1
    v_cndmask_b32 v56, v56, v24, vcc
    v_cmp_gt_i32 vcc, 49, v22
    s_nop 1
    v_cndmask_b32 v57, v57, v24, vcc
    v_cmp_gt_i32 vcc, 50, v22
    s_nop 1
    v_cndmask_b32 v58, v58, v24, vcc
    v_cmp_gt_i32 vcc, 51, v22
    s_nop 1
    v_cndmask_b32 v59, v59, v24, vcc
    v_cmp_gt_i32 vcc, 56, v22
    s_nop 1
    v_cndmask_b32 v60, v60, v24, vcc
    v_cmp_gt_i32 vcc, 57, v22
    s_nop 1
    v_cndmask_b32 v61, v61, v24, vcc
    v_cmp_gt_i32 vcc, 58, v22
    s_nop 1
    v_cndmask_b32 v62, v62, v24, vcc
    v_cmp_gt_i32 vcc, 59, v22
    s_nop 1
    v_cndmask_b32 v63, v63, v24, vcc
L_at8_i1:
    v_max3_f32 v14, v32, v33, v34
    v_max3_f32 v14, v14, v35, v36
    v_max3_f32 v14, v14, v37, v38
    v_max3_f32 v14, v14, v39, v40
    v_max3_f32 v14, v14, v41, v42
    v_max3_f32 v14, v14, v43, v44
    v_max3_f32 v14, v14, v45, v46
    v_max_f32 v14, v14, v47
    v_max3_f32 v14, v14, v48, v49
    v_max3_f32 v14, v14, v50, v51
    v_max3_f32 v14, v14, v52, v53
    v_max3_f32 v14, v14, v54, v55
    v_max3_f32 v14, v14, v56, v57
    v_max3_f32 v14, v14, v58, v59
    v_max3_f32 v14, v14, v60, v61
    v_max3_f32 v14, v14, v62, v63
    v_mov_b32 v16, v14
    s_nop 1
    v_permlane32_swap_b32 v14, v16
    v_max_f32 v14, v14, v16
    v_max_f32 v14, 4048155338, v14
    v_sub_f32 v32, v32, v14
    v_sub_f32 v33, v33, v14
    v_sub_f32 v34, v34, v14
    v_sub_f32 v35, v35, v14
    v_sub_f32 v36, v36, v14
    v_sub_f32 v37, v37, v14
    v_sub_f32 v38, v38, v14
    v_sub_f32 v39, v39, v14
    v_sub_f32 v40, v40, v14
    v_sub_f32 v41, v41, v14
    v_sub_f32 v42, v42, v14
    v_sub_f32 v43, v43, v14
    v_sub_f32 v44, v44, v14
    v_sub_f32 v45, v45, v14
    v_sub_f32 v46, v46, v14
    v_sub_f32 v47, v47, v14
    v_sub_f32 v48, v48, v14
    v_sub_f32 v49, v49, v14
    v_sub_f32 v50, v50, v14
    v_sub_f32 v51, v51, v14
    v_sub_f32 v52, v52, v14
    v_sub_f32 v53, v53, v14
    v_sub_f32 v54, v54, v14
    v_sub_f32 v55, v55, v14
    v_sub_f32 v56, v56, v14
    v_sub_f32 v57, v57, v14
    v_sub_f32 v58, v58, v14
    v_sub_f32 v59, v59, v14
    v_sub_f32 v60, v60, v14
    v_sub_f32 v61, v61, v14
    v_sub_f32 v62, v62, v14
    v_sub_f32 v63, v63, v14
    v_sub_f32 v112, v112, v14
    v_sub_f32 v113, v113, v14
    v_sub_f32 v114, v114, v14
    v_sub_f32 v115, v115, v14
    v_sub_f32 v116, v116, v14
    v_sub_f32 v117, v117, v14
    v_sub_f32 v118, v118, v14
    v_sub_f32 v119, v119, v14
    v_sub_f32 v120, v120, v14
    v_sub_f32 v121, v121, v14
    v_sub_f32 v122, v122, v14
    v_sub_f32 v123, v123, v14
    v_sub_f32 v124, v124, v14
    v_sub_f32 v125, v125, v14
    v_sub_f32 v126, v126, v14
    v_sub_f32 v127, v127, v14
    s_cmp_eq_u32 s45, 0
    s_cbranch_scc1 L_at8_cont1
L_at8_loop:
    s_waitcnt lgkmcnt(2)
    ds_read_b128 a[108:111], v9 offset:6144
    s_add_u32 s50, s48, 2
    s_cmp_gt_u32 s50, s45
    s_cselect_b32 s58, 1, 0
    s_lshl_b32 s50, s50, 1
    s_add_u32 s50, s50, s40
    s_lshl_b32 s58, s58, 24
    s_add_u32 s59, s53, s58
    v_exp_f32 v32, v32
    v_exp_f32 v33, v33
    v_exp_f32 v34, v34
    v_mfma_f32_32x32x16_bf16 v[64:79], a[96:99], a[0:3], v[112:127]
    s_waitcnt lgkmcnt(2)
    ds_read_b128 a[96:99], v9 offset:8192
    s_lshl_b32 s52, s50, 14
    v_exp_f32 v35, v35
    v_exp_f32 v36, v36
    v_exp_f32 v37, v37
    v_mfma_f32_32x32x16_bf16 v[64:79], a[100:103], a[4:7], v[64:79]
    s_waitcnt lgkmcnt(2)
    ds_read_b128 a[100:103], v9 offset:10240
    s_add_u32 s52, s52, s59
    v_exp_f32 v38, v38
    v_exp_f32 v39, v39
    v_add_f32 v12, v12, v32
    v_mfma_f32_32x32x16_bf16 v[64:79], a[104:107], a[8:11], v[64:79]
    s_waitcnt lgkmcnt(2)
    ds_read_b128 a[104:107], v9 offset:12288
    v_add_f32 v13, v13, v33
    v_add_f32 v12, v12, v34
    v_add_f32 v13, v13, v35
    v_mfma_f32_32x32x16_bf16 v[64:79], a[108:111], a[12:15], v[64:79]
    s_waitcnt lgkmcnt(2)
    ds_read_b128 a[108:111], v9 offset:14336
    s_add_u32 m0, s57, 0
    v_add_f32 v12, v12, v36
    v_add_f32 v13, v13, v37
    v_add_f32 v12, v12, v38
    v_mfma_f32_32x32x16_bf16 v[64:79], a[96:99], a[16:19], v[64:79]
    s_waitcnt lgkmcnt(2)
    ds_read_b128 a[96:99], v9 offset:512
    v_add_f32 v13, v13, v39
    v_cvt_pk_bf16_f32 v96, v32, v33
    v_cvt_pk_bf16_f32 v97, v34, v35
    v_mfma_f32_32x32x16_bf16 v[64:79], a[100:103], a[20:23], v[64:79]
    s_waitcnt lgkmcnt(2)
    ds_read_b128 a[100:103], v9 offset:2560
    buffer_load_dwordx4 v21, s[8:11], s52 offen offset:0 lds
    v_cvt_pk_bf16_f32 v98, v36, v37
    v_cvt_pk_bf16_f32 v99, v38, v39
    v_exp_f32 v40, v40
    v_mfma_f32_32x32x16_bf16 v[64:79], a[104:107], a[24:27], v[64:79]
    s_waitcnt lgkmcnt(2)
    ds_read_b128 a[104:107], v9 offset:4608
    buffer_load_dwordx4 v21, s[8:11], s52 offen offset:1024 lds
    v_exp_f32 v41, v41
    v_exp_f32 v42, v42
    v_exp_f32 v43, v43
    v_mfma_f32_32x32x16_bf16 v[64:79], a[108:111], a[28:31], v[64:79]
    s_waitcnt lgkmcnt(2)
    ds_read_b128 a[108:111], v9 offset:6656
    v_exp_f32 v44, v44
    v_exp_f32 v45, v45
    v_exp_f32 v46, v46
    v_mfma_f32_32x32x16_bf16 v[80:95], a[96:99], a[0:3], v[112:127]
    s_waitcnt lgkmcnt(2)
    ds_read_b128 a[96:99], v9 offset:8704
    buffer_load_dwordx4 v21, s[8:11], s52 offen offset:2048 lds
    v_exp_f32 v47, v47
    v_add_f32 v12, v12, v40
    v_add_f32 v13, v13, v41
    v_mfma_f32_32x32x16_bf16 v[80:95], a[100:103], a[4:7], v[80:95]
    s_waitcnt lgkmcnt(2)
    ds_read_b128 a[100:103], v9 offset:10752
    v_add_f32 v12, v12, v42
    v_add_f32 v13, v13, v43
    v_add_f32 v12, v12, v44
    v_mfma_f32_32x32x16_bf16 v[80:95], a[104:107], a[8:11], v[80:95]
    s_waitcnt lgkmcnt(2)
    ds_read_b128 a[104:107], v9 offset:12800
    buffer_load_dwordx4 v21, s[8:11], s52 offen offset:3072 lds
    v_add_f32 v13, v13, v45
    v_add_f32 v12, v12, v46
    v_add_f32 v13, v13, v47
    v_max3_f32 v14, v64, v65, v66
    v_max3_f32 v14, v14, v67, v68
    v_mfma_f32_32x32x16_bf16 v[80:95], a[108:111], a[12:15], v[80:95]
    s_waitcnt lgkmcnt(2)
    ds_read_b128 a[108:111], v9 offset:14848
    v_cvt_pk_bf16_f32 v100, v40, v41
    v_cvt_pk_bf16_f32 v101, v42, v43
    v_cvt_pk_bf16_f32 v102, v44, v45
    v_max3_f32 v14, v14, v69, v70
    v_max3_f32 v14, v14, v71, v72
    v_mfma_f32_32x32x16_bf16 v[80:95], a[96:99], a[16:19], v[80:95]
    s_waitcnt lgkmcnt(2)
    v_cvt_pk_bf16_f32 v103, v46, v47
    v_exp_f32 v48, v48
    v_exp_f32 v49, v49
    v_max3_f32 v14, v14, v73, v74
    v_mfma_f32_32x32x16_bf16 v[80:95], a[100:103], a[20:23], v[80:95]
    s_waitcnt vmcnt(4)
    s_waitcnt lgkmcnt(0)
    s_barrier
    ds_read_b128 a[112:115], v10 offset:0
    v_exp_f32 v50, v50
    v_exp_f32 v51, v51
    v_exp_f32 v52, v52
    v_max3_f32 v14, v14, v75, v76
    v_max3_f32 v14, v14, v77, v78
    v_mfma_f32_32x32x16_bf16 v[80:95], a[104:107], a[24:27], v[80:95]
    ds_read_b128 a[116:119], v10 offset:512
    s_add_u32 s51, s48, 1
    v_exp_f32 v53, v53
    v_exp_f32 v54, v54
    v_exp_f32 v55, v55
    v_max_f32 v14, v14, v79
    v_mfma_f32_32x32x16_bf16 v[80:95], a[108:111], a[28:31], v[80:95]
    s_waitcnt lgkmcnt(1)
    ds_read_b128 a[120:123], v10 offset:1024
    ds_read_b128 a[124:127], v10 offset:1536
    s_lshl_b32 s51, s51, 1
    v_add_f32 v12, v12, v48
    v_add_f32 v13, v13, v49
    v_add_f32 v12, v12, v50
    v_mfma_f32_32x32x16_bf16 a[32:47], a[112:115], v[96:99], a[32:47]
    s_waitcnt lgkmcnt(2)
    ds_read_b128 a[112:115], v10 offset:4096
    v_add_f32 v13, v13, v51
    v_add_f32 v12, v12, v52
    v_add_f32 v13, v13, v53
    v_mfma_f32_32x32x16_bf16 a[48:63], a[116:119], v[96:99], a[48:63]
    s_waitcnt lgkmcnt(2)
    ds_read_b128 a[116:119], v10 offset:4608
    s_add_u32 s51, s51, s40
    v_add_f32 v12, v12, v54
    v_add_f32 v13, v13, v55
    v_cvt_pk_bf16_f32 v104, v48, v49
    v_mfma_f32_32x32x16_bf16 a[64:79], a[120:123], v[96:99], a[64:79]
    s_waitcnt lgkmcnt(2)
    ds_read_b128 a[120:123], v10 offset:5120
    s_lshl_b32 s54, s51, 14
    v_cvt_pk_bf16_f32 v105, v50, v51
    v_cvt_pk_bf16_f32 v106, v52, v53
    v_cvt_pk_bf16_f32 v107, v54, v55
    v_mfma_f32_32x32x16_bf16 a[80:95], a[124:127], v[96:99], a[80:95]
    s_waitcnt lgkmcnt(2)
    ds_read_b128 a[124:127], v10 offset:5632
    v_exp_f32 v56, v56
    v_exp_f32 v57, v57
    v_exp_f32 v58, v58
    v_max3_f32 v14, v14, v80, v81
    v_mfma_f32_32x32x16_bf16 a[32:47], a[112:115], v[100:103], a[32:47]
    s_waitcnt lgkmcnt(2)
    ds_read_b128 a[112:115], v10 offset:8192
    s_add_u32 s54, s54, s55
    v_exp_f32 v59, v59
    v_exp_f32 v60, v60
    v_exp_f32 v61, v61
    v_max3_f32 v14, v14, v82, v83
    v_mfma_f32_32x32x16_bf16 a[48:63], a[116:119], v[100:103], a[48:63]
    s_waitcnt lgkmcnt(2)
    ds_read_b128 a[116:119], v10 offset:8704
    v_exp_f32 v62, v62
    v_exp_f32 v63, v63
    v_add_f32 v12, v12, v56
    v_max3_f32 v14, v14, v84, v85
    v_mfma_f32_32x32x16_bf16 a[64:79], a[120:123], v[100:103], a[64:79]
    s_waitcnt lgkmcnt(2)
    ds_read_b128 a[120:123], v10 offset:9216
    s_add_u32 m0, s57, 49152
    v_add_f32 v13, v13, v57
    v_add_f32 v12, v12, v58
    v_add_f32 v13, v13, v59
    v_max3_f32 v14, v14, v86, v87
    v_mfma_f32_32x32x16_bf16 a[80:95], a[124:127], v[100:103], a[80:95]
    s_waitcnt lgkmcnt(2)
    ds_read_b128 a[124:127], v10 offset:9728
    buffer_load_dwordx4 v21, s[12:15], s54 offen offset:0 lds
    v_add_f32 v12, v12, v60
    v_add_f32 v13, v13, v61
    v_add_f32 v12, v12, v62
    v_mfma_f32_32x32x16_bf16 a[32:47], a[112:115], v[104:107], a[32:47]
    s_waitcnt lgkmcnt(2)
    ds_read_b128 a[112:115], v10 offset:12288
    v_add_f32 v13, v13, v63
    v_cvt_pk_bf16_f32 v108, v56, v57
    v_cvt_pk_bf16_f32 v109, v58, v59
    v_max3_f32 v14, v14, v88, v89
    v_mfma_f32_32x32x16_bf16 a[48:63], a[116:119], v[104:107], a[48:63]
    s_waitcnt lgkmcnt(2)
    ds_read_b128 a[116:119], v10 offset:12800
    buffer_load_dwordx4 v21, s[12:15], s54 offen offset:1024 lds
    v_cvt_pk_bf16_f32 v110, v60, v61
    v_cvt_pk_bf16_f32 v111, v62, v63
    v_max3_f32 v14, v14, v90, v91
    v_mfma_f32_32x32x16_bf16 a[64:79], a[120:123], v[104:107], a[64:79]
    s_waitcnt lgkmcnt(2)
    ds_read_b128 a[120:123], v10 offset:13312
    buffer_load_dwordx4 v21, s[12:15], s54 offen offset:2048 lds
    v_max3_f32 v14, v14, v92, v93
    v_mfma_f32_32x32x16_bf16 a[80:95], a[124:127], v[104:107], a[80:95]
    s_waitcnt lgkmcnt(2)
    ds_read_b128 a[124:127], v10 offset:13824
    s_waitcnt vmcnt(3)
    s_barrier
    v_max3_f32 v14, v14, v94, v95
    v_mfma_f32_32x32x16_bf16 a[32:47], a[112:115], v[108:111], a[32:47]
    s_waitcnt lgkmcnt(2)
    ds_read_b128 a[96:99], v8 offset:0
    buffer_load_dwordx4 v21, s[12:15], s54 offen offset:3072 lds
    v_mfma_f32_32x32x16_bf16 a[48:63], a[116:119], v[108:111], a[48:63]
    s_waitcnt lgkmcnt(2)
    ds_read_b128 a[100:103], v8 offset:2048
    v_mfma_f32_32x32x16_bf16 a[64:79], a[120:123], v[108:111], a[64:79]
    s_waitcnt lgkmcnt(2)
    ds_read_b128 a[104:107], v8 offset:4096
    v_mfma_f32_32x32x16_bf16 a[80:95], a[124:127], v[108:111], a[80:95]
    s_add_u32 s48, s48, 1
    s_cmp_eq_u32 s48, s45
    s_cbranch_scc1 L_at8_fix0
L_at8_chk0:
    v_cmp_lt_f32 vcc, 8.0, v14
    s_cbranch_vccnz L_at8_slow0
L_at8_cont0:
    s_cmp_eq_u32 s48, s45
    s_cbranch_scc1 L_at8_fin1
    s_waitcnt lgkmcnt(2)
    ds_read_b128 a[108:111], v8 offset:6144
    s_add_u32 s50, s48, 2
    s_cmp_gt_u32 s50, s45
    s_cselect_b32 s58, 1, 0
    s_lshl_b32 s50, s50, 1
    s_add_u32 s50, s50, s40
    s_lshl_b32 s58, s58, 24
    s_add_u32 s59, s53, s58
    v_exp_f32 v64, v64
    v_exp_f32 v65, v65
    v_exp_f32 v66, v66
    v_mfma_f32_32x32x16_bf16 v[32:47], a[96:99], a[0:3], v[112:127]
    s_waitcnt lgkmcnt(2)
    ds_read_b128 a[96:99], v8 offset:8192
    s_lshl_b32 s52, s50, 14
    v_exp_f32 v67, v67
    v_exp_f32 v68, v68
    v_exp_f32 v69, v69
    v_mfma_f32_32x32x16_bf16 v[32:47], a[100:103], a[4:7], v[32:47]
    s_waitcnt lgkmcnt(2)
    ds_read_b128 a[100:103], v8 offset:10240
    s_add_u32 s52, s52, s59
    v_exp_f32 v70, v70
    v_exp_f32 v71, v71
    v_add_f32 v12, v12, v64
    v_mfma_f32_32x32x16_bf16 v[32:47], a[104:107], a[8:11], v[32:47]
    s_waitcnt lgkmcnt(2)
    ds_read_b128 a[104:107], v8 offset:12288
    v_add_f32 v13, v13, v65
    v_add_f32 v12, v12, v66
    v_add_f32 v13, v13, v67
    v_mfma_f32_32x32x16_bf16 v[32:47], a[108:111], a[12:15], v[32:47]
    s_waitcnt lgkmcnt(2)
    ds_read_b128 a[108:111], v8 offset:14336
    s_add_u32 m0, s57, 16384
    v_add_f32 v12, v12, v68
    v_add_f32 v13, v13, v69
    v_add_f32 v12, v12, v70
    v_mfma_f32_32x32x16_bf16 v[32:47], a[96:99], a[16:19], v[32:47]
    s_waitcnt lgkmcnt(2)
    ds_read_b128 a[96:99], v8 offset:512
    v_add_f32 v13, v13, v71
    v_cvt_pk_bf16_f32 v96, v64, v65
    v_cvt_pk_bf16_f32 v97, v66, v67
    v_mfma_f32_32x32x16_bf16 v[32:47], a[100:103], a[20:23], v[32:47]
    s_waitcnt lgkmcnt(2)
    ds_read_b128 a[100:103], v8 offset:2560
    buffer_load_dwordx4 v21, s[8:11], s52 offen offset:0 lds
    v_cvt_pk_bf16_f32 v98, v68, v69
    v_cvt_pk_bf16_f32 v99, v70, v71
    v_exp_f32 v72, v72
    v_mfma_f32_32x32x16_bf16 v[32:47], a[104:107], a[24:27], v[32:47]
    s_waitcnt lgkmcnt(2)
    ds_read_b128 a[104:107], v8 offset:4608
    buffer_load_dwordx4 v21, s[8:11], s52 offen offset:1024 lds
    v_exp_f32 v73, v73
    v_exp_f32 v74, v74
    v_exp_f32 v75, v75
    v_mfma_f32_32x32x16_bf16 v[32:47], a[108:111], a[28:31], v[32:47]
    s_waitcnt lgkmcnt(2)
    ds_read_b128 a[108:111], v8 offset:6656
    v_exp_f32 v76, v76
    v_exp_f32 v77, v77
    v_exp_f32 v78, v78
    v_mfma_f32_32x32x16_bf16 v[48:63], a[96:99], a[0:3], v[112:127]
    s_waitcnt lgkmcnt(2)
    ds_read_b128 a[96:99], v8 offset:8704
    buffer_load_dwordx4 v21, s[8:11], s52 offen offset:2048 lds
    v_exp_f32 v79, v79
    v_add_f32 v12, v12, v72
    v_add_f32 v13, v13, v73
    v_mfma_f32_32x32x16_bf16 v[48:63], a[100:103], a[4:7], v[48:63]
    s_waitcnt lgkmcnt(2)
    ds_read_b128 a[100:103], v8 offset:10752
    v_add_f32 v12, v12, v74
    v_add_f32 v13, v13, v75
    v_add_f32 v12, v12, v76
    v_mfma_f32_32x32x16_bf16 v[48:63], a[104:107], a[8:11], v[48:63]
    s_waitcnt lgkmcnt(2)
    ds_read_b128 a[104:107], v8 offset:12800
    buffer_load_dwordx4 v21, s[8:11], s52 offen offset:3072 lds
    v_add_f32 v13, v13, v77
    v_add_f32 v12, v12, v78
    v_add_f32 v13, v13, v79
    v_max3_f32 v14, v32, v33, v34
    v_max3_f32 v14, v14, v35, v36
    v_mfma_f32_32x32x16_bf16 v[48:63], a[108:111], a[12:15], v[48:63]
    s_waitcnt lgkmcnt(2)
    ds_read_b128 a[108:111], v8 offset:14848
    v_cvt_pk_bf16_f32 v100, v72, v73
    v_cvt_pk_bf16_f32 v101, v74, v75
    v_cvt_pk_bf16_f32 v102, v76, v77
    v_max3_f32 v14, v14, v37, v38
    v_max3_f32 v14, v14, v39, v40
    v_mfma_f32_32x32x16_bf16 v[48:63], a[96:99], a[16:19], v[48:63]
    s_waitcnt lgkmcnt(2)
    v_cvt_pk_bf16_f32 v103, v78, v79
    v_exp_f32 v80, v80
    v_exp_f32 v81, v81
    v_max3_f32 v14, v14, v41, v42
    v_mfma_f32_32x32x16_bf16 v[48:63], a[100:103], a[20:23], v[48:63]
    s_waitcnt vmcnt(4)
    s_waitcnt lgkmcnt(0)
    s_barrier
    ds_read_b128 a[112:115], v11 offset:0
    v_exp_f32 v82, v82
    v_exp_f32 v83, v83
    v_exp_f32 v84, v84
    v_max3_f32 v14, v14, v43, v44
    v_max3_f32 v14, v14, v45, v46
    v_mfma_f32_32x32x16_bf16 v[48:63], a[104:107], a[24:27], v[48:63]
    ds_read_b128 a[116:119], v11 offset:512
    s_add_u32 s51, s48, 1
    v_exp_f32 v85, v85
    v_exp_f32 v86, v86
    v_exp_f32 v87, v87
    v_max_f32 v14, v14, v47
    v_mfma_f32_32x32x16_bf16 v[48:63], a[108:111], a[28:31], v[48:63]
    s_waitcnt lgkmcnt(1)
    ds_read_b128 a[120:123], v11 offset:1024
    ds_read_b128 a[124:127], v11 offset:1536
    s_lshl_b32 s51, s51, 1
    v_add_f32 v12, v12, v80
    v_add_f32 v13, v13, v81
    v_add_f32 v12, v12, v82
    v_mfma_f32_32x32x16_bf16 a[32:47], a[112:115], v[96:99], a[32:47]
    s_waitcnt lgkmcnt(2)
    ds_read_b128 a[112:115], v11 offset:4096
    v_add_f32 v13, v13, v83
    v_add_f32 v12, v12, v84
    v_add_f32 v13, v13, v85
    v_mfma_f32_32x32x16_bf16 a[48:63], a[116:119], v[96:99], a[48:63]
    s_waitcnt lgkmcnt(2)
    ds_read_b128 a[116:119], v11 offset:4608
    s_add_u32 s51, s51, s40
    v_add_f32 v12, v12, v86
    v_add_f32 v13, v13, v87
    v_cvt_pk_bf16_f32 v104, v80, v81
    v_mfma_f32_32x32x16_bf16 a[64:79], a[120:123], v[96:99], a[64:79]
    s_waitcnt lgkmcnt(2)
    ds_read_b128 a[120:123], v11 offset:5120
    s_lshl_b32 s54, s51, 14
    v_cvt_pk_bf16_f32 v105, v82, v83
    v_cvt_pk_bf16_f32 v106, v84, v85
    v_cvt_pk_bf16_f32 v107, v86, v87
    v_mfma_f32_32x32x16_bf16 a[80:95], a[124:127], v[96:99], a[80:95]
    s_waitcnt lgkmcnt(2)
    ds_read_b128 a[124:127], v11 offset:5632
    v_exp_f32 v88, v88
    v_exp_f32 v89, v89
    v_exp_f32 v90, v90
    v_max3_f32 v14, v14, v48, v49
    v_mfma_f32_32x32x16_bf16 a[32:47], a[112:115], v[100:103], a[32:47]
    s_waitcnt lgkmcnt(2)
    ds_read_b128 a[112:115], v11 offset:8192
    s_add_u32 s54, s54, s55
    v_exp_f32 v91, v91
    v_exp_f32 v92, v92
    v_exp_f32 v93, v93
    v_max3_f32 v14, v14, v50, v51
    v_mfma_f32_32x32x16_bf16 a[48:63], a[116:119], v[100:103], a[48:63]
    s_waitcnt lgkmcnt(2)
    ds_read_b128 a[116:119], v11 offset:8704
    v_exp_f32 v94, v94
    v_exp_f32 v95, v95
    v_add_f32 v12, v12, v88
    v_max3_f32 v14, v14, v52, v53
    v_mfma_f32_32x32x16_bf16 a[64:79], a[120:123], v[100:103], a[64:79]
    s_waitcnt lgkmcnt(2)
    ds_read_b128 a[120:123], v11 offset:9216
    s_add_u32 m0, s57, 32768
    v_add_f32 v13, v13, v89
    v_add_f32 v12, v12, v90
    v_add_f32 v13, v13, v91
    v_max3_f32 v14, v14, v54, v55
    v_mfma_f32_32x32x16_bf16 a[80:95], a[124:127], v[100:103], a[80:95]
    s_waitcnt lgkmcnt(2)
    ds_read_b128 a[124:127], v11 offset:9728
    buffer_load_dwordx4 v21, s[12:15], s54 offen offset:0 lds
    v_add_f32 v12, v12, v92
    v_add_f32 v13, v13, v93
    v_add_f32 v12, v12, v94
    v_mfma_f32_32x32x16_bf16 a[32:47], a[112:115], v[104:107], a[32:47]
    s_waitcnt lgkmcnt(2)
    ds_read_b128 a[112:115], v11 offset:12288
    v_add_f32 v13, v13, v95
    v_cvt_pk_bf16_f32 v108, v88, v89
    v_cvt_pk_bf16_f32 v109, v90, v91
    v_max3_f32 v14, v14, v56, v57
    v_mfma_f32_32x32x16_bf16 a[48:63], a[116:119], v[104:107], a[48:63]
    s_waitcnt lgkmcnt(2)
    ds_read_b128 a[116:119], v11 offset:12800
    buffer_load_dwordx4 v21, s[12:15], s54 offen offset:1024 lds
    v_cvt_pk_bf16_f32 v110, v92, v93
    v_cvt_pk_bf16_f32 v111, v94, v95
    v_max3_f32 v14, v14, v58, v59
    v_mfma_f32_32x32x16_bf16 a[64:79], a[120:123], v[104:107], a[64:79]
    s_waitcnt lgkmcnt(2)
    ds_read_b128 a[120:123], v11 offset:13312
    buffer_load_dwordx4 v21, s[12:15], s54 offen offset:2048 lds
    v_max3_f32 v14, v14, v60, v61
    v_mfma_f32_32x32x16_bf16 a[80:95], a[124:127], v[104:107], a[80:95]
    s_waitcnt lgkmcnt(2)
    ds_read_b128 a[124:127], v11 offset:13824
    s_waitcnt vmcnt(3)
    s_barrier
    v_max3_f32 v14, v14, v62, v63
    v_mfma_f32_32x32x16_bf16 a[32:47], a[112:115], v[108:111], a[32:47]
    s_waitcnt lgkmcnt(2)
    ds_read_b128 a[96:99], v9 offset:0
    buffer_load_dwordx4 v21, s[12:15], s54 offen offset:3072 lds
    v_mfma_f32_32x32x16_bf16 a[48:63], a[116:119], v[108:111], a[48:63]
    s_waitcnt lgkmcnt(2)
    ds_read_b128 a[100:103], v9 offset:2048
    v_mfma_f32_32x32x16_bf16 a[64:79], a[120:123], v[108:111], a[64:79]
    s_waitcnt lgkmcnt(2)
    ds_read_b128 a[104:107], v9 offset:4096
    v_mfma_f32_32x32x16_bf16 a[80:95], a[124:127], v[108:111], a[80:95]
    s_add_u32 s48, s48, 1
    s_cmp_eq_u32 s48, s45
    s_cbranch_scc1 L_at8_fix1
L_at8_chk1:
    v_cmp_lt_f32 vcc, 8.0, v14
    s_cbranch_vccnz L_at8_slow1
L_at8_cont1:
    s_cmp_eq_u32 s48, s45
    s_cbranch_scc0 L_at8_loop
    s_waitcnt vmcnt(0) lgkmcnt(0)
    s_barrier
    ds_read_b128 a[112:115], v10 offset:0
    ds_read_b128 a[116:119], v10 offset:512
    ds_read_b128 a[120:123], v10 offset:1024
    v_exp_f32 v32, v32
    v_exp_f32 v33, v33
    v_exp_f32 v34, v34
    v_exp_f32 v35, v35
    v_exp_f32 v36, v36
    v_exp_f32 v37, v37
    v_exp_f32 v38, v38
    v_exp_f32 v39, v39
    v_add_f32 v12, v12, v32
    v_add_f32 v13, v13, v33
    v_add_f32 v12, v12, v34
    v_add_f32 v13, v13, v35
    v_add_f32 v12, v12, v36
    v_add_f32 v13, v13, v37
    v_add_f32 v12, v12, v38
    v_add_f32 v13, v13, v39
    v_cvt_pk_bf16_f32 v96, v32, v33
    v_cvt_pk_bf16_f32 v97, v34, v35
    v_cvt_pk_bf16_f32 v98, v36, v37
    v_cvt_pk_bf16_f32 v99, v38, v39
    s_waitcnt lgkmcnt(2)
    ds_read_b128 a[124:127], v10 offset:1536
    v_exp_f32 v40, v40
    v_exp_f32 v41, v41
    v_exp_f32 v42, v42
    v_exp_f32 v43, v43
    v_exp_f32 v44, v44
    v_exp_f32 v45, v45
    v_mfma_f32_32x32x16_bf16 a[32:47], a[112:115], v[96:99], a[32:47]
    s_waitcnt lgkmcnt(2)
    ds_read_b128 a[112:115], v10 offset:4096
    v_exp_f32 v46, v46
    v_exp_f32 v47, v47
    v_add_f32 v12, v12, v40
    v_add_f32 v13, v13, v41
    v_add_f32 v12, v12, v42
    v_mfma_f32_32x32x16_bf16 a[48:63], a[116:119], v[96:99], a[48:63]
    s_waitcnt lgkmcnt(2)
    ds_read_b128 a[116:119], v10 offset:4608
    v_add_f32 v13, v13, v43
    v_add_f32 v12, v12, v44
    v_add_f32 v13, v13, v45
    v_add_f32 v12, v12, v46
    v_add_f32 v13, v13, v47
    v_cvt_pk_bf16_f32 v100, v40, v41
    v_mfma_f32_32x32x16_bf16 a[64:79], a[120:123], v[96:99], a[64:79]
    s_waitcnt lgkmcnt(2)
    ds_read_b128 a[120:123], v10 offset:5120
    v_cvt_pk_bf16_f32 v101, v42, v43
    v_cvt_pk_bf16_f32 v102, v44, v45
    v_cvt_pk_bf16_f32 v103, v46, v47
    v_exp_f32 v48, v48
    v_exp_f32 v49, v49
    v_mfma_f32_32x32x16_bf16 a[80:95], a[124:127], v[96:99], a[80:95]
    s_waitcnt lgkmcnt(2)
    ds_read_b128 a[124:127], v10 offset:5632
    v_exp_f32 v50, v50
    v_exp_f32 v51, v51
    v_exp_f32 v52, v52
    v_exp_f32 v53, v53
    v_exp_f32 v54, v54
    v_exp_f32 v55, v55
    v_mfma_f32_32x32x16_bf16 a[32:47], a[112:115], v[100:103], a[32:47]
    s_waitcnt lgkmcnt(2)
    ds_read_b128 a[112:115], v10 offset:8192
    v_add_f32 v12, v12, v48
    v_add_f32 v13, v13, v49
    v_add_f32 v12, v12, v50
    v_add_f32 v13, v13, v51
    v_add_f32 v12, v12, v52
    v_mfma_f32_32x32x16_bf16 a[48:63], a[116:119], v[100:103], a[48:63]
    s_waitcnt lgkmcnt(2)
    ds_read_b128 a[116:119], v10 offset:8704
    v_add_f32 v13, v13, v53
    v_add_f32 v12, v12, v54
    v_add_f32 v13, v13, v55
    v_cvt_pk_bf16_f32 v104, v48, v49
    v_cvt_pk_bf16_f32 v105, v50, v51
    v_cvt_pk_bf16_f32 v106, v52, v53
    v_mfma_f32_32x32x16_bf16 a[64:79], a[120:123], v[100:103], a[64:79]
    s_waitcnt lgkmcnt(2)
    ds_read_b128 a[120:123], v10 offset:9216
    v_cvt_pk_bf16_f32 v107, v54, v55
    v_exp_f32 v56, v56
    v_exp_f32 v57, v57
    v_exp_f32 v58, v58
    v_exp_f32 v59, v59
    v_mfma_f32_32x32x16_bf16 a[80:95], a[124:127], v[100:103], a[80:95]
    s_waitcnt lgkmcnt(2)
    ds_read_b128 a[124:127], v10 offset:9728
    v_exp_f32 v60, v60
    v_exp_f32 v61, v61
    v_exp_f32 v62, v62
    v_exp_f32 v63, v63
    v_add_f32 v12, v12, v56
    v_add_f32 v13, v13, v57
    v_mfma_f32_32x32x16_bf16 a[32:47], a[112:115], v[104:107], a[32:47]
    s_waitcnt lgkmcnt(2)
    ds_read_b128 a[112:115], v10 offset:12288
    v_add_f32 v12, v12, v58
    v_add_f32 v13, v13, v59
    v_add_f32 v12, v12, v60
    v_add_f32 v13, v13, v61
    v_add_f32 v12, v12, v62
    v_mfma_f32_32x32x16_bf16 a[48:63], a[116:119], v[104:107], a[48:63]
    s_waitcnt lgkmcnt(2)
    ds_read_b128 a[116:119], v10 offset:12800
    v_add_f32 v13, v13, v63
    v_cvt_pk_bf16_f32 v108, v56, v57
    v_cvt_pk_bf16_f32 v109, v58, v59
    v_cvt_pk_bf16_f32 v110, v60, v61
    v_cvt_pk_bf16_f32 v111, v62, v63
    v_mfma_f32_32x32x16_bf16 a[64:79], a[120:123], v[104:107], a[64:79]
    s_waitcnt lgkmcnt(2)
    ds_read_b128 a[120:123], v10 offset:13312
    v_mfma_f32_32x32x16_bf16 a[80:95], a[124:127], v[104:107], a[80:95]
    s_waitcnt lgkmcnt(2)
    ds_read_b128 a[124:127], v10 offset:13824
    v_mfma_f32_32x32x16_bf16 a[32:47], a[112:115], v[108:111], a[32:47]
    s_waitcnt lgkmcnt(2)
    v_mfma_f32_32x32x16_bf16 a[48:63], a[116:119], v[108:111], a[48:63]
    s_waitcnt lgkmcnt(1)
    v_mfma_f32_32x32x16_bf16 a[64:79], a[120:123], v[108:111], a[64:79]
    s_waitcnt lgkmcnt(0)
    v_mfma_f32_32x32x16_bf16 a[80:95], a[124:127], v[108:111], a[80:95]
    s_branch L_at8_comb
L_at8_fin1:
    s_waitcnt vmcnt(0) lgkmcnt(0)
    s_barrier
    ds_read_b128 a[112:115], v11 offset:0
    ds_read_b128 a[116:119], v11 offset:512
    ds_read_b128 a[120:123], v11 offset:1024
    v_exp_f32 v64, v64
    v_exp_f32 v65, v65
    v_exp_f32 v66, v66
    v_exp_f32 v67, v67
    v_exp_f32 v68, v68
    v_exp_f32 v69, v69
    v_exp_f32 v70, v70
    v_exp_f32 v71, v71
    v_add_f32 v12, v12, v64
    v_add_f32 v13, v13, v65
    v_add_f32 v12, v12, v66
    v_add_f32 v13, v13, v67
    v_add_f32 v12, v12, v68
    v_add_f32 v13, v13, v69
    v_add_f32 v12, v12, v70
    v_add_f32 v13, v13, v71
    v_cvt_pk_bf16_f32 v96, v64, v65
    v_cvt_pk_bf16_f32 v97, v66, v67
    v_cvt_pk_bf16_f32 v98, v68, v69
    v_cvt_pk_bf16_f32 v99, v70, v71
    s_waitcnt lgkmcnt(2)
    ds_read_b128 a[124:127], v11 offset:1536
    v_exp_f32 v72, v72
    v_exp_f32 v73, v73
    v_exp_f32 v74, v74
    v_exp_f32 v75, v75
    v_exp_f32 v76, v76
    v_exp_f32 v77, v77
    v_mfma_f32_32x32x16_bf16 a[32:47], a[112:115], v[96:99], a[32:47]
    s_waitcnt lgkmcnt(2)
    ds_read_b128 a[112:115], v11 offset:4096
    v_exp_f32 v78, v78
    v_exp_f32 v79, v79
    v_add_f32 v12, v12, v72
    v_add_f32 v13, v13, v73
    v_add_f32 v12, v12, v74
    v_mfma_f32_32x32x16_bf16 a[48:63], a[116:119], v[96:99], a[48:63]
    s_waitcnt lgkmcnt(2)
    ds_read_b128 a[116:119], v11 offset:4608
    v_add_f32 v13, v13, v75
    v_add_f32 v12, v12, v76
    v_add_f32 v13, v13, v77
    v_add_f32 v12, v12, v78
    v_add_f32 v13, v13, v79
    v_cvt_pk_bf16_f32 v100, v72, v73
    v_mfma_f32_32x32x16_bf16 a[64:79], a[120:123], v[96:99], a[64:79]
    s_waitcnt lgkmcnt(2)
    ds_read_b128 a[120:123], v11 offset:5120
    v_cvt_pk_bf16_f32 v101, v74, v75
    v_cvt_pk_bf16_f32 v102, v76, v77
    v_cvt_pk_bf16_f32 v103, v78, v79
    v_exp_f32 v80, v80
    v_exp_f32 v81, v81
    v_mfma_f32_32x32x16_bf16 a[80:95], a[124:127], v[96:99], a[80:95]
    s_waitcnt lgkmcnt(2)
    ds_read_b128 a[124:127], v11 offset:5632
    v_exp_f32 v82, v82
    v_exp_f32 v83, v83
    v_exp_f32 v84, v84
    v_exp_f32 v85, v85
    v_exp_f32 v86, v86
    v_exp_f32 v87, v87
    v_mfma_f32_32x32x16_bf16 a[32:47], a[112:115], v[100:103], a[32:47]
    s_waitcnt lgkmcnt(2)
    ds_read_b128 a[112:115], v11 offset:8192
    v_add_f32 v12, v12, v80
    v_add_f32 v13, v13, v81
    v_add_f32 v12, v12, v82
    v_add_f32 v13, v13, v83
    v_add_f32 v12, v12, v84
    v_mfma_f32_32x32x16_bf16 a[48:63], a[116:119], v[100:103], a[48:63]
    s_waitcnt lgkmcnt(2)
    ds_read_b128 a[116:119], v11 offset:8704
    v_add_f32 v13, v13, v85
    v_add_f32 v12, v12, v86
    v_add_f32 v13, v13, v87
    v_cvt_pk_bf16_f32 v104, v80, v81
    v_cvt_pk_bf16_f32 v105, v82, v83
    v_cvt_pk_bf16_f32 v106, v84, v85
    v_mfma_f32_32x32x16_bf16 a[64:79], a[120:123], v[100:103], a[64:79]
    s_waitcnt lgkmcnt(2)
    ds_read_b128 a[120:123], v11 offset:9216
    v_cvt_pk_bf16_f32 v107, v86, v87
    v_exp_f32 v88, v88
    v_exp_f32 v89, v89
    v_exp_f32 v90, v90
    v_exp_f32 v91, v91
    v_mfma_f32_32x32x16_bf16 a[80:95], a[124:127], v[100:103], a[80:95]
    s_waitcnt lgkmcnt(2)
    ds_read_b128 a[124:127], v11 offset:9728
    v_exp_f32 v92, v92
    v_exp_f32 v93, v93
    v_exp_f32 v94, v94
    v_exp_f32 v95, v95
    v_add_f32 v12, v12, v88
    v_add_f32 v13, v13, v89
    v_mfma_f32_32x32x16_bf16 a[32:47], a[112:115], v[104:107], a[32:47]
    s_waitcnt lgkmcnt(2)
    ds_read_b128 a[112:115], v11 offset:12288
    v_add_f32 v12, v12, v90
    v_add_f32 v13, v13, v91
    v_add_f32 v12, v12, v92
    v_add_f32 v13, v13, v93
    v_add_f32 v12, v12, v94
    v_mfma_f32_32x32x16_bf16 a[48:63], a[116:119], v[104:107], a[48:63]
    s_waitcnt lgkmcnt(2)
    ds_read_b128 a[116:119], v11 offset:12800
    v_add_f32 v13, v13, v95
    v_cvt_pk_bf16_f32 v108, v88, v89
    v_cvt_pk_bf16_f32 v109, v90, v91
    v_cvt_pk_bf16_f32 v110, v92, v93
    v_cvt_pk_bf16_f32 v111, v94, v95
    v_mfma_f32_32x32x16_bf16 a[64:79], a[120:123], v[104:107], a[64:79]
    s_waitcnt lgkmcnt(2)
    ds_read_b128 a[120:123], v11 offset:13312
    v_mfma_f32_32x32x16_bf16 a[80:95], a[124:127], v[104:107], a[80:95]
    s_waitcnt lgkmcnt(2)
    ds_read_b128 a[124:127], v11 offset:13824
    v_mfma_f32_32x32x16_bf16 a[32:47], a[112:115], v[108:111], a[32:47]
    s_waitcnt lgkmcnt(2)
    v_mfma_f32_32x32x16_bf16 a[48:63], a[116:119], v[108:111], a[48:63]
    s_waitcnt lgkmcnt(1)
    v_mfma_f32_32x32x16_bf16 a[64:79], a[120:123], v[108:111], a[64:79]
    s_waitcnt lgkmcnt(0)
    v_mfma_f32_32x32x16_bf16 a[80:95], a[124:127], v[108:111], a[80:95]
    s_branch L_at8_comb
L_at8_fix0:
    v_add_u32 v22, s63, v20
    v_cmp_gt_i32 vcc, 0, v22
    s_nop 1
    v_cndmask_b32 v64, v64, v24, vcc
    v_cmp_gt_i32 vcc, 1, v22
    s_nop 1
    v_cndmask_b32 v65, v65, v24, vcc
    v_cmp_gt_i32 vcc, 2, v22
    s_nop 1
    v_cndmask_b32 v66, v66, v24, vcc
    v_cmp_gt_i32 vcc, 3, v22
    s_nop 1
    v_cndmask_b32 v67, v67, v24, vcc
    v_cmp_gt_i32 vcc, 8, v22
    s_nop 1
    v_cndmask_b32 v68, v68, v24, vcc
    v_cmp_gt_i32 vcc, 9, v22
    s_nop 1
    v_cndmask_b32 v69, v69, v24, vcc
    v_cmp_gt_i32 vcc, 10, v22
    s_nop 1
    v_cndmask_b32 v70, v70, v24, vcc
    v_cmp_gt_i32 vcc, 11, v22
    s_nop 1
    v_cndmask_b32 v71, v71, v24, vcc
    v_cmp_gt_i32 vcc, 16, v22
    s_nop 1
    v_cndmask_b32 v72, v72, v24, vcc
    v_cmp_gt_i32 vcc, 17, v22
    s_nop 1
    v_cndmask_b32 v73, v73, v24, vcc
    v_cmp_gt_i32 vcc, 18, v22
    s_nop 1
    v_cndmask_b32 v74, v74, v24, vcc
    v_cmp_gt_i32 vcc, 19, v22
    s_nop 1
    v_cndmask_b32 v75, v75, v24, vcc
    v_cmp_gt_i32 vcc, 24, v22
    s_nop 1
    v_cndmask_b32 v76, v76, v24, vcc
    v_cmp_gt_i32 vcc, 25, v22
    s_nop 1
    v_cndmask_b32 v77, v77, v24, vcc
    v_cmp_gt_i32 vcc, 26, v22
    s_nop 1
    v_cndmask_b32 v78, v78, v24, vcc
    v_cmp_gt_i32 vcc, 27, v22
    s_nop 1
    v_cndmask_b32 v79, v79, v24, vcc
    v_cmp_gt_i32 vcc, 32, v22
    s_nop 1
    v_cndmask_b32 v80, v80, v24, vcc
    v_cmp_gt_i32 vcc, 33, v22
    s_nop 1
    v_cndmask_b32 v81, v81, v24, vcc
    v_cmp_gt_i32 vcc, 34, v22
    s_nop 1
    v_cndmask_b32 v82, v82, v24, vcc
    v_cmp_gt_i32 vcc, 35, v22
    s_nop 1
    v_cndmask_b32 v83, v83, v24, vcc
    v_cmp_gt_i32 vcc, 40, v22
    s_nop 1
    v_cndmask_b32 v84, v84, v24, vcc
    v_cmp_gt_i32 vcc, 41, v22
    s_nop 1
    v_cndmask_b32 v85, v85, v24, vcc
    v_cmp_gt_i32 vcc, 42, v22
    s_nop 1
    v_cndmask_b32 v86, v86, v24, vcc
    v_cmp_gt_i32 vcc, 43, v22
    s_nop 1
    v_cndmask_b32 v87, v87, v24, vcc
    v_cmp_gt_i32 vcc, 48, v22
    s_nop 1
    v_cndmask_b32 v88, v88, v24, vcc
    v_cmp_gt_i32 vcc, 49, v22
    s_nop 1
    v_cndmask_b32 v89, v89, v24, vcc
    v_cmp_gt_i32 vcc, 50, v22
    s_nop 1
    v_cndmask_b32 v90, v90, v24, vcc
    v_cmp_gt_i32 vcc, 51, v22
    s_nop 1
    v_cndmask_b32 v91, v91, v24, vcc
    v_cmp_gt_i32 vcc, 56, v22
    s_nop 1
    v_cndmask_b32 v92, v92, v24, vcc
    v_cmp_gt_i32 vcc, 57, v22
    s_nop 1
    v_cndmask_b32 v93, v93, v24, vcc
    v_cmp_gt_i32 vcc, 58, v22
    s_nop 1
    v_cndmask_b32 v94, v94, v24, vcc
    v_cmp_gt_i32 vcc, 59, v22
    s_nop 1
    v_cndmask_b32 v95, v95, v24, vcc
    v_max3_f32 v14, v64, v65, v66
    v_max3_f32 v14, v14, v67, v68
    v_max3_f32 v14, v14, v69, v70
    v_max3_f32 v14, v14, v71, v72
    v_max3_f32 v14, v14, v73, v74
    v_max3_f32 v14, v14, v75, v76
    v_max3_f32 v14, v14, v77, v78
    v_max_f32 v14, v14, v79
    v_max3_f32 v14, v14, v80, v81
    v_max3_f32 v14, v14, v82, v83
    v_max3_f32 v14, v14, v84, v85
    v_max3_f32 v14, v14, v86, v87
    v_max3_f32 v14, v14, v88, v89
    v_max3_f32 v14, v14, v90, v91
    v_max3_f32 v14, v14, v92, v93
    v_max3_f32 v14, v14, v94, v95
    s_branch L_at8_chk0
L_at8_slow0:
    v_mov_b32 v16, v14
    s_nop 1
    v_permlane32_swap_b32 v14, v16
    v_max_f32 v14, v14, v16
    v_max_f32 v14, 0, v14
    v_sub_f32 v64, v64, v14
    v_sub_f32 v65, v65, v14
    v_sub_f32 v66, v66, v14
    v_sub_f32 v67, v67, v14
    v_sub_f32 v68, v68, v14
    v_sub_f32 v69, v69, v14
    v_sub_f32 v70, v70, v14
    v_sub_f32 v71, v71, v14
    v_sub_f32 v72, v72, v14
    v_sub_f32 v73, v73, v14
    v_sub_f32 v74, v74, v14
    v_sub_f32 v75, v75, v14
    v_sub_f32 v76, v76, v14
    v_sub_f32 v77, v77, v14
    v_sub_f32 v78, v78, v14
    v_sub_f32 v79, v79, v14
    v_sub_f32 v80, v80, v14
    v_sub_f32 v81, v81, v14
    v_sub_f32 v82, v82, v14
    v_sub_f32 v83, v83, v14
    v_sub_f32 v84, v84, v14
    v_sub_f32 v85, v85, v14
    v_sub_f32 v86, v86, v14
    v_sub_f32 v87, v87, v14
    v_sub_f32 v88, v88, v14
    v_sub_f32 v89, v89, v14
    v_sub_f32 v90, v90, v14
    v_sub_f32 v91, v91, v14
    v_sub_f32 v92, v92, v14
    v_sub_f32 v93, v93, v14
    v_sub_f32 v94, v94, v14
    v_sub_f32 v95, v95, v14
    v_sub_f32 v112, v112, v14
    v_sub_f32 v113, v113, v14
    v_sub_f32 v114, v114, v14
    v_sub_f32 v115, v115, v14
    v_sub_f32 v116, v116, v14
    v_sub_f32 v117, v117, v14
    v_sub_f32 v118, v118, v14
    v_sub_f32 v119, v119, v14
    v_sub_f32 v120, v120, v14
    v_sub_f32 v121, v121, v14
    v_sub_f32 v122, v122, v14
    v_sub_f32 v123, v123, v14
    v_sub_f32 v124, v124, v14
    v_sub_f32 v125, v125, v14
    v_sub_f32 v126, v126, v14
    v_sub_f32 v127, v127, v14
    v_exp_f32 v16, -v14
    s_nop 0
    v_mul_f32 v12, v12, v16
    v_mul_f32 v13, v13, v16
    v_accvgpr_read_b32 v17, a32
    v_mul_f32 v17, v17, v16
    v_accvgpr_write_b32 a32, v17
    v_accvgpr_read_b32 v17, a33
    v_mul_f32 v17, v17, v16
    v_accvgpr_write_b32 a33, v17
    v_accvgpr_read_b32 v17, a34
    v_mul_f32 v17, v17, v16
    v_accvgpr_write_b32 a34, v17
    v_accvgpr_read_b32 v17, a35
    v_mul_f32 v17, v17, v16
    v_accvgpr_write_b32 a35, v17
    v_accvgpr_read_b32 v17, a36
    v_mul_f32 v17, v17, v16
    v_accvgpr_write_b32 a36, v17
    v_accvgpr_read_b32 v17, a37
    v_mul_f32 v17, v17, v16
    v_accvgpr_write_b32 a37, v17
    v_accvgpr_read_b32 v17, a38
    v_mul_f32 v17, v17, v16
    v_accvgpr_write_b32 a38, v17
    v_accvgpr_read_b32 v17, a39
    v_mul_f32 v17, v17, v16
    v_accvgpr_write_b32 a39, v17
    v_accvgpr_read_b32 v17, a40
    v_mul_f32 v17, v17, v16
    v_accvgpr_write_b32 a40, v17
    v_accvgpr_read_b32 v17, a41
    v_mul_f32 v17, v17, v16
    v_accvgpr_write_b32 a41, v17
    v_accvgpr_read_b32 v17, a42
    v_mul_f32 v17, v17, v16
    v_accvgpr_write_b32 a42, v17
    v_accvgpr_read_b32 v17, a43
    v_mul_f32 v17, v17, v16
    v_accvgpr_write_b32 a43, v17
    v_accvgpr_read_b32 v17, a44
    v_mul_f32 v17, v17, v16
    v_accvgpr_write_b32 a44, v17
    v_accvgpr_read_b32 v17, a45
    v_mul_f32 v17, v17, v16
    v_accvgpr_write_b32 a45, v17
    v_accvgpr_read_b32 v17, a46
    v_mul_f32 v17, v17, v16
    v_accvgpr_write_b32 a46, v17
    v_accvgpr_read_b32 v17, a47
    v_mul_f32 v17, v17, v16
    v_accvgpr_write_b32 a47, v17
    v_accvgpr_read_b32 v17, a48
    v_mul_f32 v17, v17, v16
    v_accvgpr_write_b32 a48, v17
    v_accvgpr_read_b32 v17, a49
    v_mul_f32 v17, v17, v16
    v_accvgpr_write_b32 a49, v17
    v_accvgpr_read_b32 v17, a50
    v_mul_f32 v17, v17, v16
    v_accvgpr_write_b32 a50, v17
    v_accvgpr_read_b32 v17, a51
    v_mul_f32 v17, v17, v16
    v_accvgpr_write_b32 a51, v17
    v_accvgpr_read_b32 v17, a52
    v_mul_f32 v17, v17, v16
    v_accvgpr_write_b32 a52, v17
    v_accvgpr_read_b32 v17, a53
    v_mul_f32 v17, v17, v16
    v_accvgpr_write_b32 a53, v17
    v_accvgpr_read_b32 v17, a54
    v_mul_f32 v17, v17, v16
    v_accvgpr_write_b32 a54, v17
    v_accvgpr_read_b32 v17, a55
    v_mul_f32 v17, v17, v16
    v_accvgpr_write_b32 a55, v17
    v_accvgpr_read_b32 v17, a56
    v_mul_f32 v17, v17, v16
    v_accvgpr_write_b32 a56, v17
    v_accvgpr_read_b32 v17, a57
    v_mul_f32 v17, v17, v16
    v_accvgpr_write_b32 a57, v17
    v_accvgpr_read_b32 v17, a58
    v_mul_f32 v17, v17, v16
    v_accvgpr_write_b32 a58, v17
    v_accvgpr_read_b32 v17, a59
    v_mul_f32 v17, v17, v16
    v_accvgpr_write_b32 a59, v17
    v_accvgpr_read_b32 v17, a60
    v_mul_f32 v17, v17, v16
    v_accvgpr_write_b32 a60, v17
    v_accvgpr_read_b32 v17, a61
    v_mul_f32 v17, v17, v16
    v_accvgpr_write_b32 a61, v17
    v_accvgpr_read_b32 v17, a62
    v_mul_f32 v17, v17, v16
    v_accvgpr_write_b32 a62, v17
    v_accvgpr_read_b32 v17, a63
    v_mul_f32 v17, v17, v16
    v_accvgpr_write_b32 a63, v17
    v_accvgpr_read_b32 v17, a64
    v_mul_f32 v17, v17, v16
    v_accvgpr_write_b32 a64, v17
    v_accvgpr_read_b32 v17, a65
    v_mul_f32 v17, v17, v16
    v_accvgpr_write_b32 a65, v17
    v_accvgpr_read_b32 v17, a66
    v_mul_f32 v17, v17, v16
    v_accvgpr_write_b32 a66, v17
    v_accvgpr_read_b32 v17, a67
    v_mul_f32 v17, v17, v16
    v_accvgpr_write_b32 a67, v17
    v_accvgpr_read_b32 v17, a68
    v_mul_f32 v17, v17, v16
    v_accvgpr_write_b32 a68, v17
    v_accvgpr_read_b32 v17, a69
    v_mul_f32 v17, v17, v16
    v_accvgpr_write_b32 a69, v17
    v_accvgpr_read_b32 v17, a70
    v_mul_f32 v17, v17, v16
    v_accvgpr_write_b32 a70, v17
    v_accvgpr_read_b32 v17, a71
    v_mul_f32 v17, v17, v16
    v_accvgpr_write_b32 a71, v17
    v_accvgpr_read_b32 v17, a72
    v_mul_f32 v17, v17, v16
    v_accvgpr_write_b32 a72, v17
    v_accvgpr_read_b32 v17, a73
    v_mul_f32 v17, v17, v16
    v_accvgpr_write_b32 a73, v17
    v_accvgpr_read_b32 v17, a74
    v_mul_f32 v17, v17, v16
    v_accvgpr_write_b32 a74, v17
    v_accvgpr_read_b32 v17, a75
    v_mul_f32 v17, v17, v16
    v_accvgpr_write_b32 a75, v17
    v_accvgpr_read_b32 v17, a76
    v_mul_f32 v17, v17, v16
    v_accvgpr_write_b32 a76, v17
    v_accvgpr_read_b32 v17, a77
    v_mul_f32 v17, v17, v16
    v_accvgpr_write_b32 a77, v17
    v_accvgpr_read_b32 v17, a78
    v_mul_f32 v17, v17, v16
    v_accvgpr_write_b32 a78, v17
    v_accvgpr_read_b32 v17, a79
    v_mul_f32 v17, v17, v16
    v_accvgpr_write_b32 a79, v17
    v_accvgpr_read_b32 v17, a80
    v_mul_f32 v17, v17, v16
    v_accvgpr_write_b32 a80, v17
    v_accvgpr_read_b32 v17, a81
    v_mul_f32 v17, v17, v16
    v_accvgpr_write_b32 a81, v17
    v_accvgpr_read_b32 v17, a82
    v_mul_f32 v17, v17, v16
    v_accvgpr_write_b32 a82, v17
    v_accvgpr_read_b32 v17, a83
    v_mul_f32 v17, v17, v16
    v_accvgpr_write_b32 a83, v17
    v_accvgpr_read_b32 v17, a84
    v_mul_f32 v17, v17, v16
    v_accvgpr_write_b32 a84, v17
    v_accvgpr_read_b32 v17, a85
    v_mul_f32 v17, v17, v16
    v_accvgpr_write_b32 a85, v17
    v_accvgpr_read_b32 v17, a86
    v_mul_f32 v17, v17, v16
    v_accvgpr_write_b32 a86, v17
    v_accvgpr_read_b32 v17, a87
    v_mul_f32 v17, v17, v16
    v_accvgpr_write_b32 a87, v17
    v_accvgpr_read_b32 v17, a88
    v_mul_f32 v17, v17, v16
    v_accvgpr_write_b32 a88, v17
    v_accvgpr_read_b32 v17, a89
    v_mul_f32 v17, v17, v16
    v_accvgpr_write_b32 a89, v17
    v_accvgpr_read_b32 v17, a90
    v_mul_f32 v17, v17, v16
    v_accvgpr_write_b32 a90, v17
    v_accvgpr_read_b32 v17, a91
    v_mul_f32 v17, v17, v16
    v_accvgpr_write_b32 a91, v17
    v_accvgpr_read_b32 v17, a92
    v_mul_f32 v17, v17, v16
    v_accvgpr_write_b32 a92, v17
    v_accvgpr_read_b32 v17, a93
    v_mul_f32 v17, v17, v16
    v_accvgpr_write_b32 a93, v17
    v_accvgpr_read_b32 v17, a94
    v_mul_f32 v17, v17, v16
    v_accvgpr_write_b32 a94, v17
    v_accvgpr_read_b32 v17, a95
    v_mul_f32 v17, v17, v16
    v_accvgpr_write_b32 a95, v17
    s_branch L_at8_cont0
L_at8_fix1:
    v_add_u32 v22, s63, v20
    v_cmp_gt_i32 vcc, 0, v22
    s_nop 1
    v_cndmask_b32 v32, v32, v24, vcc
    v_cmp_gt_i32 vcc, 1, v22
    s_nop 1
    v_cndmask_b32 v33, v33, v24, vcc
    v_cmp_gt_i32 vcc, 2, v22
    s_nop 1
    v_cndmask_b32 v34, v34, v24, vcc
    v_cmp_gt_i32 vcc, 3, v22
    s_nop 1
    v_cndmask_b32 v35, v35, v24, vcc
    v_cmp_gt_i32 vcc, 8, v22
    s_nop 1
    v_cndmask_b32 v36, v36, v24, vcc
    v_cmp_gt_i32 vcc, 9, v22
    s_nop 1
    v_cndmask_b32 v37, v37, v24, vcc
    v_cmp_gt_i32 vcc, 10, v22
    s_nop 1
    v_cndmask_b32 v38, v38, v24, vcc
    v_cmp_gt_i32 vcc, 11, v22
    s_nop 1
    v_cndmask_b32 v39, v39, v24, vcc
    v_cmp_gt_i32 vcc, 16, v22
    s_nop 1
    v_cndmask_b32 v40, v40, v24, vcc
    v_cmp_gt_i32 vcc, 17, v22
    s_nop 1
    v_cndmask_b32 v41, v41, v24, vcc
    v_cmp_gt_i32 vcc, 18, v22
    s_nop 1
    v_cndmask_b32 v42, v42, v24, vcc
    v_cmp_gt_i32 vcc, 19, v22
    s_nop 1
    v_cndmask_b32 v43, v43, v24, vcc
    v_cmp_gt_i32 vcc, 24, v22
    s_nop 1
    v_cndmask_b32 v44, v44, v24, vcc
    v_cmp_gt_i32 vcc, 25, v22
    s_nop 1
    v_cndmask_b32 v45, v45, v24, vcc
    v_cmp_gt_i32 vcc, 26, v22
    s_nop 1
    v_cndmask_b32 v46, v46, v24, vcc
    v_cmp_gt_i32 vcc, 27, v22
    s_nop 1
    v_cndmask_b32 v47, v47, v24, vcc
    v_cmp_gt_i32 vcc, 32, v22
    s_nop 1
    v_cndmask_b32 v48, v48, v24, vcc
    v_cmp_gt_i32 vcc, 33, v22
    s_nop 1
    v_cndmask_b32 v49, v49, v24, vcc
    v_cmp_gt_i32 vcc, 34, v22
    s_nop 1
    v_cndmask_b32 v50, v50, v24, vcc
    v_cmp_gt_i32 vcc, 35, v22
    s_nop 1
    v_cndmask_b32 v51, v51, v24, vcc
    v_cmp_gt_i32 vcc, 40, v22
    s_nop 1
    v_cndmask_b32 v52, v52, v24, vcc
    v_cmp_gt_i32 vcc, 41, v22
    s_nop 1
    v_cndmask_b32 v53, v53, v24, vcc
    v_cmp_gt_i32 vcc, 42, v22
    s_nop 1
    v_cndmask_b32 v54, v54, v24, vcc
    v_cmp_gt_i32 vcc, 43, v22
    s_nop 1
    v_cndmask_b32 v55, v55, v24, vcc
    v_cmp_gt_i32 vcc, 48, v22
    s_nop 1
    v_cndmask_b32 v56, v56, v24, vcc
    v_cmp_gt_i32 vcc, 49, v22
    s_nop 1
    v_cndmask_b32 v57, v57, v24, vcc
    v_cmp_gt_i32 vcc, 50, v22
    s_nop 1
    v_cndmask_b32 v58, v58, v24, vcc
    v_cmp_gt_i32 vcc, 51, v22
    s_nop 1
    v_cndmask_b32 v59, v59, v24, vcc
    v_cmp_gt_i32 vcc, 56, v22
    s_nop 1
    v_cndmask_b32 v60, v60, v24, vcc
    v_cmp_gt_i32 vcc, 57, v22
    s_nop 1
    v_cndmask_b32 v61, v61, v24, vcc
    v_cmp_gt_i32 vcc, 58, v22
    s_nop 1
    v_cndmask_b32 v62, v62, v24, vcc
    v_cmp_gt_i32 vcc, 59, v22
    s_nop 1
    v_cndmask_b32 v63, v63, v24, vcc
    v_max3_f32 v14, v32, v33, v34
    v_max3_f32 v14, v14, v35, v36
    v_max3_f32 v14, v14, v37, v38
    v_max3_f32 v14, v14, v39, v40
    v_max3_f32 v14, v14, v41, v42
    v_max3_f32 v14, v14, v43, v44
    v_max3_f32 v14, v14, v45, v46
    v_max_f32 v14, v14, v47
    v_max3_f32 v14, v14, v48, v49
    v_max3_f32 v14, v14, v50, v51
    v_max3_f32 v14, v14, v52, v53
    v_max3_f32 v14, v14, v54, v55
    v_max3_f32 v14, v14, v56, v57
    v_max3_f32 v14, v14, v58, v59
    v_max3_f32 v14, v14, v60, v61
    v_max3_f32 v14, v14, v62, v63
    s_branch L_at8_chk1
L_at8_slow1:
    v_mov_b32 v16, v14
    s_nop 1
    v_permlane32_swap_b32 v14, v16
    v_max_f32 v14, v14, v16
    v_max_f32 v14, 0, v14
    v_sub_f32 v32, v32, v14
    v_sub_f32 v33, v33, v14
    v_sub_f32 v34, v34, v14
    v_sub_f32 v35, v35, v14
    v_sub_f32 v36, v36, v14
    v_sub_f32 v37, v37, v14
    v_sub_f32 v38, v38, v14
    v_sub_f32 v39, v39, v14
    v_sub_f32 v40, v40, v14
    v_sub_f32 v41, v41, v14
    v_sub_f32 v42, v42, v14
    v_sub_f32 v43, v43, v14
    v_sub_f32 v44, v44, v14
    v_sub_f32 v45, v45, v14
    v_sub_f32 v46, v46, v14
    v_sub_f32 v47, v47, v14
    v_sub_f32 v48, v48, v14
    v_sub_f32 v49, v49, v14
    v_sub_f32 v50, v50, v14
    v_sub_f32 v51, v51, v14
    v_sub_f32 v52, v52, v14
    v_sub_f32 v53, v53, v14
    v_sub_f32 v54, v54, v14
    v_sub_f32 v55, v55, v14
    v_sub_f32 v56, v56, v14
    v_sub_f32 v57, v57, v14
    v_sub_f32 v58, v58, v14
    v_sub_f32 v59, v59, v14
    v_sub_f32 v60, v60, v14
    v_sub_f32 v61, v61, v14
    v_sub_f32 v62, v62, v14
    v_sub_f32 v63, v63, v14
    v_sub_f32 v112, v112, v14
    v_sub_f32 v113, v113, v14
    v_sub_f32 v114, v114, v14
    v_sub_f32 v115, v115, v14
    v_sub_f32 v116, v116, v14
    v_sub_f32 v117, v117, v14
    v_sub_f32 v118, v118, v14
    v_sub_f32 v119, v119, v14
    v_sub_f32 v120, v120, v14
    v_sub_f32 v121, v121, v14
    v_sub_f32 v122, v122, v14
    v_sub_f32 v123, v123, v14
    v_sub_f32 v124, v124, v14
    v_sub_f32 v125, v125, v14
    v_sub_f32 v126, v126, v14
    v_sub_f32 v127, v127, v14
    v_exp_f32 v16, -v14
    s_nop 0
    v_mul_f32 v12, v12, v16
    v_mul_f32 v13, v13, v16
    v_accvgpr_read_b32 v17, a32
    v_mul_f32 v17, v17, v16
    v_accvgpr_write_b32 a32, v17
    v_accvgpr_read_b32 v17, a33
    v_mul_f32 v17, v17, v16
    v_accvgpr_write_b32 a33, v17
    v_accvgpr_read_b32 v17, a34
    v_mul_f32 v17, v17, v16
    v_accvgpr_write_b32 a34, v17
    v_accvgpr_read_b32 v17, a35
    v_mul_f32 v17, v17, v16
    v_accvgpr_write_b32 a35, v17
    v_accvgpr_read_b32 v17, a36
    v_mul_f32 v17, v17, v16
    v_accvgpr_write_b32 a36, v17
    v_accvgpr_read_b32 v17, a37
    v_mul_f32 v17, v17, v16
    v_accvgpr_write_b32 a37, v17
    v_accvgpr_read_b32 v17, a38
    v_mul_f32 v17, v17, v16
    v_accvgpr_write_b32 a38, v17
    v_accvgpr_read_b32 v17, a39
    v_mul_f32 v17, v17, v16
    v_accvgpr_write_b32 a39, v17
    v_accvgpr_read_b32 v17, a40
    v_mul_f32 v17, v17, v16
    v_accvgpr_write_b32 a40, v17
    v_accvgpr_read_b32 v17, a41
    v_mul_f32 v17, v17, v16
    v_accvgpr_write_b32 a41, v17
    v_accvgpr_read_b32 v17, a42
    v_mul_f32 v17, v17, v16
    v_accvgpr_write_b32 a42, v17
    v_accvgpr_read_b32 v17, a43
    v_mul_f32 v17, v17, v16
    v_accvgpr_write_b32 a43, v17
    v_accvgpr_read_b32 v17, a44
    v_mul_f32 v17, v17, v16
    v_accvgpr_write_b32 a44, v17
    v_accvgpr_read_b32 v17, a45
    v_mul_f32 v17, v17, v16
    v_accvgpr_write_b32 a45, v17
    v_accvgpr_read_b32 v17, a46
    v_mul_f32 v17, v17, v16
    v_accvgpr_write_b32 a46, v17
    v_accvgpr_read_b32 v17, a47
    v_mul_f32 v17, v17, v16
    v_accvgpr_write_b32 a47, v17
    v_accvgpr_read_b32 v17, a48
    v_mul_f32 v17, v17, v16
    v_accvgpr_write_b32 a48, v17
    v_accvgpr_read_b32 v17, a49
    v_mul_f32 v17, v17, v16
    v_accvgpr_write_b32 a49, v17
    v_accvgpr_read_b32 v17, a50
    v_mul_f32 v17, v17, v16
    v_accvgpr_write_b32 a50, v17
    v_accvgpr_read_b32 v17, a51
    v_mul_f32 v17, v17, v16
    v_accvgpr_write_b32 a51, v17
    v_accvgpr_read_b32 v17, a52
    v_mul_f32 v17, v17, v16
    v_accvgpr_write_b32 a52, v17
    v_accvgpr_read_b32 v17, a53
    v_mul_f32 v17, v17, v16
    v_accvgpr_write_b32 a53, v17
    v_accvgpr_read_b32 v17, a54
    v_mul_f32 v17, v17, v16
    v_accvgpr_write_b32 a54, v17
    v_accvgpr_read_b32 v17, a55
    v_mul_f32 v17, v17, v16
    v_accvgpr_write_b32 a55, v17
    v_accvgpr_read_b32 v17, a56
    v_mul_f32 v17, v17, v16
    v_accvgpr_write_b32 a56, v17
    v_accvgpr_read_b32 v17, a57
    v_mul_f32 v17, v17, v16
    v_accvgpr_write_b32 a57, v17
    v_accvgpr_read_b32 v17, a58
    v_mul_f32 v17, v17, v16
    v_accvgpr_write_b32 a58, v17
    v_accvgpr_read_b32 v17, a59
    v_mul_f32 v17, v17, v16
    v_accvgpr_write_b32 a59, v17
    v_accvgpr_read_b32 v17, a60
    v_mul_f32 v17, v17, v16
    v_accvgpr_write_b32 a60, v17
    v_accvgpr_read_b32 v17, a61
    v_mul_f32 v17, v17, v16
    v_accvgpr_write_b32 a61, v17
    v_accvgpr_read_b32 v17, a62
    v_mul_f32 v17, v17, v16
    v_accvgpr_write_b32 a62, v17
    v_accvgpr_read_b32 v17, a63
    v_mul_f32 v17, v17, v16
    v_accvgpr_write_b32 a63, v17
    v_accvgpr_read_b32 v17, a64
    v_mul_f32 v17, v17, v16
    v_accvgpr_write_b32 a64, v17
    v_accvgpr_read_b32 v17, a65
    v_mul_f32 v17, v17, v16
    v_accvgpr_write_b32 a65, v17
    v_accvgpr_read_b32 v17, a66
    v_mul_f32 v17, v17, v16
    v_accvgpr_write_b32 a66, v17
    v_accvgpr_read_b32 v17, a67
    v_mul_f32 v17, v17, v16
    v_accvgpr_write_b32 a67, v17
    v_accvgpr_read_b32 v17, a68
    v_mul_f32 v17, v17, v16
    v_accvgpr_write_b32 a68, v17
    v_accvgpr_read_b32 v17, a69
    v_mul_f32 v17, v17, v16
    v_accvgpr_write_b32 a69, v17
    v_accvgpr_read_b32 v17, a70
    v_mul_f32 v17, v17, v16
    v_accvgpr_write_b32 a70, v17
    v_accvgpr_read_b32 v17, a71
    v_mul_f32 v17, v17, v16
    v_accvgpr_write_b32 a71, v17
    v_accvgpr_read_b32 v17, a72
    v_mul_f32 v17, v17, v16
    v_accvgpr_write_b32 a72, v17
    v_accvgpr_read_b32 v17, a73
    v_mul_f32 v17, v17, v16
    v_accvgpr_write_b32 a73, v17
    v_accvgpr_read_b32 v17, a74
    v_mul_f32 v17, v17, v16
    v_accvgpr_write_b32 a74, v17
    v_accvgpr_read_b32 v17, a75
    v_mul_f32 v17, v17, v16
    v_accvgpr_write_b32 a75, v17
    v_accvgpr_read_b32 v17, a76
    v_mul_f32 v17, v17, v16
    v_accvgpr_write_b32 a76, v17
    v_accvgpr_read_b32 v17, a77
    v_mul_f32 v17, v17, v16
    v_accvgpr_write_b32 a77, v17
    v_accvgpr_read_b32 v17, a78
    v_mul_f32 v17, v17, v16
    v_accvgpr_write_b32 a78, v17
    v_accvgpr_read_b32 v17, a79
    v_mul_f32 v17, v17, v16
    v_accvgpr_write_b32 a79, v17
    v_accvgpr_read_b32 v17, a80
    v_mul_f32 v17, v17, v16
    v_accvgpr_write_b32 a80, v17
    v_accvgpr_read_b32 v17, a81
    v_mul_f32 v17, v17, v16
    v_accvgpr_write_b32 a81, v17
    v_accvgpr_read_b32 v17, a82
    v_mul_f32 v17, v17, v16
    v_accvgpr_write_b32 a82, v17
    v_accvgpr_read_b32 v17, a83
    v_mul_f32 v17, v17, v16
    v_accvgpr_write_b32 a83, v17
    v_accvgpr_read_b32 v17, a84
    v_mul_f32 v17, v17, v16
    v_accvgpr_write_b32 a84, v17
    v_accvgpr_read_b32 v17, a85
    v_mul_f32 v17, v17, v16
    v_accvgpr_write_b32 a85, v17
    v_accvgpr_read_b32 v17, a86
    v_mul_f32 v17, v17, v16
    v_accvgpr_write_b32 a86, v17
    v_accvgpr_read_b32 v17, a87
    v_mul_f32 v17, v17, v16
    v_accvgpr_write_b32 a87, v17
    v_accvgpr_read_b32 v17, a88
    v_mul_f32 v17, v17, v16
    v_accvgpr_write_b32 a88, v17
    v_accvgpr_read_b32 v17, a89
    v_mul_f32 v17, v17, v16
    v_accvgpr_write_b32 a89, v17
    v_accvgpr_read_b32 v17, a90
    v_mul_f32 v17, v17, v16
    v_accvgpr_write_b32 a90, v17
    v_accvgpr_read_b32 v17, a91
    v_mul_f32 v17, v17, v16
    v_accvgpr_write_b32 a91, v17
    v_accvgpr_read_b32 v17, a92
    v_mul_f32 v17, v17, v16
    v_accvgpr_write_b32 a92, v17
    v_accvgpr_read_b32 v17, a93
    v_mul_f32 v17, v17, v16
    v_accvgpr_write_b32 a93, v17
    v_accvgpr_read_b32 v17, a94
    v_mul_f32 v17, v17, v16
    v_accvgpr_write_b32 a94, v17
    v_accvgpr_read_b32 v17, a95
    v_mul_f32 v17, v17, v16
    v_accvgpr_write_b32 a95, v17
    s_branch L_at8_cont1
L_at8_comb:
    v_add_f32 v12, v12, v13
    v_mov_b32 v16, v12
    s_nop 1
    v_permlane32_swap_b32 v12, v16
    v_add_f32 v12, v12, v16
    s_waitcnt vmcnt(0)
    s_barrier
    s_cmp_lg_u32 s44, 0
    s_cbranch_scc1 L_at8_nonext
    s_mov_b32 s50, s40
    s_lshl_b32 s52, s50, 14
    s_add_u32 s52, s52, s53
    s_add_u32 m0, s57, 0
    s_nop 0
    buffer_load_dwordx4 v21, s[8:11], s52 offen offset:0 lds
    buffer_load_dwordx4 v21, s[8:11], s52 offen offset:1024 lds
    buffer_load_dwordx4 v21, s[8:11], s52 offen offset:2048 lds
    buffer_load_dwordx4 v21, s[8:11], s52 offen offset:3072 lds
    s_lshl_b32 s30, s42, 7
    s_lshl_b32 s31, s39, 5
    s_add_u32 s30, s30, s31
    v_and_b32 v6, 31, v1
    v_lshrrev_b32 v7, 5, v1
    v_add_u32 v6, s30, v6
    v_lshlrev_b32 v6, 4, v6
    v_lshl_add_u32 v6, v7, 15, v6
    s_mov_b32 s56, 0
    buffer_load_dwordx4 a[0:3], v6, s[4:7], s56 offen
    s_mov_b32 s56, 65536
    buffer_load_dwordx4 a[4:7], v6, s[4:7], s56 offen
    s_mov_b32 s56, 131072
    buffer_load_dwordx4 a[8:11], v6, s[4:7], s56 offen
    s_mov_b32 s56, 196608
    buffer_load_dwordx4 a[12:15], v6, s[4:7], s56 offen
    s_mov_b32 s56, 262144
    buffer_load_dwordx4 a[16:19], v6, s[4:7], s56 offen
    s_mov_b32 s56, 327680
    buffer_load_dwordx4 a[20:23], v6, s[4:7], s56 offen
    s_mov_b32 s56, 393216
    buffer_load_dwordx4 a[24:27], v6, s[4:7], s56 offen
    s_mov_b32 s56, 458752
    buffer_load_dwordx4 a[28:31], v6, s[4:7], s56 offen
    s_add_u32 s50, s40, 2
    s_lshl_b32 s52, s50, 14
    s_add_u32 s52, s52, s53
    s_add_u32 m0, s57, 16384
    s_nop 0
    buffer_load_dwordx4 v21, s[8:11], s52 offen offset:0 lds
    buffer_load_dwordx4 v21, s[8:11], s52 offen offset:1024 lds
    buffer_load_dwordx4 v21, s[8:11], s52 offen offset:2048 lds
    buffer_load_dwordx4 v21, s[8:11], s52 offen offset:3072 lds
L_at8_nonext:
    s_and_b32 s61, s38, 3
    s_lshl_b32 s61, s61, 13
    s_lshr_b32 s30, s38, 2
    s_lshl_b32 s30, s30, 16
    s_add_u32 s61, s61, s30
    s_add_u32 s61, s61, 32768
    v_add_u32 v2, s61, v21
    s_cmp_eq_u32 s40, 0
    s_cbranch_scc0 L_at8_w1
    ds_write_b128 v2, a[64:67] offset:0
    ds_write_b128 v2, a[68:71] offset:1024
    ds_write_b128 v2, a[72:75] offset:2048
    ds_write_b128 v2, a[76:79] offset:3072
    ds_write_b128 v2, a[80:83] offset:4096
    ds_write_b128 v2, a[84:87] offset:5120
    ds_write_b128 v2, a[88:91] offset:6144
    ds_write_b128 v2, a[92:95] offset:7168
    s_branch L_at8_w2
L_at8_w1:
    ds_write_b128 v2, a[32:35] offset:0
    ds_write_b128 v2, a[36:39] offset:1024
    ds_write_b128 v2, a[40:43] offset:2048
    ds_write_b128 v2, a[44:47] offset:3072
    ds_write_b128 v2, a[48:51] offset:4096
    ds_write_b128 v2, a[52:55] offset:5120
    ds_write_b128 v2, a[56:59] offset:6144
    ds_write_b128 v2, a[60:63] offset:7168
L_at8_w2:
    v_mov_b32 v4, v112
    v_mov_b32 v5, v12
    s_lshl_b32 s62, s38, 9
    s_add_u32 s62, s62, 131072
    v_lshlrev_b32 v3, 3, v1
    v_add_u32 v3, s62, v3
    ds_write_b64 v3, v[4:5]
    s_waitcnt lgkmcnt(0)
    s_barrier
    s_xor_b32 s60, s38, 4
    s_lshl_b32 s62, s60, 9
    s_and_b32 s61, s60, 3
    s_lshl_b32 s61, s61, 13
    s_lshr_b32 s30, s60, 2
    s_lshl_b32 s30, s30, 16
    s_add_u32 s61, s61, s30
    s_add_u32 s61, s61, 32768
    v_add_u32 v2, s61, v21
    s_add_u32 s62, s62, 131072
    v_lshlrev_b32 v3, 3, v1
    v_add_u32 v3, s62, v3
    ds_read_b64 v[4:5], v3
    ds_read_b128 v[32:35], v2 offset:0
    ds_read_b128 v[36:39], v2 offset:1024
    ds_read_b128 v[40:43], v2 offset:2048
    ds_read_b128 v[44:47], v2 offset:3072
    ds_read_b128 v[48:51], v2 offset:4096
    ds_read_b128 v[52:55], v2 offset:5120
    ds_read_b128 v[56:59], v2 offset:6144
    ds_read_b128 v[60:63], v2 offset:7168
    s_waitcnt lgkmcnt(0)
    s_barrier
    v_min_f32 v16, v112, v4
    v_sub_f32 v17, v16, v112
    v_sub_f32 v18, v16, v4
    v_exp_f32 v17, v17
    v_exp_f32 v18, v18
    v_mul_f32 v16, v17, v12
    v_fmac_f32 v16, v18, v5
    v_rcp_f32 v16, v16
    s_nop 0
    v_mul_f32 v26, v17, v16
    v_mul_f32 v27, v18, v16
    v_lshrrev_b32 v3, 5, v1
    v_lshl_add_u32 v25, v3, 15, v25
    s_lshl_b32 s61, s40, 18
    s_add_u32 s61, s61, s43
    s_cmp_eq_u32 s40, 0
    s_cbranch_scc0 L_at8_f1
    v_accvgpr_read_b32 v16, a32
    v_mul_f32 v32, v32, v27
    v_fmac_f32 v32, v16, v26
    v_accvgpr_read_b32 v16, a33
    v_mul_f32 v33, v33, v27
    v_fmac_f32 v33, v16, v26
    v_accvgpr_read_b32 v16, a34
    v_mul_f32 v34, v34, v27
    v_fmac_f32 v34, v16, v26
    v_accvgpr_read_b32 v16, a35
    v_mul_f32 v35, v35, v27
    v_fmac_f32 v35, v16, v26
    v_accvgpr_read_b32 v16, a36
    v_mul_f32 v36, v36, v27
    v_fmac_f32 v36, v16, v26
    v_accvgpr_read_b32 v16, a37
    v_mul_f32 v37, v37, v27
    v_fmac_f32 v37, v16, v26
    v_accvgpr_read_b32 v16, a38
    v_mul_f32 v38, v38, v27
    v_fmac_f32 v38, v16, v26
    v_accvgpr_read_b32 v16, a39
    v_mul_f32 v39, v39, v27
    v_fmac_f32 v39, v16, v26
    v_accvgpr_read_b32 v16, a40
    v_mul_f32 v40, v40, v27
    v_fmac_f32 v40, v16, v26
    v_accvgpr_read_b32 v16, a41
    v_mul_f32 v41, v41, v27
    v_fmac_f32 v41, v16, v26
    v_accvgpr_read_b32 v16, a42
    v_mul_f32 v42, v42, v27
    v_fmac_f32 v42, v16, v26
    v_accvgpr_read_b32 v16, a43
    v_mul_f32 v43, v43, v27
    v_fmac_f32 v43, v16, v26
    v_accvgpr_read_b32 v16, a44
    v_mul_f32 v44, v44, v27
    v_fmac_f32 v44, v16, v26
    v_accvgpr_read_b32 v16, a45
    v_mul_f32 v45, v45, v27
    v_fmac_f32 v45, v16, v26
    v_accvgpr_read_b32 v16, a46
    v_mul_f32 v46, v46, v27
    v_fmac_f32 v46, v16, v26
    v_accvgpr_read_b32 v16, a47
    v_mul_f32 v47, v47, v27
    v_fmac_f32 v47, v16, v26
    v_cvt_pk_bf16_f32 v96, v32, v33
    v_cvt_pk_bf16_f32 v97, v34, v35
    v_cvt_pk_bf16_f32 v98, v36, v37
    v_cvt_pk_bf16_f32 v99, v38, v39
    v_cvt_pk_bf16_f32 v100, v40, v41
    v_cvt_pk_bf16_f32 v101, v42, v43
    v_cvt_pk_bf16_f32 v102, v44, v45
    v_cvt_pk_bf16_f32 v103, v46, v47
    s_add_u32 s62, s61, 0
    buffer_store_dwordx4 v[96:99], v25, s[16:19], s62 offen
    s_add_u32 s62, s61, 32768
    buffer_store_dwordx4 v[100:103], v25, s[16:19], s62 offen
    v_accvgpr_read_b32 v16, a48
    v_mul_f32 v48, v48, v27
    v_fmac_f32 v48, v16, v26
    v_accvgpr_read_b32 v16, a49
    v_mul_f32 v49, v49, v27
    v_fmac_f32 v49, v16, v26
    v_accvgpr_read_b32 v16, a50
    v_mul_f32 v50, v50, v27
    v_fmac_f32 v50, v16, v26
    v_accvgpr_read_b32 v16, a51
    v_mul_f32 v51, v51, v27
    v_fmac_f32 v51, v16, v26
    v_accvgpr_read_b32 v16, a52
    v_mul_f32 v52, v52, v27
    v_fmac_f32 v52, v16, v26
    v_accvgpr_read_b32 v16, a53
    v_mul_f32 v53, v53, v27
    v_fmac_f32 v53, v16, v26
    v_accvgpr_read_b32 v16, a54
    v_mul_f32 v54, v54, v27
    v_fmac_f32 v54, v16, v26
    v_accvgpr_read_b32 v16, a55
    v_mul_f32 v55, v55, v27
    v_fmac_f32 v55, v16, v26
    v_accvgpr_read_b32 v16, a56
    v_mul_f32 v56, v56, v27
    v_fmac_f32 v56, v16, v26
    v_accvgpr_read_b32 v16, a57
    v_mul_f32 v57, v57, v27
    v_fmac_f32 v57, v16, v26
    v_accvgpr_read_b32 v16, a58
    v_mul_f32 v58, v58, v27
    v_fmac_f32 v58, v16, v26
    v_accvgpr_read_b32 v16, a59
    v_mul_f32 v59, v59, v27
    v_fmac_f32 v59, v16, v26
    v_accvgpr_read_b32 v16, a60
    v_mul_f32 v60, v60, v27
    v_fmac_f32 v60, v16, v26
    v_accvgpr_read_b32 v16, a61
    v_mul_f32 v61, v61, v27
    v_fmac_f32 v61, v16, v26
    v_accvgpr_read_b32 v16, a62
    v_mul_f32 v62, v62, v27
    v_fmac_f32 v62, v16, v26
    v_accvgpr_read_b32 v16, a63
    v_mul_f32 v63, v63, v27
    v_fmac_f32 v63, v16, v26
    v_cvt_pk_bf16_f32 v104, v48, v49
    v_cvt_pk_bf16_f32 v105, v50, v51
    v_cvt_pk_bf16_f32 v106, v52, v53
    v_cvt_pk_bf16_f32 v107, v54, v55
    v_cvt_pk_bf16_f32 v108, v56, v57
    v_cvt_pk_bf16_f32 v109, v58, v59
    v_cvt_pk_bf16_f32 v110, v60, v61
    v_cvt_pk_bf16_f32 v111, v62, v63
    s_add_u32 s62, s61, 131072
    buffer_store_dwordx4 v[104:107], v25, s[16:19], s62 offen
    s_add_u32 s62, s61, 163840
    buffer_store_dwordx4 v[108:111], v25, s[16:19], s62 offen
    s_branch L_at8_f2
L_at8_f1:
    v_accvgpr_read_b32 v16, a64
    v_mul_f32 v32, v32, v27
    v_fmac_f32 v32, v16, v26
    v_accvgpr_read_b32 v16, a65
    v_mul_f32 v33, v33, v27
    v_fmac_f32 v33, v16, v26
    v_accvgpr_read_b32 v16, a66
    v_mul_f32 v34, v34, v27
    v_fmac_f32 v34, v16, v26
    v_accvgpr_read_b32 v16, a67
    v_mul_f32 v35, v35, v27
    v_fmac_f32 v35, v16, v26
    v_accvgpr_read_b32 v16, a68
    v_mul_f32 v36, v36, v27
    v_fmac_f32 v36, v16, v26
    v_accvgpr_read_b32 v16, a69
    v_mul_f32 v37, v37, v27
    v_fmac_f32 v37, v16, v26
    v_accvgpr_read_b32 v16, a70
    v_mul_f32 v38, v38, v27
    v_fmac_f32 v38, v16, v26
    v_accvgpr_read_b32 v16, a71
    v_mul_f32 v39, v39, v27
    v_fmac_f32 v39, v16, v26
    v_accvgpr_read_b32 v16, a72
    v_mul_f32 v40, v40, v27
    v_fmac_f32 v40, v16, v26
    v_accvgpr_read_b32 v16, a73
    v_mul_f32 v41, v41, v27
    v_fmac_f32 v41, v16, v26
    v_accvgpr_read_b32 v16, a74
    v_mul_f32 v42, v42, v27
    v_fmac_f32 v42, v16, v26
    v_accvgpr_read_b32 v16, a75
    v_mul_f32 v43, v43, v27
    v_fmac_f32 v43, v16, v26
    v_accvgpr_read_b32 v16, a76
    v_mul_f32 v44, v44, v27
    v_fmac_f32 v44, v16, v26
    v_accvgpr_read_b32 v16, a77
    v_mul_f32 v45, v45, v27
    v_fmac_f32 v45, v16, v26
    v_accvgpr_read_b32 v16, a78
    v_mul_f32 v46, v46, v27
    v_fmac_f32 v46, v16, v26
    v_accvgpr_read_b32 v16, a79
    v_mul_f32 v47, v47, v27
    v_fmac_f32 v47, v16, v26
    v_cvt_pk_bf16_f32 v96, v32, v33
    v_cvt_pk_bf16_f32 v97, v34, v35
    v_cvt_pk_bf16_f32 v98, v36, v37
    v_cvt_pk_bf16_f32 v99, v38, v39
    v_cvt_pk_bf16_f32 v100, v40, v41
    v_cvt_pk_bf16_f32 v101, v42, v43
    v_cvt_pk_bf16_f32 v102, v44, v45
    v_cvt_pk_bf16_f32 v103, v46, v47
    s_add_u32 s62, s61, 0
    buffer_store_dwordx4 v[96:99], v25, s[16:19], s62 offen
    s_add_u32 s62, s61, 32768
    buffer_store_dwordx4 v[100:103], v25, s[16:19], s62 offen
    v_accvgpr_read_b32 v16, a80
    v_mul_f32 v48, v48, v27
    v_fmac_f32 v48, v16, v26
    v_accvgpr_read_b32 v16, a81
    v_mul_f32 v49, v49, v27
    v_fmac_f32 v49, v16, v26
    v_accvgpr_read_b32 v16, a82
    v_mul_f32 v50, v50, v27
    v_fmac_f32 v50, v16, v26
    v_accvgpr_read_b32 v16, a83
    v_mul_f32 v51, v51, v27
    v_fmac_f32 v51, v16, v26
    v_accvgpr_read_b32 v16, a84
    v_mul_f32 v52, v52, v27
    v_fmac_f32 v52, v16, v26
    v_accvgpr_read_b32 v16, a85
    v_mul_f32 v53, v53, v27
    v_fmac_f32 v53, v16, v26
    v_accvgpr_read_b32 v16, a86
    v_mul_f32 v54, v54, v27
    v_fmac_f32 v54, v16, v26
    v_accvgpr_read_b32 v16, a87
    v_mul_f32 v55, v55, v27
    v_fmac_f32 v55, v16, v26
    v_accvgpr_read_b32 v16, a88
    v_mul_f32 v56, v56, v27
    v_fmac_f32 v56, v16, v26
    v_accvgpr_read_b32 v16, a89
    v_mul_f32 v57, v57, v27
    v_fmac_f32 v57, v16, v26
    v_accvgpr_read_b32 v16, a90
    v_mul_f32 v58, v58, v27
    v_fmac_f32 v58, v16, v26
    v_accvgpr_read_b32 v16, a91
    v_mul_f32 v59, v59, v27
    v_fmac_f32 v59, v16, v26
    v_accvgpr_read_b32 v16, a92
    v_mul_f32 v60, v60, v27
    v_fmac_f32 v60, v16, v26
    v_accvgpr_read_b32 v16, a93
    v_mul_f32 v61, v61, v27
    v_fmac_f32 v61, v16, v26
    v_accvgpr_read_b32 v16, a94
    v_mul_f32 v62, v62, v27
    v_fmac_f32 v62, v16, v26
    v_accvgpr_read_b32 v16, a95
    v_mul_f32 v63, v63, v27
    v_fmac_f32 v63, v16, v26
    v_cvt_pk_bf16_f32 v104, v48, v49
    v_cvt_pk_bf16_f32 v105, v50, v51
    v_cvt_pk_bf16_f32 v106, v52, v53
    v_cvt_pk_bf16_f32 v107, v54, v55
    v_cvt_pk_bf16_f32 v108, v56, v57
    v_cvt_pk_bf16_f32 v109, v58, v59
    v_cvt_pk_bf16_f32 v110, v60, v61
    v_cvt_pk_bf16_f32 v111, v62, v63
    s_add_u32 s62, s61, 131072
    buffer_store_dwordx4 v[104:107], v25, s[16:19], s62 offen
    s_add_u32 s62, s61, 163840
    buffer_store_dwordx4 v[108:111], v25, s[16:19], s62 offen
L_at8_f2:
    s_add_u32 s44, s44, 1
    s_cmp_lt_u32 s44, 2
    s_cbranch_scc1 L_at8_job
    s_waitcnt vmcnt(0)
L_at8_end:
    s_endpgm
.globl oproj_kernel
.p2align 8
.type oproj_kernel,@function
oproj_kernel:
    s_cmp_ge_u32 s2, 256
    s_cbranch_scc1 L_op_end
    s_load_dwordx2 s[18:19], s[0:1], 40
    s_load_dwordx2 s[24:25], s[0:1], 112
    v_and_b32 v1, 63, v0
    v_lshrrev_b32 v2, 6, v0
    s_nop 0
    v_readfirstlane_b32 s38, v2
    s_and_b32 s30, s2, 7
    s_lshr_b32 s31, s2, 3
    s_lshr_b32 s58, s30, 1
    s_and_b32 s32, s30, 1
    s_lshl_b32 s32, s32, 3
    s_and_b32 s59, s31, 3
    s_lshr_b32 s31, s31, 2
    s_add_u32 s31, s31, s32
    s_lshl_b32 s39, s31, 7
    s_lshl_b32 s32, s38, 5
    s_add_u32 s39, s39, s32
    s_mov_b32 s37, 1024
    s_lshl_b32 s36, s58, 20
    s_lshl_b32 s33, s59, 8
    s_add_u32 s36, s36, s33
    v_lshrrev_b32 v2, 4, v1
    v_and_b32 v3, 15, v1
    v_lshrrev_b32 v4, 2, v3
    v_and_b32 v5, 3, v3
    v_lshrrev_b32 v6, 1, v2
    v_lshl_add_u32 v6, v6, 4, v4
    v_lshlrev_b32 v6, 7, v6
    v_and_b32 v7, 1, v2
    v_lshlrev_b32 v7, 1, v7
    v_lshrrev_b32 v2, 1, v5
    v_add_u32 v7, v7, v2
    v_lshrrev_b32 v2, 1, v4
    v_lshl_add_u32 v7, v2, 2, v7
    v_lshl_add_u32 v6, v7, 4, v6
    v_and_b32 v2, 1, v5
    v_lshl_add_u32 v12, v2, 3, v6
    v_xor_b32 v13, 64, v12
    v_mov_b32 v8, v12
    v_mov_b32 v9, v13
    v_add_u32 v10, 32768, v12
    v_add_u32 v11, 32768, v13
    s_mov_b32 s43, 32768
    v_lshrrev_b32 v2, 3, v1
    v_bfe_u32 v4, v1, 4, 1
    v_lshlrev_b32 v4, 2, v4
    v_and_b32 v3, 7, v1
    v_xor_b32 v3, v3, v4
    s_lshl_b32 s30, s38, 6
    v_add_u32 v2, s30, v2
    v_mul_lo_u32 v2, v2, s37
    v_lshl_add_u32 v2, v3, 4, v2
    v_add_u32 v14, s36, v2
    s_mul_i32 s44, s37, 0
    s_mul_i32 s45, s37, 8
    s_mul_i32 s46, s37, 16
    s_mul_i32 s47, s37, 24
    s_mul_i32 s48, s37, 32
    s_mul_i32 s49, s37, 40
    s_mul_i32 s50, s37, 48
    s_mul_i32 s51, s37, 56
    s_lshl_b32 s42, s38, 13
    s_mov_b32 s41, 0
    s_mov_b32 s40, s42
    v_and_b32 v2, 31, v1
    v_add_u32 v2, s39, v2
    v_lshlrev_b32 v2, 4, v2
    v_lshrrev_b32 v3, 5, v1
    v_lshl_add_u32 v19, v3, 15, v2
    s_waitcnt lgkmcnt(0)
    s_mov_b32 s8, s18
    s_mov_b32 s9, s19
    s_and_b32 s9, s9, 0xffff
    s_mov_b32 s10, 4194304
    s_mov_b32 s11, 0x00020000
    s_add_u32 s4, s24, 54525952
    s_addc_u32 s5, s25, 0
    s_and_b32 s5, s5, 0xffff
    s_mov_b32 s6, 16777216
    s_mov_b32 s7, 0x00020000
    s_add_u32 s12, s24, 71303168
    s_addc_u32 s13, s25, 0
    s_and_b32 s13, s13, 0xffff
    s_mov_b32 s14, 16777216
    s_mov_b32 s15, 0x00020000
    s_add_u32 m0, s40, 0
    s_nop 0
    buffer_load_dwordx4 v14, s[8:11], s44 offen lds
    s_add_u32 m0, s40, 1024
    s_nop 0
    buffer_load_dwordx4 v14, s[8:11], s45 offen lds
    s_add_u32 m0, s40, 2048
    s_nop 0
    buffer_load_dwordx4 v14, s[8:11], s46 offen lds
    s_add_u32 m0, s40, 3072
    s_nop 0
    buffer_load_dwordx4 v14, s[8:11], s47 offen lds
    s_add_u32 m0, s40, 4096
    s_nop 0
    buffer_load_dwordx4 v14, s[8:11], s48 offen lds
    s_add_u32 m0, s40, 5120
    s_nop 0
    buffer_load_dwordx4 v14, s[8:11], s49 offen lds
    s_add_u32 m0, s40, 6144
    s_nop 0
    buffer_load_dwordx4 v14, s[8:11], s50 offen lds
    s_add_u32 m0, s40, 7168
    s_nop 0
    buffer_load_dwordx4 v14, s[8:11], s51 offen lds
    v_add_u32 v14, 262144, v14
    s_add_u32 s41, s41, 32768
    s_and_b32 s41, s41, 0x1ffff
    s_add_u32 s40, s41, s42
    s_lshl_b32 s57, s58, 22
    s_add_u32 s30, s57, 0
    buffer_load_dwordx4 a[0:3], v19, s[4:7], s30 offen offset:0
    s_add_u32 s30, s57, 65536
    buffer_load_dwordx4 a[4:7], v19, s[4:7], s30 offen offset:0
    s_add_u32 s30, s57, 131072
    buffer_load_dwordx4 a[8:11], v19, s[4:7], s30 offen offset:0
    s_add_u32 s30, s57, 196608
    buffer_load_dwordx4 a[12:15], v19, s[4:7], s30 offen offset:0
    s_add_u32 s30, s57, 262144
    buffer_load_dwordx4 a[16:19], v19, s[4:7], s30 offen offset:0
    s_add_u32 s30, s57, 327680
    buffer_load_dwordx4 a[20:23], v19, s[4:7], s30 offen offset:0
    s_add_u32 s30, s57, 393216
    buffer_load_dwordx4 a[24:27], v19, s[4:7], s30 offen offset:0
    s_add_u32 s30, s57, 458752
    buffer_load_dwordx4 a[28:31], v19, s[4:7], s30 offen offset:0
    s_add_u32 m0, s40, 0
    s_nop 0
    buffer_load_dwordx4 v14, s[8:11], s44 offen lds
    s_add_u32 m0, s40, 1024
    s_nop 0
    buffer_load_dwordx4 v14, s[8:11], s45 offen lds
    s_add_u32 m0, s40, 2048
    s_nop 0
    buffer_load_dwordx4 v14, s[8:11], s46 offen lds
    s_add_u32 m0, s40, 3072
    s_nop 0
    buffer_load_dwordx4 v14, s[8:11], s47 offen lds
    s_add_u32 m0, s40, 4096
    s_nop 0
    buffer_load_dwordx4 v14, s[8:11], s48 offen lds
    s_add_u32 m0, s40, 5120
    s_nop 0
    buffer_load_dwordx4 v14, s[8:11], s49 offen lds
    s_add_u32 m0, s40, 6144
    s_nop 0
    buffer_load_dwordx4 v14, s[8:11], s50 offen lds
    s_add_u32 m0, s40, 7168
    s_nop 0
    buffer_load_dwordx4 v14, s[8:11], s51 offen lds
    v_add_u32 v14, 262144, v14
    s_add_u32 s41, s41, 32768
    s_and_b32 s41, s41, 0x1ffff
    s_add_u32 s40, s41, s42
    s_add_u32 m0, s40, 0
    s_nop 0
    buffer_load_dwordx4 v14, s[8:11], s44 offen lds
    s_add_u32 m0, s40, 1024
    s_nop 0
    buffer_load_dwordx4 v14, s[8:11], s45 offen lds
    s_add_u32 m0, s40, 2048
    s_nop 0
    buffer_load_dwordx4 v14, s[8:11], s46 offen lds
    s_add_u32 m0, s40, 3072
    s_nop 0
    buffer_load_dwordx4 v14, s[8:11], s47 offen lds
    s_add_u32 m0, s40, 4096
    s_nop 0
    buffer_load_dwordx4 v14, s[8:11], s48 offen lds
    s_add_u32 m0, s40, 5120
    s_nop 0
    buffer_load_dwordx4 v14, s[8:11], s49 offen lds
    s_add_u32 m0, s40, 6144
    s_nop 0
    buffer_load_dwordx4 v14, s[8:11], s50 offen lds
    s_add_u32 m0, s40, 7168
    s_nop 0
    buffer_load_dwordx4 v14, s[8:11], s51 offen lds
    v_add_u32 v14, 262144, v14
    s_add_u32 s41, s41, 32768
    s_and_b32 s41, s41, 0x1ffff
    s_add_u32 s40, s41, s42
    v_and_b32 v4, 31, v1
    v_lshrrev_b32 v5, 5, v1
    v_add_u32 v6, s39, v4
    v_lshlrev_b32 v6, 4, v6
    v_lshl_add_u32 v15, v5, 16, v6
    s_lshl_b32 s60, s58, 21
    s_lshl_b32 s33, s59, 19
    s_add_u32 s60, s60, s33
    s_waitcnt vmcnt(24)
    s_barrier
    ds_read_b64_tr_b16 v[32:33], v8 offset:0
    ds_read_b64_tr_b16 v[34:35], v8 offset:1024
    ds_read_b64_tr_b16 v[36:37], v9 offset:0
    ds_read_b64_tr_b16 v[38:39], v9 offset:1024
    ds_read_b64_tr_b16 v[40:41], v8 offset:512
    ds_read_b64_tr_b16 v[42:43], v8 offset:1536
    s_waitcnt lgkmcnt(4)
    ds_read_b64_tr_b16 v[44:45], v9 offset:512
    ds_read_b64_tr_b16 v[46:47], v9 offset:1536
    s_add_u32 s30, s57, 524288
    buffer_load_dwordx4 a[32:35], v19, s[4:7], s30 offen offset:0
    s_waitcnt vmcnt(24)
    v_mfma_f32_32x32x16_bf16 v[64:79], v[32:35], a[0:3], 0
    s_waitcnt lgkmcnt(4)
    ds_read_b64_tr_b16 v[32:33], v8 offset:4096
    ds_read_b64_tr_b16 v[34:35], v8 offset:5120
    v_mfma_f32_32x32x16_bf16 v[80:95], v[36:39], a[0:3], 0
    s_waitcnt lgkmcnt(4)
    ds_read_b64_tr_b16 v[36:37], v9 offset:4096
    ds_read_b64_tr_b16 v[38:39], v9 offset:5120
    s_add_u32 s30, s57, 589824
    buffer_load_dwordx4 a[36:39], v19, s[4:7], s30 offen offset:0
    s_waitcnt vmcnt(24)
    v_mfma_f32_32x32x16_bf16 v[64:79], v[40:43], a[4:7], v[64:79]
    s_waitcnt lgkmcnt(4)
    ds_read_b64_tr_b16 v[40:41], v8 offset:4608
    ds_read_b64_tr_b16 v[42:43], v8 offset:5632
    v_mfma_f32_32x32x16_bf16 v[80:95], v[44:47], a[4:7], v[80:95]
    s_waitcnt lgkmcnt(4)
    ds_read_b64_tr_b16 v[44:45], v9 offset:4608
    ds_read_b64_tr_b16 v[46:47], v9 offset:5632
    s_add_u32 s30, s57, 655360
    buffer_load_dwordx4 a[40:43], v19, s[4:7], s30 offen offset:0
    s_waitcnt vmcnt(24)
    v_mfma_f32_32x32x16_bf16 v[64:79], v[32:35], a[8:11], v[64:79]
    s_waitcnt lgkmcnt(4)
    ds_read_b64_tr_b16 v[32:33], v8 offset:8192
    ds_read_b64_tr_b16 v[34:35], v8 offset:9216
    v_mfma_f32_32x32x16_bf16 v[80:95], v[36:39], a[8:11], v[80:95]
    s_waitcnt lgkmcnt(4)
    ds_read_b64_tr_b16 v[36:37], v9 offset:8192
    ds_read_b64_tr_b16 v[38:39], v9 offset:9216
    s_add_u32 s30, s57, 720896
    buffer_load_dwordx4 a[44:47], v19, s[4:7], s30 offen offset:0
    s_waitcnt vmcnt(24)
    v_mfma_f32_32x32x16_bf16 v[64:79], v[40:43], a[12:15], v[64:79]
    s_waitcnt lgkmcnt(4)
    ds_read_b64_tr_b16 v[40:41], v8 offset:8704
    ds_read_b64_tr_b16 v[42:43], v8 offset:9728
    v_mfma_f32_32x32x16_bf16 v[80:95], v[44:47], a[12:15], v[80:95]
    s_waitcnt lgkmcnt(4)
    ds_read_b64_tr_b16 v[44:45], v9 offset:8704
    ds_read_b64_tr_b16 v[46:47], v9 offset:9728
    s_add_u32 s30, s57, 786432
    buffer_load_dwordx4 a[48:51], v19, s[4:7], s30 offen offset:0
    s_waitcnt vmcnt(24)
    v_mfma_f32_32x32x16_bf16 v[64:79], v[32:35], a[16:19], v[64:79]
    s_waitcnt lgkmcnt(4)
    ds_read_b64_tr_b16 v[32:33], v8 offset:12288
    ds_read_b64_tr_b16 v[34:35], v8 offset:13312
    v_mfma_f32_32x32x16_bf16 v[80:95], v[36:39], a[16:19], v[80:95]
    s_waitcnt lgkmcnt(4)
    ds_read_b64_tr_b16 v[36:37], v9 offset:12288
    ds_read_b64_tr_b16 v[38:39], v9 offset:13312
    s_add_u32 s30, s57, 851968
    buffer_load_dwordx4 a[52:55], v19, s[4:7], s30 offen offset:0
    s_waitcnt vmcnt(24)
    v_mfma_f32_32x32x16_bf16 v[64:79], v[40:43], a[20:23], v[64:79]
    s_waitcnt lgkmcnt(4)
    ds_read_b64_tr_b16 v[40:41], v8 offset:12800
    ds_read_b64_tr_b16 v[42:43], v8 offset:13824
    v_mfma_f32_32x32x16_bf16 v[80:95], v[44:47], a[20:23], v[80:95]
    s_waitcnt lgkmcnt(4)
    ds_read_b64_tr_b16 v[44:45], v9 offset:12800
    ds_read_b64_tr_b16 v[46:47], v9 offset:13824
    s_add_u32 s30, s57, 917504
    buffer_load_dwordx4 a[56:59], v19, s[4:7], s30 offen offset:0
    s_waitcnt vmcnt(24)
    v_mfma_f32_32x32x16_bf16 v[64:79], v[32:35], a[24:27], v[64:79]
    s_waitcnt lgkmcnt(4)
    ds_read_b64_tr_b16 v[32:33], v8 offset:16384
    ds_read_b64_tr_b16 v[34:35], v8 offset:17408
    v_mfma_f32_32x32x16_bf16 v[80:95], v[36:39], a[24:27], v[80:95]
    s_waitcnt lgkmcnt(4)
    ds_read_b64_tr_b16 v[36:37], v9 offset:16384
    ds_read_b64_tr_b16 v[38:39], v9 offset:17408
    s_add_u32 s30, s57, 983040
    buffer_load_dwordx4 a[60:63], v19, s[4:7], s30 offen offset:0
    s_waitcnt vmcnt(24)
    v_mfma_f32_32x32x16_bf16 v[64:79], v[40:43], a[28:31], v[64:79]
    s_waitcnt lgkmcnt(4)
    ds_read_b64_tr_b16 v[40:41], v8 offset:16896
    ds_read_b64_tr_b16 v[42:43], v8 offset:17920
    v_mfma_f32_32x32x16_bf16 v[80:95], v[44:47], a[28:31], v[80:95]
    s_waitcnt vmcnt(16)
    s_barrier
    s_waitcnt lgkmcnt(4)
    ds_read_b64_tr_b16 v[44:45], v9 offset:16896
    ds_read_b64_tr_b16 v[46:47], v9 offset:17920
    s_add_u32 s30, s57, 1048576
    buffer_load_dwordx4 a[64:67], v19, s[4:7], s30 offen offset:0
    s_waitcnt vmcnt(8)
    v_mfma_f32_32x32x16_bf16 v[64:79], v[32:35], a[32:35], v[64:79]
    s_waitcnt lgkmcnt(4)
    ds_read_b64_tr_b16 v[32:33], v8 offset:20480
    ds_read_b64_tr_b16 v[34:35], v8 offset:21504
    v_mfma_f32_32x32x16_bf16 v[80:95], v[36:39], a[32:35], v[80:95]
    s_waitcnt lgkmcnt(4)
    ds_read_b64_tr_b16 v[36:37], v9 offset:20480
    ds_read_b64_tr_b16 v[38:39], v9 offset:21504
    s_add_u32 s30, s57, 1114112
    buffer_load_dwordx4 a[68:71], v19, s[4:7], s30 offen offset:0
    s_waitcnt vmcnt(8)
    s_add_u32 m0, s40, 0
    s_nop 0
    buffer_load_dwordx4 v14, s[8:11], s44 offen lds
    v_mfma_f32_32x32x16_bf16 v[64:79], v[40:43], a[36:39], v[64:79]
    s_waitcnt lgkmcnt(4)
    ds_read_b64_tr_b16 v[40:41], v8 offset:20992
    ds_read_b64_tr_b16 v[42:43], v8 offset:22016
    s_add_u32 m0, s40, 1024
    s_nop 0
    buffer_load_dwordx4 v14, s[8:11], s45 offen lds
    v_mfma_f32_32x32x16_bf16 v[80:95], v[44:47], a[36:39], v[80:95]
    s_waitcnt lgkmcnt(4)
    ds_read_b64_tr_b16 v[44:45], v9 offset:20992
    ds_read_b64_tr_b16 v[46:47], v9 offset:22016
    s_add_u32 s30, s57, 1179648
    buffer_load_dwordx4 a[72:75], v19, s[4:7], s30 offen offset:0
    s_waitcnt vmcnt(10)
    v_mfma_f32_32x32x16_bf16 v[64:79], v[32:35], a[40:43], v[64:79]
    s_waitcnt lgkmcnt(4)
    ds_read_b64_tr_b16 v[32:33], v8 offset:24576
    ds_read_b64_tr_b16 v[34:35], v8 offset:25600
    s_add_u32 m0, s40, 2048
    s_nop 0
    buffer_load_dwordx4 v14, s[8:11], s46 offen lds
    v_mfma_f32_32x32x16_bf16 v[80:95], v[36:39], a[40:43], v[80:95]
    s_waitcnt lgkmcnt(4)
    ds_read_b64_tr_b16 v[36:37], v9 offset:24576
    ds_read_b64_tr_b16 v[38:39], v9 offset:25600
    s_add_u32 s30, s57, 1245184
    buffer_load_dwordx4 a[76:79], v19, s[4:7], s30 offen offset:0
    s_waitcnt vmcnt(11)
    s_add_u32 m0, s40, 3072
    s_nop 0
    buffer_load_dwordx4 v14, s[8:11], s47 offen lds
    v_mfma_f32_32x32x16_bf16 v[64:79], v[40:43], a[44:47], v[64:79]
    s_waitcnt lgkmcnt(4)
    ds_read_b64_tr_b16 v[40:41], v8 offset:25088
    ds_read_b64_tr_b16 v[42:43], v8 offset:26112
    v_mfma_f32_32x32x16_bf16 v[80:95], v[44:47], a[44:47], v[80:95]
    s_waitcnt lgkmcnt(4)
    ds_read_b64_tr_b16 v[44:45], v9 offset:25088
    ds_read_b64_tr_b16 v[46:47], v9 offset:26112
    s_add_u32 s30, s57, 1310720
    buffer_load_dwordx4 a[80:83], v19, s[4:7], s30 offen offset:0
    s_waitcnt vmcnt(12)
    s_add_u32 m0, s40, 4096
    s_nop 0
    buffer_load_dwordx4 v14, s[8:11], s48 offen lds
    v_mfma_f32_32x32x16_bf16 v[64:79], v[32:35], a[48:51], v[64:79]
    s_waitcnt lgkmcnt(4)
    ds_read_b64_tr_b16 v[32:33], v8 offset:28672
    ds_read_b64_tr_b16 v[34:35], v8 offset:29696
    s_add_u32 m0, s40, 5120
    s_nop 0
    buffer_load_dwordx4 v14, s[8:11], s49 offen lds
    v_mfma_f32_32x32x16_bf16 v[80:95], v[36:39], a[48:51], v[80:95]
    s_waitcnt lgkmcnt(4)
    ds_read_b64_tr_b16 v[36:37], v9 offset:28672
    ds_read_b64_tr_b16 v[38:39], v9 offset:29696
    s_add_u32 s30, s57, 1376256
    buffer_load_dwordx4 a[84:87], v19, s[4:7], s30 offen offset:0
    s_waitcnt vmcnt(14)
    v_mfma_f32_32x32x16_bf16 v[64:79], v[40:43], a[52:55], v[64:79]
    s_waitcnt lgkmcnt(4)
    ds_read_b64_tr_b16 v[40:41], v8 offset:29184
    ds_read_b64_tr_b16 v[42:43], v8 offset:30208
    s_add_u32 m0, s40, 6144
    s_nop 0
    buffer_load_dwordx4 v14, s[8:11], s50 offen lds
    v_mfma_f32_32x32x16_bf16 v[80:95], v[44:47], a[52:55], v[80:95]
    s_waitcnt lgkmcnt(4)
    ds_read_b64_tr_b16 v[44:45], v9 offset:29184
    ds_read_b64_tr_b16 v[46:47], v9 offset:30208
    s_add_u32 s30, s57, 1441792
    buffer_load_dwordx4 a[88:91], v19, s[4:7], s30 offen offset:0
    s_waitcnt vmcnt(15)
    s_add_u32 m0, s40, 7168
    s_nop 0
    buffer_load_dwordx4 v14, s[8:11], s51 offen lds
    v_mfma_f32_32x32x16_bf16 v[64:79], v[32:35], a[56:59], v[64:79]
    s_waitcnt lgkmcnt(4)
    ds_read_b64_tr_b16 v[32:33], v10 offset:0
    ds_read_b64_tr_b16 v[34:35], v10 offset:1024
    v_mfma_f32_32x32x16_bf16 v[80:95], v[36:39], a[56:59], v[80:95]
    s_waitcnt lgkmcnt(4)
    ds_read_b64_tr_b16 v[36:37], v11 offset:0
    ds_read_b64_tr_b16 v[38:39], v11 offset:1024
    s_add_u32 s30, s57, 1507328
    buffer_load_dwordx4 a[92:95], v19, s[4:7], s30 offen offset:0
    s_waitcnt vmcnt(16)
    v_mfma_f32_32x32x16_bf16 v[64:79], v[40:43], a[60:63], v[64:79]
    s_waitcnt lgkmcnt(4)
    ds_read_b64_tr_b16 v[40:41], v10 offset:512
    ds_read_b64_tr_b16 v[42:43], v10 offset:1536
    v_add_u32 v14, 4294180992, v14
    s_add_u32 s41, s41, 32768
    s_and_b32 s41, s41, 0x1ffff
    s_add_u32 s40, s41, s42
    v_mfma_f32_32x32x16_bf16 v[80:95], v[44:47], a[60:63], v[80:95]
    v_mov_b32 v8, v10
    v_mov_b32 v9, v11
    s_add_u32 s43, s43, 32768
    s_and_b32 s43, s43, 0x1ffff
    v_add_u32 v10, s43, v12
    v_add_u32 v11, s43, v13
    s_waitcnt lgkmcnt(4)
    ds_read_b64_tr_b16 v[44:45], v9 offset:512
    ds_read_b64_tr_b16 v[46:47], v9 offset:1536
    s_add_u32 s30, s57, 1572864
    buffer_load_dwordx4 a[96:99], v19, s[4:7], s30 offen offset:0
    s_waitcnt vmcnt(16)
    v_mfma_f32_32x32x16_bf16 v[64:79], v[32:35], a[64:67], v[64:79]
    s_waitcnt lgkmcnt(4)
    ds_read_b64_tr_b16 v[32:33], v8 offset:4096
    ds_read_b64_tr_b16 v[34:35], v8 offset:5120
    v_mfma_f32_32x32x16_bf16 v[80:95], v[36:39], a[64:67], v[80:95]
    s_waitcnt lgkmcnt(4)
    ds_read_b64_tr_b16 v[36:37], v9 offset:4096
    ds_read_b64_tr_b16 v[38:39], v9 offset:5120
    s_add_u32 s30, s57, 1638400
    buffer_load_dwordx4 a[100:103], v19, s[4:7], s30 offen offset:0
    s_waitcnt vmcnt(16)
    v_mfma_f32_32x32x16_bf16 v[64:79], v[40:43], a[68:71], v[64:79]
    s_waitcnt lgkmcnt(4)
    ds_read_b64_tr_b16 v[40:41], v8 offset:4608
    ds_read_b64_tr_b16 v[42:43], v8 offset:5632
    v_mfma_f32_32x32x16_bf16 v[80:95], v[44:47], a[68:71], v[80:95]
    s_waitcnt lgkmcnt(4)
    ds_read_b64_tr_b16 v[44:45], v9 offset:4608
    ds_read_b64_tr_b16 v[46:47], v9 offset:5632
    s_add_u32 s30, s57, 1703936
    buffer_load_dwordx4 a[104:107], v19, s[4:7], s30 offen offset:0
    s_waitcnt vmcnt(14)
    v_mfma_f32_32x32x16_bf16 v[64:79], v[32:35], a[72:75], v[64:79]
    s_waitcnt lgkmcnt(4)
    ds_read_b64_tr_b16 v[32:33], v8 offset:8192
    ds_read_b64_tr_b16 v[34:35], v8 offset:9216
    v_mfma_f32_32x32x16_bf16 v[80:95], v[36:39], a[72:75], v[80:95]
    s_waitcnt lgkmcnt(4)
    ds_read_b64_tr_b16 v[36:37], v9 offset:8192
    ds_read_b64_tr_b16 v[38:39], v9 offset:9216
    s_add_u32 s30, s57, 1769472
    buffer_load_dwordx4 a[108:111], v19, s[4:7], s30 offen offset:0
    s_waitcnt vmcnt(13)
    v_mfma_f32_32x32x16_bf16 v[64:79], v[40:43], a[76:79], v[64:79]
    s_waitcnt lgkmcnt(4)
    ds_read_b64_tr_b16 v[40:41], v8 offset:8704
    ds_read_b64_tr_b16 v[42:43], v8 offset:9728
    v_mfma_f32_32x32x16_bf16 v[80:95], v[44:47], a[76:79], v[80:95]
    s_waitcnt lgkmcnt(4)
    ds_read_b64_tr_b16 v[44:45], v9 offset:8704
    ds_read_b64_tr_b16 v[46:47], v9 offset:9728
    s_add_u32 s30, s57, 1835008
    buffer_load_dwordx4 a[112:115], v19, s[4:7], s30 offen offset:0
    s_waitcnt vmcnt(12)
    v_mfma_f32_32x32x16_bf16 v[64:79], v[32:35], a[80:83], v[64:79]
    s_waitcnt lgkmcnt(4)
    ds_read_b64_tr_b16 v[32:33], v8 offset:12288
    ds_read_b64_tr_b16 v[34:35], v8 offset:13312
    v_mfma_f32_32x32x16_bf16 v[80:95], v[36:39], a[80:83], v[80:95]
    s_waitcnt lgkmcnt(4)
    ds_read_b64_tr_b16 v[36:37], v9 offset:12288
    ds_read_b64_tr_b16 v[38:39], v9 offset:13312
    s_add_u32 s30, s57, 1900544
    buffer_load_dwordx4 a[116:119], v19, s[4:7], s30 offen offset:0
    s_waitcnt vmcnt(10)
    v_mfma_f32_32x32x16_bf16 v[64:79], v[40:43], a[84:87], v[64:79]
    s_waitcnt lgkmcnt(4)
    ds_read_b64_tr_b16 v[40:41], v8 offset:12800
    ds_read_b64_tr_b16 v[42:43], v8 offset:13824
    v_mfma_f32_32x32x16_bf16 v[80:95], v[44:47], a[84:87], v[80:95]
    s_waitcnt lgkmcnt(4)
    ds_read_b64_tr_b16 v[44:45], v9 offset:12800
    ds_read_b64_tr_b16 v[46:47], v9 offset:13824
    s_add_u32 s30, s57, 1966080
    buffer_load_dwordx4 a[120:123], v19, s[4:7], s30 offen offset:0
    s_waitcnt vmcnt(9)
    v_mfma_f32_32x32x16_bf16 v[64:79], v[32:35], a[88:91], v[64:79]
    s_waitcnt lgkmcnt(4)
    ds_read_b64_tr_b16 v[32:33], v8 offset:16384
    ds_read_b64_tr_b16 v[34:35], v8 offset:17408
    v_mfma_f32_32x32x16_bf16 v[80:95], v[36:39], a[88:91], v[80:95]
    s_waitcnt lgkmcnt(4)
    ds_read_b64_tr_b16 v[36:37], v9 offset:16384
    ds_read_b64_tr_b16 v[38:39], v9 offset:17408
    s_add_u32 s30, s57, 2031616
    buffer_load_dwordx4 a[124:127], v19, s[4:7], s30 offen offset:0
    s_waitcnt vmcnt(8)
    v_mfma_f32_32x32x16_bf16 v[64:79], v[40:43], a[92:95], v[64:79]
    s_waitcnt lgkmcnt(4)
    ds_read_b64_tr_b16 v[40:41], v8 offset:16896
    ds_read_b64_tr_b16 v[42:43], v8 offset:17920
    v_mfma_f32_32x32x16_bf16 v[80:95], v[44:47], a[92:95], v[80:95]
    s_waitcnt vmcnt(32)
    s_barrier
    s_waitcnt lgkmcnt(4)
    ds_read_b64_tr_b16 v[44:45], v9 offset:16896
    ds_read_b64_tr_b16 v[46:47], v9 offset:17920
    s_add_u32 s30, s57, 2097152
    buffer_load_dwordx4 a[128:131], v19, s[4:7], s30 offen offset:0
    s_waitcnt vmcnt(8)
    v_mfma_f32_32x32x16_bf16 v[64:79], v[32:35], a[96:99], v[64:79]
    s_waitcnt lgkmcnt(4)
    ds_read_b64_tr_b16 v[32:33], v8 offset:20480
    ds_read_b64_tr_b16 v[34:35], v8 offset:21504
    v_mfma_f32_32x32x16_bf16 v[80:95], v[36:39], a[96:99], v[80:95]
    s_waitcnt lgkmcnt(4)
    ds_read_b64_tr_b16 v[36:37], v9 offset:20480
    ds_read_b64_tr_b16 v[38:39], v9 offset:21504
    s_add_u32 s30, s57, 2162688
    buffer_load_dwordx4 a[132:135], v19, s[4:7], s30 offen offset:0
    s_waitcnt vmcnt(8)
    s_add_u32 m0, s40, 0
    s_nop 0
    buffer_load_dwordx4 v14, s[8:11], s44 offen lds
    v_mfma_f32_32x32x16_bf16 v[64:79], v[40:43], a[100:103], v[64:79]
    s_waitcnt lgkmcnt(4)
    ds_read_b64_tr_b16 v[40:41], v8 offset:20992
    ds_read_b64_tr_b16 v[42:43], v8 offset:22016
    s_add_u32 m0, s40, 1024
    s_nop 0
    buffer_load_dwordx4 v14, s[8:11], s45 offen lds
    v_mfma_f32_32x32x16_bf16 v[80:95], v[44:47], a[100:103], v[80:95]
    s_waitcnt lgkmcnt(4)
    ds_read_b64_tr_b16 v[44:45], v9 offset:20992
    ds_read_b64_tr_b16 v[46:47], v9 offset:22016
    s_add_u32 s30, s57, 2228224
    buffer_load_dwordx4 a[136:139], v19, s[4:7], s30 offen offset:0
    s_waitcnt vmcnt(10)
    v_mfma_f32_32x32x16_bf16 v[64:79], v[32:35], a[104:107], v[64:79]
    s_waitcnt lgkmcnt(4)
    ds_read_b64_tr_b16 v[32:33], v8 offset:24576
    ds_read_b64_tr_b16 v[34:35], v8 offset:25600
    s_add_u32 m0, s40, 2048
    s_nop 0
    buffer_load_dwordx4 v14, s[8:11], s46 offen lds
    v_mfma_f32_32x32x16_bf16 v[80:95], v[36:39], a[104:107], v[80:95]
    s_waitcnt lgkmcnt(4)
    ds_read_b64_tr_b16 v[36:37], v9 offset:24576
    ds_read_b64_tr_b16 v[38:39], v9 offset:25600
    s_add_u32 s30, s57, 2293760
    buffer_load_dwordx4 a[140:143], v19, s[4:7], s30 offen offset:0
    s_waitcnt vmcnt(11)
    s_add_u32 m0, s40, 3072
    s_nop 0
    buffer_load_dwordx4 v14, s[8:11], s47 offen lds
    v_mfma_f32_32x32x16_bf16 v[64:79], v[40:43], a[108:111], v[64:79]
    s_waitcnt lgkmcnt(4)
    ds_read_b64_tr_b16 v[40:41], v8 offset:25088
    ds_read_b64_tr_b16 v[42:43], v8 offset:26112
    v_mfma_f32_32x32x16_bf16 v[80:95], v[44:47], a[108:111], v[80:95]
    s_waitcnt lgkmcnt(4)
    ds_read_b64_tr_b16 v[44:45], v9 offset:25088
    ds_read_b64_tr_b16 v[46:47], v9 offset:26112
    s_add_u32 s30, s57, 2359296
    buffer_load_dwordx4 a[144:147], v19, s[4:7], s30 offen offset:0
    s_waitcnt vmcnt(12)
    s_add_u32 m0, s40, 4096
    s_nop 0
    buffer_load_dwordx4 v14, s[8:11], s48 offen lds
    v_mfma_f32_32x32x16_bf16 v[64:79], v[32:35], a[112:115], v[64:79]
    s_waitcnt lgkmcnt(4)
    ds_read_b64_tr_b16 v[32:33], v8 offset:28672
    ds_read_b64_tr_b16 v[34:35], v8 offset:29696
    s_add_u32 m0, s40, 5120
    s_nop 0
    buffer_load_dwordx4 v14, s[8:11], s49 offen lds
    v_mfma_f32_32x32x16_bf16 v[80:95], v[36:39], a[112:115], v[80:95]
    s_waitcnt lgkmcnt(4)
    ds_read_b64_tr_b16 v[36:37], v9 offset:28672
    ds_read_b64_tr_b16 v[38:39], v9 offset:29696
    s_add_u32 s30, s57, 2424832
    buffer_load_dwordx4 a[148:151], v19, s[4:7], s30 offen offset:0
    s_waitcnt vmcnt(14)
    v_mfma_f32_32x32x16_bf16 v[64:79], v[40:43], a[116:119], v[64:79]
    s_waitcnt lgkmcnt(4)
    ds_read_b64_tr_b16 v[40:41], v8 offset:29184
    ds_read_b64_tr_b16 v[42:43], v8 offset:30208
    s_add_u32 m0, s40, 6144
    s_nop 0
    buffer_load_dwordx4 v14, s[8:11], s50 offen lds
    v_mfma_f32_32x32x16_bf16 v[80:95], v[44:47], a[116:119], v[80:95]
    s_waitcnt lgkmcnt(4)
    ds_read_b64_tr_b16 v[44:45], v9 offset:29184
    ds_read_b64_tr_b16 v[46:47], v9 offset:30208
    s_add_u32 s30, s57, 2490368
    buffer_load_dwordx4 a[152:155], v19, s[4:7], s30 offen offset:0
    s_waitcnt vmcnt(15)
    s_add_u32 m0, s40, 7168
    s_nop 0
    buffer_load_dwordx4 v14, s[8:11], s51 offen lds
    v_mfma_f32_32x32x16_bf16 v[64:79], v[32:35], a[120:123], v[64:79]
    s_waitcnt lgkmcnt(4)
    ds_read_b64_tr_b16 v[32:33], v10 offset:0
    ds_read_b64_tr_b16 v[34:35], v10 offset:1024
    v_mfma_f32_32x32x16_bf16 v[80:95], v[36:39], a[120:123], v[80:95]
    s_waitcnt lgkmcnt(4)
    ds_read_b64_tr_b16 v[36:37], v11 offset:0
    ds_read_b64_tr_b16 v[38:39], v11 offset:1024
    s_add_u32 s30, s57, 2555904
    buffer_load_dwordx4 a[156:159], v19, s[4:7], s30 offen offset:0
    s_waitcnt vmcnt(16)
    v_mfma_f32_32x32x16_bf16 v[64:79], v[40:43], a[124:127], v[64:79]
    s_waitcnt lgkmcnt(4)
    ds_read_b64_tr_b16 v[40:41], v10 offset:512
    ds_read_b64_tr_b16 v[42:43], v10 offset:1536
    v_add_u32 v14, 262144, v14
    s_add_u32 s41, s41, 32768
    s_and_b32 s41, s41, 0x1ffff
    s_add_u32 s40, s41, s42
    v_mfma_f32_32x32x16_bf16 v[80:95], v[44:47], a[124:127], v[80:95]
    v_mov_b32 v8, v10
    v_mov_b32 v9, v11
    s_add_u32 s43, s43, 32768
    s_and_b32 s43, s43, 0x1ffff
    v_add_u32 v10, s43, v12
    v_add_u32 v11, s43, v13
    s_waitcnt lgkmcnt(4)
    ds_read_b64_tr_b16 v[44:45], v9 offset:512
    ds_read_b64_tr_b16 v[46:47], v9 offset:1536
    s_add_u32 s30, s57, 2621440
    buffer_load_dwordx4 a[160:163], v19, s[4:7], s30 offen offset:0
    s_waitcnt vmcnt(16)
    v_mfma_f32_32x32x16_bf16 v[64:79], v[32:35], a[128:131], v[64:79]
    s_waitcnt lgkmcnt(4)
    ds_read_b64_tr_b16 v[32:33], v8 offset:4096
    ds_read_b64_tr_b16 v[34:35], v8 offset:5120
    v_mfma_f32_32x32x16_bf16 v[80:95], v[36:39], a[128:131], v[80:95]
    s_waitcnt lgkmcnt(4)
    ds_read_b64_tr_b16 v[36:37], v9 offset:4096
    ds_read_b64_tr_b16 v[38:39], v9 offset:5120
    s_add_u32 s30, s57, 2686976
    buffer_load_dwordx4 a[164:167], v19, s[4:7], s30 offen offset:0
    s_waitcnt vmcnt(16)
    v_mfma_f32_32x32x16_bf16 v[64:79], v[40:43], a[132:135], v[64:79]
    s_waitcnt lgkmcnt(4)
    ds_read_b64_tr_b16 v[40:41], v8 offset:4608
    ds_read_b64_tr_b16 v[42:43], v8 offset:5632
    v_mfma_f32_32x32x16_bf16 v[80:95], v[44:47], a[132:135], v[80:95]
    s_waitcnt lgkmcnt(4)
    ds_read_b64_tr_b16 v[44:45], v9 offset:4608
    ds_read_b64_tr_b16 v[46:47], v9 offset:5632
    s_add_u32 s30, s57, 2752512
    buffer_load_dwordx4 a[168:171], v19, s[4:7], s30 offen offset:0
    s_waitcnt vmcnt(14)
    v_mfma_f32_32x32x16_bf16 v[64:79], v[32:35], a[136:139], v[64:79]
    s_waitcnt lgkmcnt(4)
    ds_read_b64_tr_b16 v[32:33], v8 offset:8192
    ds_read_b64_tr_b16 v[34:35], v8 offset:9216
    v_mfma_f32_32x32x16_bf16 v[80:95], v[36:39], a[136:139], v[80:95]
    s_waitcnt lgkmcnt(4)
    ds_read_b64_tr_b16 v[36:37], v9 offset:8192
    ds_read_b64_tr_b16 v[38:39], v9 offset:9216
    s_add_u32 s30, s57, 2818048
    buffer_load_dwordx4 a[172:175], v19, s[4:7], s30 offen offset:0
    s_waitcnt vmcnt(13)
    v_mfma_f32_32x32x16_bf16 v[64:79], v[40:43], a[140:143], v[64:79]
    s_waitcnt lgkmcnt(4)
    ds_read_b64_tr_b16 v[40:41], v8 offset:8704
    ds_read_b64_tr_b16 v[42:43], v8 offset:9728
    v_mfma_f32_32x32x16_bf16 v[80:95], v[44:47], a[140:143], v[80:95]
    s_waitcnt lgkmcnt(4)
    ds_read_b64_tr_b16 v[44:45], v9 offset:8704
    ds_read_b64_tr_b16 v[46:47], v9 offset:9728
    s_add_u32 s30, s57, 2883584
    buffer_load_dwordx4 a[176:179], v19, s[4:7], s30 offen offset:0
    s_waitcnt vmcnt(12)
    v_mfma_f32_32x32x16_bf16 v[64:79], v[32:35], a[144:147], v[64:79]
    s_waitcnt lgkmcnt(4)
    ds_read_b64_tr_b16 v[32:33], v8 offset:12288
    ds_read_b64_tr_b16 v[34:35], v8 offset:13312
    v_mfma_f32_32x32x16_bf16 v[80:95], v[36:39], a[144:147], v[80:95]
    s_waitcnt lgkmcnt(4)
    ds_read_b64_tr_b16 v[36:37], v9 offset:12288
    ds_read_b64_tr_b16 v[38:39], v9 offset:13312
    s_add_u32 s30, s57, 2949120
    buffer_load_dwordx4 a[180:183], v19, s[4:7], s30 offen offset:0
    s_waitcnt vmcnt(10)
    v_mfma_f32_32x32x16_bf16 v[64:79], v[40:43], a[148:151], v[64:79]
    s_waitcnt lgkmcnt(4)
    ds_read_b64_tr_b16 v[40:41], v8 offset:12800
    ds_read_b64_tr_b16 v[42:43], v8 offset:13824
    v_mfma_f32_32x32x16_bf16 v[80:95], v[44:47], a[148:151], v[80:95]
    s_waitcnt lgkmcnt(4)
    ds_read_b64_tr_b16 v[44:45], v9 offset:12800
    ds_read_b64_tr_b16 v[46:47], v9 offset:13824
    s_add_u32 s30, s57, 3014656
    buffer_load_dwordx4 a[184:187], v19, s[4:7], s30 offen offset:0
    s_waitcnt vmcnt(9)
    v_mfma_f32_32x32x16_bf16 v[64:79], v[32:35], a[152:155], v[64:79]
    s_waitcnt lgkmcnt(4)
    ds_read_b64_tr_b16 v[32:33], v8 offset:16384
    ds_read_b64_tr_b16 v[34:35], v8 offset:17408
    v_mfma_f32_32x32x16_bf16 v[80:95], v[36:39], a[152:155], v[80:95]
    s_waitcnt lgkmcnt(4)
    ds_read_b64_tr_b16 v[36:37], v9 offset:16384
    ds_read_b64_tr_b16 v[38:39], v9 offset:17408
    s_add_u32 s30, s57, 3080192
    buffer_load_dwordx4 a[188:191], v19, s[4:7], s30 offen offset:0
    s_waitcnt vmcnt(8)
    v_mfma_f32_32x32x16_bf16 v[64:79], v[40:43], a[156:159], v[64:79]
    s_waitcnt lgkmcnt(4)
    ds_read_b64_tr_b16 v[40:41], v8 offset:16896
    ds_read_b64_tr_b16 v[42:43], v8 offset:17920
    v_mfma_f32_32x32x16_bf16 v[80:95], v[44:47], a[156:159], v[80:95]
    s_waitcnt vmcnt(33)
    s_barrier
    s_waitcnt lgkmcnt(4)
    ds_read_b64_tr_b16 v[44:45], v9 offset:16896
    ds_read_b64_tr_b16 v[46:47], v9 offset:17920
    s_add_u32 s30, s57, 3145728
    buffer_load_dwordx4 a[192:195], v19, s[4:7], s30 offen offset:0
    s_waitcnt vmcnt(8)
    v_mfma_f32_32x32x16_bf16 v[64:79], v[32:35], a[160:163], v[64:79]
    s_waitcnt lgkmcnt(4)
    ds_read_b64_tr_b16 v[32:33], v8 offset:20480
    ds_read_b64_tr_b16 v[34:35], v8 offset:21504
    v_mfma_f32_32x32x16_bf16 v[80:95], v[36:39], a[160:163], v[80:95]
    s_waitcnt lgkmcnt(4)
    ds_read_b64_tr_b16 v[36:37], v9 offset:20480
    ds_read_b64_tr_b16 v[38:39], v9 offset:21504
    s_add_u32 s30, s57, 3211264
    buffer_load_dwordx4 a[196:199], v19, s[4:7], s30 offen offset:0
    s_waitcnt vmcnt(8)
    s_add_u32 m0, s40, 0
    s_nop 0
    buffer_load_dwordx4 v14, s[8:11], s44 offen lds
    v_mfma_f32_32x32x16_bf16 v[64:79], v[40:43], a[164:167], v[64:79]
    s_waitcnt lgkmcnt(4)
    ds_read_b64_tr_b16 v[40:41], v8 offset:20992
    ds_read_b64_tr_b16 v[42:43], v8 offset:22016
    s_add_u32 m0, s40, 1024
    s_nop 0
    buffer_load_dwordx4 v14, s[8:11], s45 offen lds
    v_mfma_f32_32x32x16_bf16 v[80:95], v[44:47], a[164:167], v[80:95]
    s_waitcnt lgkmcnt(4)
    ds_read_b64_tr_b16 v[44:45], v9 offset:20992
    ds_read_b64_tr_b16 v[46:47], v9 offset:22016
    s_add_u32 s30, s57, 3276800
    buffer_load_dwordx4 a[200:203], v19, s[4:7], s30 offen offset:0
    s_waitcnt vmcnt(10)
    v_mfma_f32_32x32x16_bf16 v[64:79], v[32:35], a[168:171], v[64:79]
    s_waitcnt lgkmcnt(4)
    ds_read_b64_tr_b16 v[32:33], v8 offset:24576
    ds_read_b64_tr_b16 v[34:35], v8 offset:25600
    s_add_u32 m0, s40, 2048
    s_nop 0
    buffer_load_dwordx4 v14, s[8:11], s46 offen lds
    v_mfma_f32_32x32x16_bf16 v[80:95], v[36:39], a[168:171], v[80:95]
    s_waitcnt lgkmcnt(4)
    ds_read_b64_tr_b16 v[36:37], v9 offset:24576
    ds_read_b64_tr_b16 v[38:39], v9 offset:25600
    s_add_u32 s30, s57, 3342336
    buffer_load_dwordx4 a[204:207], v19, s[4:7], s30 offen offset:0
    s_waitcnt vmcnt(11)
    s_add_u32 m0, s40, 3072
    s_nop 0
    buffer_load_dwordx4 v14, s[8:11], s47 offen lds
    v_mfma_f32_32x32x16_bf16 v[64:79], v[40:43], a[172:175], v[64:79]
    s_waitcnt lgkmcnt(4)
    ds_read_b64_tr_b16 v[40:41], v8 offset:25088
    ds_read_b64_tr_b16 v[42:43], v8 offset:26112
    v_mfma_f32_32x32x16_bf16 v[80:95], v[44:47], a[172:175], v[80:95]
    s_waitcnt lgkmcnt(4)
    ds_read_b64_tr_b16 v[44:45], v9 offset:25088
    ds_read_b64_tr_b16 v[46:47], v9 offset:26112
    s_add_u32 s30, s57, 3407872
    buffer_load_dwordx4 a[208:211], v19, s[4:7], s30 offen offset:0
    s_waitcnt vmcnt(12)
    s_add_u32 m0, s40, 4096
    s_nop 0
    buffer_load_dwordx4 v14, s[8:11], s48 offen lds
    v_mfma_f32_32x32x16_bf16 v[64:79], v[32:35], a[176:179], v[64:79]
    s_waitcnt lgkmcnt(4)
    ds_read_b64_tr_b16 v[32:33], v8 offset:28672
    ds_read_b64_tr_b16 v[34:35], v8 offset:29696
    s_add_u32 m0, s40, 5120
    s_nop 0
    buffer_load_dwordx4 v14, s[8:11], s49 offen lds
    v_mfma_f32_32x32x16_bf16 v[80:95], v[36:39], a[176:179], v[80:95]
    s_waitcnt lgkmcnt(4)
    ds_read_b64_tr_b16 v[36:37], v9 offset:28672
    ds_read_b64_tr_b16 v[38:39], v9 offset:29696
    s_add_u32 s30, s57, 3473408
    buffer_load_dwordx4 a[212:215], v19, s[4:7], s30 offen offset:0
    s_waitcnt vmcnt(14)
    v_mfma_f32_32x32x16_bf16 v[64:79], v[40:43], a[180:183], v[64:79]
    s_waitcnt lgkmcnt(4)
    ds_read_b64_tr_b16 v[40:41], v8 offset:29184
    ds_read_b64_tr_b16 v[42:43], v8 offset:30208
    s_add_u32 m0, s40, 6144
    s_nop 0
    buffer_load_dwordx4 v14, s[8:11], s50 offen lds
    v_mfma_f32_32x32x16_bf16 v[80:95], v[44:47], a[180:183], v[80:95]
    s_waitcnt lgkmcnt(4)
    ds_read_b64_tr_b16 v[44:45], v9 offset:29184
    ds_read_b64_tr_b16 v[46:47], v9 offset:30208
    s_add_u32 s30, s57, 3538944
    buffer_load_dwordx4 a[216:219], v19, s[4:7], s30 offen offset:0
    s_waitcnt vmcnt(15)
    s_add_u32 m0, s40, 7168
    s_nop 0
    buffer_load_dwordx4 v14, s[8:11], s51 offen lds
    v_mfma_f32_32x32x16_bf16 v[64:79], v[32:35], a[184:187], v[64:79]
    s_waitcnt lgkmcnt(4)
    ds_read_b64_tr_b16 v[32:33], v10 offset:0
    ds_read_b64_tr_b16 v[34:35], v10 offset:1024
    v_mfma_f32_32x32x16_bf16 v[80:95], v[36:39], a[184:187], v[80:95]
    s_waitcnt lgkmcnt(4)
    ds_read_b64_tr_b16 v[36:37], v11 offset:0
    ds_read_b64_tr_b16 v[38:39], v11 offset:1024
    s_add_u32 s30, s57, 3604480
    buffer_load_dwordx4 a[220:223], v19, s[4:7], s30 offen offset:0
    s_waitcnt vmcnt(16)
    v_mfma_f32_32x32x16_bf16 v[64:79], v[40:43], a[188:191], v[64:79]
    s_waitcnt lgkmcnt(4)
    ds_read_b64_tr_b16 v[40:41], v10 offset:512
    ds_read_b64_tr_b16 v[42:43], v10 offset:1536
    v_add_u32 v14, 262144, v14
    s_add_u32 s41, s41, 32768
    s_and_b32 s41, s41, 0x1ffff
    s_add_u32 s40, s41, s42
    v_mfma_f32_32x32x16_bf16 v[80:95], v[44:47], a[188:191], v[80:95]
    v_mov_b32 v8, v10
    v_mov_b32 v9, v11
    s_add_u32 s43, s43, 32768
    s_and_b32 s43, s43, 0x1ffff
    v_add_u32 v10, s43, v12
    v_add_u32 v11, s43, v13
    s_waitcnt lgkmcnt(4)
    ds_read_b64_tr_b16 v[44:45], v9 offset:512
    ds_read_b64_tr_b16 v[46:47], v9 offset:1536
    s_add_u32 s30, s57, 3670016
    buffer_load_dwordx4 a[224:227], v19, s[4:7], s30 offen offset:0
    s_waitcnt vmcnt(16)
    v_mfma_f32_32x32x16_bf16 v[64:79], v[32:35], a[192:195], v[64:79]
    s_waitcnt lgkmcnt(4)
    ds_read_b64_tr_b16 v[32:33], v8 offset:4096
    ds_read_b64_tr_b16 v[34:35], v8 offset:5120
    v_mfma_f32_32x32x16_bf16 v[80:95], v[36:39], a[192:195], v[80:95]
    s_waitcnt lgkmcnt(4)
    ds_read_b64_tr_b16 v[36:37], v9 offset:4096
    ds_read_b64_tr_b16 v[38:39], v9 offset:5120
    s_add_u32 s30, s57, 3735552
    buffer_load_dwordx4 a[228:231], v19, s[4:7], s30 offen offset:0
    s_waitcnt vmcnt(16)
    v_mfma_f32_32x32x16_bf16 v[64:79], v[40:43], a[196:199], v[64:79]
    s_waitcnt lgkmcnt(4)
    ds_read_b64_tr_b16 v[40:41], v8 offset:4608
    ds_read_b64_tr_b16 v[42:43], v8 offset:5632
    v_mfma_f32_32x32x16_bf16 v[80:95], v[44:47], a[196:199], v[80:95]
    s_waitcnt lgkmcnt(4)
    ds_read_b64_tr_b16 v[44:45], v9 offset:4608
    ds_read_b64_tr_b16 v[46:47], v9 offset:5632
    s_add_u32 s30, s57, 3801088
    buffer_load_dwordx4 a[232:235], v19, s[4:7], s30 offen offset:0
    s_waitcnt vmcnt(14)
    v_mfma_f32_32x32x16_bf16 v[64:79], v[32:35], a[200:203], v[64:79]
    s_waitcnt lgkmcnt(4)
    ds_read_b64_tr_b16 v[32:33], v8 offset:8192
    ds_read_b64_tr_b16 v[34:35], v8 offset:9216
    v_mfma_f32_32x32x16_bf16 v[80:95], v[36:39], a[200:203], v[80:95]
    s_waitcnt lgkmcnt(4)
    ds_read_b64_tr_b16 v[36:37], v9 offset:8192
    ds_read_b64_tr_b16 v[38:39], v9 offset:9216
    s_add_u32 s30, s57, 3866624
    buffer_load_dwordx4 a[236:239], v19, s[4:7], s30 offen offset:0
    s_waitcnt vmcnt(13)
    v_mfma_f32_32x32x16_bf16 v[64:79], v[40:43], a[204:207], v[64:79]
    s_waitcnt lgkmcnt(4)
    ds_read_b64_tr_b16 v[40:41], v8 offset:8704
    ds_read_b64_tr_b16 v[42:43], v8 offset:9728
    v_mfma_f32_32x32x16_bf16 v[80:95], v[44:47], a[204:207], v[80:95]
    s_waitcnt lgkmcnt(4)
    ds_read_b64_tr_b16 v[44:45], v9 offset:8704
    ds_read_b64_tr_b16 v[46:47], v9 offset:9728
    s_add_u32 s30, s57, 3932160
    buffer_load_dwordx4 a[240:243], v19, s[4:7], s30 offen offset:0
    s_waitcnt vmcnt(12)
    v_mfma_f32_32x32x16_bf16 v[64:79], v[32:35], a[208:211], v[64:79]
    s_waitcnt lgkmcnt(4)
    ds_read_b64_tr_b16 v[32:33], v8 offset:12288
    ds_read_b64_tr_b16 v[34:35], v8 offset:13312
    v_mfma_f32_32x32x16_bf16 v[80:95], v[36:39], a[208:211], v[80:95]
    s_waitcnt lgkmcnt(4)
    ds_read_b64_tr_b16 v[36:37], v9 offset:12288
    ds_read_b64_tr_b16 v[38:39], v9 offset:13312
    s_add_u32 s30, s57, 3997696
    buffer_load_dwordx4 a[244:247], v19, s[4:7], s30 offen offset:0
    s_waitcnt vmcnt(10)
    v_mfma_f32_32x32x16_bf16 v[64:79], v[40:43], a[212:215], v[64:79]
    s_waitcnt lgkmcnt(4)
    ds_read_b64_tr_b16 v[40:41], v8 offset:12800
    ds_read_b64_tr_b16 v[42:43], v8 offset:13824
    v_mfma_f32_32x32x16_bf16 v[80:95], v[44:47], a[212:215], v[80:95]
    s_waitcnt lgkmcnt(4)
    ds_read_b64_tr_b16 v[44:45], v9 offset:12800
    ds_read_b64_tr_b16 v[46:47], v9 offset:13824
    s_add_u32 s30, s57, 4063232
    buffer_load_dwordx4 a[248:251], v19, s[4:7], s30 offen offset:0
    s_waitcnt vmcnt(9)
    v_mfma_f32_32x32x16_bf16 v[64:79], v[32:35], a[216:219], v[64:79]
    s_waitcnt lgkmcnt(4)
    ds_read_b64_tr_b16 v[32:33], v8 offset:16384
    ds_read_b64_tr_b16 v[34:35], v8 offset:17408
    v_mfma_f32_32x32x16_bf16 v[80:95], v[36:39], a[216:219], v[80:95]
    s_waitcnt lgkmcnt(4)
    ds_read_b64_tr_b16 v[36:37], v9 offset:16384
    ds_read_b64_tr_b16 v[38:39], v9 offset:17408
    s_add_u32 s30, s57, 4128768
    buffer_load_dwordx4 a[252:255], v19, s[4:7], s30 offen offset:0
    s_waitcnt vmcnt(8)
    v_mfma_f32_32x32x16_bf16 v[64:79], v[40:43], a[220:223], v[64:79]
    s_waitcnt lgkmcnt(4)
    ds_read_b64_tr_b16 v[40:41], v8 offset:16896
    ds_read_b64_tr_b16 v[42:43], v8 offset:17920
    v_mfma_f32_32x32x16_bf16 v[80:95], v[44:47], a[220:223], v[80:95]
    s_waitcnt vmcnt(33)
    s_barrier
    s_waitcnt lgkmcnt(4)
    ds_read_b64_tr_b16 v[44:45], v9 offset:16896
    ds_read_b64_tr_b16 v[46:47], v9 offset:17920
    s_waitcnt vmcnt(7)
    v_mfma_f32_32x32x16_bf16 v[64:79], v[32:35], a[224:227], v[64:79]
    s_waitcnt lgkmcnt(4)
    ds_read_b64_tr_b16 v[32:33], v8 offset:20480
    ds_read_b64_tr_b16 v[34:35], v8 offset:21504
    v_mfma_f32_32x32x16_bf16 v[80:95], v[36:39], a[224:227], v[80:95]
    s_waitcnt lgkmcnt(4)
    ds_read_b64_tr_b16 v[36:37], v9 offset:20480
    ds_read_b64_tr_b16 v[38:39], v9 offset:21504
    s_waitcnt vmcnt(6)
    s_add_u32 m0, s40, 0
    s_nop 0
    buffer_load_dwordx4 v14, s[8:11], s44 offen lds
    v_mfma_f32_32x32x16_bf16 v[64:79], v[40:43], a[228:231], v[64:79]
    s_waitcnt lgkmcnt(4)
    ds_read_b64_tr_b16 v[40:41], v8 offset:20992
    ds_read_b64_tr_b16 v[42:43], v8 offset:22016
    s_add_u32 m0, s40, 1024
    s_nop 0
    buffer_load_dwordx4 v14, s[8:11], s45 offen lds
    v_mfma_f32_32x32x16_bf16 v[80:95], v[44:47], a[228:231], v[80:95]
    s_waitcnt lgkmcnt(4)
    ds_read_b64_tr_b16 v[44:45], v9 offset:20992
    ds_read_b64_tr_b16 v[46:47], v9 offset:22016
    s_waitcnt vmcnt(7)
    v_mfma_f32_32x32x16_bf16 v[64:79], v[32:35], a[232:235], v[64:79]
    s_waitcnt lgkmcnt(4)
    ds_read_b64_tr_b16 v[32:33], v8 offset:24576
    ds_read_b64_tr_b16 v[34:35], v8 offset:25600
    s_add_u32 m0, s40, 2048
    s_nop 0
    buffer_load_dwordx4 v14, s[8:11], s46 offen lds
    v_mfma_f32_32x32x16_bf16 v[80:95], v[36:39], a[232:235], v[80:95]
    s_waitcnt lgkmcnt(4)
    ds_read_b64_tr_b16 v[36:37], v9 offset:24576
    ds_read_b64_tr_b16 v[38:39], v9 offset:25600
    s_waitcnt vmcnt(7)
    s_add_u32 m0, s40, 3072
    s_nop 0
    buffer_load_dwordx4 v14, s[8:11], s47 offen lds
    v_mfma_f32_32x32x16_bf16 v[64:79], v[40:43], a[236:239], v[64:79]
    s_waitcnt lgkmcnt(4)
    ds_read_b64_tr_b16 v[40:41], v8 offset:25088
    ds_read_b64_tr_b16 v[42:43], v8 offset:26112
    v_mfma_f32_32x32x16_bf16 v[80:95], v[44:47], a[236:239], v[80:95]
    s_waitcnt lgkmcnt(4)
    ds_read_b64_tr_b16 v[44:45], v9 offset:25088
    ds_read_b64_tr_b16 v[46:47], v9 offset:26112
    s_waitcnt vmcnt(7)
    s_add_u32 m0, s40, 4096
    s_nop 0
    buffer_load_dwordx4 v14, s[8:11], s48 offen lds
    v_mfma_f32_32x32x16_bf16 v[64:79], v[32:35], a[240:243], v[64:79]
    s_waitcnt lgkmcnt(4)
    ds_read_b64_tr_b16 v[32:33], v8 offset:28672
    ds_read_b64_tr_b16 v[34:35], v8 offset:29696
    s_add_u32 m0, s40, 5120
    s_nop 0
    buffer_load_dwordx4 v14, s[8:11], s49 offen lds
    v_mfma_f32_32x32x16_bf16 v[80:95], v[36:39], a[240:243], v[80:95]
    s_waitcnt lgkmcnt(4)
    ds_read_b64_tr_b16 v[36:37], v9 offset:28672
    ds_read_b64_tr_b16 v[38:39], v9 offset:29696
    s_waitcnt vmcnt(8)
    v_mfma_f32_32x32x16_bf16 v[64:79], v[40:43], a[244:247], v[64:79]
    s_waitcnt lgkmcnt(4)
    ds_read_b64_tr_b16 v[40:41], v8 offset:29184
    ds_read_b64_tr_b16 v[42:43], v8 offset:30208
    s_add_u32 m0, s40, 6144
    s_nop 0
    buffer_load_dwordx4 v14, s[8:11], s50 offen lds
    v_mfma_f32_32x32x16_bf16 v[80:95], v[44:47], a[244:247], v[80:95]
    s_waitcnt lgkmcnt(4)
    ds_read_b64_tr_b16 v[44:45], v9 offset:29184
    ds_read_b64_tr_b16 v[46:47], v9 offset:30208
    s_waitcnt vmcnt(8)
    s_add_u32 m0, s40, 7168
    s_nop 0
    buffer_load_dwordx4 v14, s[8:11], s51 offen lds
    v_mfma_f32_32x32x16_bf16 v[64:79], v[32:35], a[248:251], v[64:79]
    s_waitcnt lgkmcnt(4)
    ds_read_b64_tr_b16 v[32:33], v10 offset:0
    ds_read_b64_tr_b16 v[34:35], v10 offset:1024
    v_mfma_f32_32x32x16_bf16 v[80:95], v[36:39], a[248:251], v[80:95]
    s_waitcnt lgkmcnt(4)
    ds_read_b64_tr_b16 v[36:37], v11 offset:0
    ds_read_b64_tr_b16 v[38:39], v11 offset:1024
    s_waitcnt vmcnt(8)
    v_mfma_f32_32x32x16_bf16 v[64:79], v[40:43], a[252:255], v[64:79]
    s_waitcnt lgkmcnt(4)
    ds_read_b64_tr_b16 v[40:41], v10 offset:512
    ds_read_b64_tr_b16 v[42:43], v10 offset:1536
    v_add_u32 v14, 262144, v14
    s_add_u32 s41, s41, 32768
    s_and_b32 s41, s41, 0x1ffff
    s_add_u32 s40, s41, s42
    v_mfma_f32_32x32x16_bf16 v[80:95], v[44:47], a[252:255], v[80:95]
    v_mov_b32 v8, v10
    v_mov_b32 v9, v11
    s_add_u32 s43, s43, 32768
    s_and_b32 s43, s43, 0x1ffff
    v_add_u32 v10, s43, v12
    v_add_u32 v11, s43, v13
    s_waitcnt lgkmcnt(4)
    ds_read_b64_tr_b16 v[44:45], v9 offset:512
    ds_read_b64_tr_b16 v[46:47], v9 offset:1536
    v_mfma_f32_32x32x16_bf16 v[96:111], v[32:35], a[0:3], 0
    s_waitcnt lgkmcnt(4)
    ds_read_b64_tr_b16 v[32:33], v8 offset:4096
    ds_read_b64_tr_b16 v[34:35], v8 offset:5120
    v_mfma_f32_32x32x16_bf16 v[112:127], v[36:39], a[0:3], 0
    s_waitcnt lgkmcnt(4)
    ds_read_b64_tr_b16 v[36:37], v9 offset:4096
    ds_read_b64_tr_b16 v[38:39], v9 offset:5120
    v_mfma_f32_32x32x16_bf16 v[96:111], v[40:43], a[4:7], v[96:111]
    s_waitcnt lgkmcnt(4)
    ds_read_b64_tr_b16 v[40:41], v8 offset:4608
    ds_read_b64_tr_b16 v[42:43], v8 offset:5632
    v_cvt_pk_bf16_f32 v48, v64, v65
    v_cvt_pk_bf16_f32 v49, v66, v67
    v_mfma_f32_32x32x16_bf16 v[112:127], v[44:47], a[4:7], v[112:127]
    s_waitcnt lgkmcnt(4)
    ds_read_b64_tr_b16 v[44:45], v9 offset:4608
    ds_read_b64_tr_b16 v[46:47], v9 offset:5632
    v_cvt_pk_bf16_f32 v50, v68, v69
    v_cvt_pk_bf16_f32 v51, v70, v71
    v_mfma_f32_32x32x16_bf16 v[96:111], v[32:35], a[8:11], v[96:111]
    s_waitcnt lgkmcnt(4)
    ds_read_b64_tr_b16 v[32:33], v8 offset:8192
    ds_read_b64_tr_b16 v[34:35], v8 offset:9216
    v_cvt_pk_bf16_f32 v52, v72, v73
    v_cvt_pk_bf16_f32 v53, v74, v75
    v_mfma_f32_32x32x16_bf16 v[112:127], v[36:39], a[8:11], v[112:127]
    s_waitcnt lgkmcnt(4)
    ds_read_b64_tr_b16 v[36:37], v9 offset:8192
    ds_read_b64_tr_b16 v[38:39], v9 offset:9216
    v_cvt_pk_bf16_f32 v54, v76, v77
    v_cvt_pk_bf16_f32 v55, v78, v79
    v_mfma_f32_32x32x16_bf16 v[96:111], v[40:43], a[12:15], v[96:111]
    s_waitcnt lgkmcnt(4)
    ds_read_b64_tr_b16 v[40:41], v8 offset:8704
    ds_read_b64_tr_b16 v[42:43], v8 offset:9728
    s_add_u32 s61, s60, 0
    buffer_store_dwordx4 v[48:51], v15, s[12:15], s61 offen
    v_mfma_f32_32x32x16_bf16 v[112:127], v[44:47], a[12:15], v[112:127]
    s_waitcnt lgkmcnt(4)
    ds_read_b64_tr_b16 v[44:45], v9 offset:8704
    ds_read_b64_tr_b16 v[46:47], v9 offset:9728
    s_add_u32 s61, s60, 32768
    buffer_store_dwordx4 v[52:55], v15, s[12:15], s61 offen
    v_mfma_f32_32x32x16_bf16 v[96:111], v[32:35], a[16:19], v[96:111]
    s_waitcnt lgkmcnt(4)
    ds_read_b64_tr_b16 v[32:33], v8 offset:12288
    ds_read_b64_tr_b16 v[34:35], v8 offset:13312
    v_cvt_pk_bf16_f32 v56, v80, v81
    v_cvt_pk_bf16_f32 v57, v82, v83
    v_mfma_f32_32x32x16_bf16 v[112:127], v[36:39], a[16:19], v[112:127]
    s_waitcnt lgkmcnt(4)
    ds_read_b64_tr_b16 v[36:37], v9 offset:12288
    ds_read_b64_tr_b16 v[38:39], v9 offset:13312
    v_cvt_pk_bf16_f32 v58, v84, v85
    v_cvt_pk_bf16_f32 v59, v86, v87
    v_mfma_f32_32x32x16_bf16 v[96:111], v[40:43], a[20:23], v[96:111]
    s_waitcnt lgkmcnt(4)
    ds_read_b64_tr_b16 v[40:41], v8 offset:12800
    ds_read_b64_tr_b16 v[42:43], v8 offset:13824
    v_cvt_pk_bf16_f32 v60, v88, v89
    v_cvt_pk_bf16_f32 v61, v90, v91
    v_mfma_f32_32x32x16_bf16 v[112:127], v[44:47], a[20:23], v[112:127]
    s_waitcnt lgkmcnt(4)
    ds_read_b64_tr_b16 v[44:45], v9 offset:12800
    ds_read_b64_tr_b16 v[46:47], v9 offset:13824
    v_cvt_pk_bf16_f32 v62, v92, v93
    v_cvt_pk_bf16_f32 v63, v94, v95
    v_mfma_f32_32x32x16_bf16 v[96:111], v[32:35], a[24:27], v[96:111]
    s_waitcnt lgkmcnt(4)
    ds_read_b64_tr_b16 v[32:33], v8 offset:16384
    ds_read_b64_tr_b16 v[34:35], v8 offset:17408
    s_add_u32 s61, s60, 131072
    buffer_store_dwordx4 v[56:59], v15, s[12:15], s61 offen
    v_mfma_f32_32x32x16_bf16 v[112:127], v[36:39], a[24:27], v[112:127]
    s_waitcnt lgkmcnt(4)
    ds_read_b64_tr_b16 v[36:37], v9 offset:16384
    ds_read_b64_tr_b16 v[38:39], v9 offset:17408
    s_add_u32 s61, s60, 163840
    buffer_store_dwordx4 v[60:63], v15, s[12:15], s61 offen
    v_mfma_f32_32x32x16_bf16 v[96:111], v[40:43], a[28:31], v[96:111]
    s_waitcnt lgkmcnt(4)
    ds_read_b64_tr_b16 v[40:41], v8 offset:16896
    ds_read_b64_tr_b16 v[42:43], v8 offset:17920
    v_mfma_f32_32x32x16_bf16 v[112:127], v[44:47], a[28:31], v[112:127]
    s_waitcnt vmcnt(21)
    s_barrier
    s_waitcnt lgkmcnt(4)
    ds_read_b64_tr_b16 v[44:45], v9 offset:16896
    ds_read_b64_tr_b16 v[46:47], v9 offset:17920
    v_mfma_f32_32x32x16_bf16 v[96:111], v[32:35], a[32:35], v[96:111]
    s_waitcnt lgkmcnt(4)
    ds_read_b64_tr_b16 v[32:33], v8 offset:20480
    ds_read_b64_tr_b16 v[34:35], v8 offset:21504
    v_mfma_f32_32x32x16_bf16 v[112:127], v[36:39], a[32:35], v[112:127]
    s_waitcnt lgkmcnt(4)
    ds_read_b64_tr_b16 v[36:37], v9 offset:20480
    ds_read_b64_tr_b16 v[38:39], v9 offset:21504
    s_add_u32 m0, s40, 0
    s_nop 0
    buffer_load_dwordx4 v14, s[8:11], s44 offen lds
    v_mfma_f32_32x32x16_bf16 v[96:111], v[40:43], a[36:39], v[96:111]
    s_waitcnt lgkmcnt(4)
    ds_read_b64_tr_b16 v[40:41], v8 offset:20992
    ds_read_b64_tr_b16 v[42:43], v8 offset:22016
    s_add_u32 m0, s40, 1024
    s_nop 0
    buffer_load_dwordx4 v14, s[8:11], s45 offen lds
    v_mfma_f32_32x32x16_bf16 v[112:127], v[44:47], a[36:39], v[112:127]
    s_waitcnt lgkmcnt(4)
    ds_read_b64_tr_b16 v[44:45], v9 offset:20992
    ds_read_b64_tr_b16 v[46:47], v9 offset:22016
    v_mfma_f32_32x32x16_bf16 v[96:111], v[32:35], a[40:43], v[96:111]
    s_waitcnt lgkmcnt(4)
    ds_read_b64_tr_b16 v[32:33], v8 offset:24576
    ds_read_b64_tr_b16 v[34:35], v8 offset:25600
    s_add_u32 m0, s40, 2048
    s_nop 0
    buffer_load_dwordx4 v14, s[8:11], s46 offen lds
    v_mfma_f32_32x32x16_bf16 v[112:127], v[36:39], a[40:43], v[112:127]
    s_waitcnt lgkmcnt(4)
    ds_read_b64_tr_b16 v[36:37], v9 offset:24576
    ds_read_b64_tr_b16 v[38:39], v9 offset:25600
    s_add_u32 m0, s40, 3072
    s_nop 0
    buffer_load_dwordx4 v14, s[8:11], s47 offen lds
    v_mfma_f32_32x32x16_bf16 v[96:111], v[40:43], a[44:47], v[96:111]
    s_waitcnt lgkmcnt(4)
    ds_read_b64_tr_b16 v[40:41], v8 offset:25088
    ds_read_b64_tr_b16 v[42:43], v8 offset:26112
    v_mfma_f32_32x32x16_bf16 v[112:127], v[44:47], a[44:47], v[112:127]
    s_waitcnt lgkmcnt(4)
    ds_read_b64_tr_b16 v[44:45], v9 offset:25088
    ds_read_b64_tr_b16 v[46:47], v9 offset:26112
    s_add_u32 m0, s40, 4096
    s_nop 0
    buffer_load_dwordx4 v14, s[8:11], s48 offen lds
    v_mfma_f32_32x32x16_bf16 v[96:111], v[32:35], a[48:51], v[96:111]
    s_waitcnt lgkmcnt(4)
    ds_read_b64_tr_b16 v[32:33], v8 offset:28672
    ds_read_b64_tr_b16 v[34:35], v8 offset:29696
    s_add_u32 m0, s40, 5120
    s_nop 0
    buffer_load_dwordx4 v14, s[8:11], s49 offen lds
    v_mfma_f32_32x32x16_bf16 v[112:127], v[36:39], a[48:51], v[112:127]
    s_waitcnt lgkmcnt(4)
    ds_read_b64_tr_b16 v[36:37], v9 offset:28672
    ds_read_b64_tr_b16 v[38:39], v9 offset:29696
    v_mfma_f32_32x32x16_bf16 v[96:111], v[40:43], a[52:55], v[96:111]
    s_waitcnt lgkmcnt(4)
    ds_read_b64_tr_b16 v[40:41], v8 offset:29184
    ds_read_b64_tr_b16 v[42:43], v8 offset:30208
    s_add_u32 m0, s40, 6144
    s_nop 0
    buffer_load_dwordx4 v14, s[8:11], s50 offen lds
    v_mfma_f32_32x32x16_bf16 v[112:127], v[44:47], a[52:55], v[112:127]
    s_waitcnt lgkmcnt(4)
    ds_read_b64_tr_b16 v[44:45], v9 offset:29184
    ds_read_b64_tr_b16 v[46:47], v9 offset:30208
    s_add_u32 m0, s40, 7168
    s_nop 0
    buffer_load_dwordx4 v14, s[8:11], s51 offen lds
    v_mfma_f32_32x32x16_bf16 v[96:111], v[32:35], a[56:59], v[96:111]
    s_waitcnt lgkmcnt(4)
    ds_read_b64_tr_b16 v[32:33], v10 offset:0
    ds_read_b64_tr_b16 v[34:35], v10 offset:1024
    v_mfma_f32_32x32x16_bf16 v[112:127], v[36:39], a[56:59], v[112:127]
    s_waitcnt lgkmcnt(4)
    ds_read_b64_tr_b16 v[36:37], v11 offset:0
    ds_read_b64_tr_b16 v[38:39], v11 offset:1024
    v_mfma_f32_32x32x16_bf16 v[96:111], v[40:43], a[60:63], v[96:111]
    s_waitcnt lgkmcnt(4)
    ds_read_b64_tr_b16 v[40:41], v10 offset:512
    ds_read_b64_tr_b16 v[42:43], v10 offset:1536
    v_add_u32 v14, 4294180992, v14
    s_add_u32 s41, s41, 32768
    s_and_b32 s41, s41, 0x1ffff
    s_add_u32 s40, s41, s42
    v_mfma_f32_32x32x16_bf16 v[112:127], v[44:47], a[60:63], v[112:127]
    v_mov_b32 v8, v10
    v_mov_b32 v9, v11
    s_add_u32 s43, s43, 32768
    s_and_b32 s43, s43, 0x1ffff
    v_add_u32 v10, s43, v12
    v_add_u32 v11, s43, v13
    s_waitcnt lgkmcnt(4)
    ds_read_b64_tr_b16 v[44:45], v9 offset:512
    ds_read_b64_tr_b16 v[46:47], v9 offset:1536
    v_mfma_f32_32x32x16_bf16 v[96:111], v[32:35], a[64:67], v[96:111]
    s_waitcnt lgkmcnt(4)
    ds_read_b64_tr_b16 v[32:33], v8 offset:4096
    ds_read_b64_tr_b16 v[34:35], v8 offset:5120
    v_mfma_f32_32x32x16_bf16 v[112:127], v[36:39], a[64:67], v[112:127]
    s_waitcnt lgkmcnt(4)
    ds_read_b64_tr_b16 v[36:37], v9 offset:4096
    ds_read_b64_tr_b16 v[38:39], v9 offset:5120
    v_mfma_f32_32x32x16_bf16 v[96:111], v[40:43], a[68:71], v[96:111]
    s_waitcnt lgkmcnt(4)
    ds_read_b64_tr_b16 v[40:41], v8 offset:4608
    ds_read_b64_tr_b16 v[42:43], v8 offset:5632
    v_mfma_f32_32x32x16_bf16 v[112:127], v[44:47], a[68:71], v[112:127]
    s_waitcnt lgkmcnt(4)
    ds_read_b64_tr_b16 v[44:45], v9 offset:4608
    ds_read_b64_tr_b16 v[46:47], v9 offset:5632
    v_mfma_f32_32x32x16_bf16 v[96:111], v[32:35], a[72:75], v[96:111]
    s_waitcnt lgkmcnt(4)
    ds_read_b64_tr_b16 v[32:33], v8 offset:8192
    ds_read_b64_tr_b16 v[34:35], v8 offset:9216
    v_mfma_f32_32x32x16_bf16 v[112:127], v[36:39], a[72:75], v[112:127]
    s_waitcnt lgkmcnt(4)
    ds_read_b64_tr_b16 v[36:37], v9 offset:8192
    ds_read_b64_tr_b16 v[38:39], v9 offset:9216
    v_mfma_f32_32x32x16_bf16 v[96:111], v[40:43], a[76:79], v[96:111]
    s_waitcnt lgkmcnt(4)
    ds_read_b64_tr_b16 v[40:41], v8 offset:8704
    ds_read_b64_tr_b16 v[42:43], v8 offset:9728
    v_mfma_f32_32x32x16_bf16 v[112:127], v[44:47], a[76:79], v[112:127]
    s_waitcnt lgkmcnt(4)
    ds_read_b64_tr_b16 v[44:45], v9 offset:8704
    ds_read_b64_tr_b16 v[46:47], v9 offset:9728
    v_mfma_f32_32x32x16_bf16 v[96:111], v[32:35], a[80:83], v[96:111]
    s_waitcnt lgkmcnt(4)
    ds_read_b64_tr_b16 v[32:33], v8 offset:12288
    ds_read_b64_tr_b16 v[34:35], v8 offset:13312
    v_mfma_f32_32x32x16_bf16 v[112:127], v[36:39], a[80:83], v[112:127]
    s_waitcnt lgkmcnt(4)
    ds_read_b64_tr_b16 v[36:37], v9 offset:12288
    ds_read_b64_tr_b16 v[38:39], v9 offset:13312
    v_mfma_f32_32x32x16_bf16 v[96:111], v[40:43], a[84:87], v[96:111]
    s_waitcnt lgkmcnt(4)
    ds_read_b64_tr_b16 v[40:41], v8 offset:12800
    ds_read_b64_tr_b16 v[42:43], v8 offset:13824
    v_mfma_f32_32x32x16_bf16 v[112:127], v[44:47], a[84:87], v[112:127]
    s_waitcnt lgkmcnt(4)
    ds_read_b64_tr_b16 v[44:45], v9 offset:12800
    ds_read_b64_tr_b16 v[46:47], v9 offset:13824
    v_mfma_f32_32x32x16_bf16 v[96:111], v[32:35], a[88:91], v[96:111]
    s_waitcnt lgkmcnt(4)
    ds_read_b64_tr_b16 v[32:33], v8 offset:16384
    ds_read_b64_tr_b16 v[34:35], v8 offset:17408
    v_mfma_f32_32x32x16_bf16 v[112:127], v[36:39], a[88:91], v[112:127]
    s_waitcnt lgkmcnt(4)
    ds_read_b64_tr_b16 v[36:37], v9 offset:16384
    ds_read_b64_tr_b16 v[38:39], v9 offset:17408
    v_mfma_f32_32x32x16_bf16 v[96:111], v[40:43], a[92:95], v[96:111]
    s_waitcnt lgkmcnt(4)
    ds_read_b64_tr_b16 v[40:41], v8 offset:16896
    ds_read_b64_tr_b16 v[42:43], v8 offset:17920
    v_mfma_f32_32x32x16_bf16 v[112:127], v[44:47], a[92:95], v[112:127]
    s_waitcnt vmcnt(12)
    s_barrier
    s_waitcnt lgkmcnt(4)
    ds_read_b64_tr_b16 v[44:45], v9 offset:16896
    ds_read_b64_tr_b16 v[46:47], v9 offset:17920
    v_mfma_f32_32x32x16_bf16 v[96:111], v[32:35], a[96:99], v[96:111]
    s_waitcnt lgkmcnt(4)
    ds_read_b64_tr_b16 v[32:33], v8 offset:20480
    ds_read_b64_tr_b16 v[34:35], v8 offset:21504
    v_mfma_f32_32x32x16_bf16 v[112:127], v[36:39], a[96:99], v[112:127]
    s_waitcnt lgkmcnt(4)
    ds_read_b64_tr_b16 v[36:37], v9 offset:20480
    ds_read_b64_tr_b16 v[38:39], v9 offset:21504
    v_mfma_f32_32x32x16_bf16 v[96:111], v[40:43], a[100:103], v[96:111]
    s_waitcnt lgkmcnt(4)
    ds_read_b64_tr_b16 v[40:41], v8 offset:20992
    ds_read_b64_tr_b16 v[42:43], v8 offset:22016
    v_mfma_f32_32x32x16_bf16 v[112:127], v[44:47], a[100:103], v[112:127]
    s_waitcnt lgkmcnt(4)
    ds_read_b64_tr_b16 v[44:45], v9 offset:20992
    ds_read_b64_tr_b16 v[46:47], v9 offset:22016
    v_mfma_f32_32x32x16_bf16 v[96:111], v[32:35], a[104:107], v[96:111]
    s_waitcnt lgkmcnt(4)
    ds_read_b64_tr_b16 v[32:33], v8 offset:24576
    ds_read_b64_tr_b16 v[34:35], v8 offset:25600
    v_mfma_f32_32x32x16_bf16 v[112:127], v[36:39], a[104:107], v[112:127]
    s_waitcnt lgkmcnt(4)
    ds_read_b64_tr_b16 v[36:37], v9 offset:24576
    ds_read_b64_tr_b16 v[38:39], v9 offset:25600
    v_mfma_f32_32x32x16_bf16 v[96:111], v[40:43], a[108:111], v[96:111]
    s_waitcnt lgkmcnt(4)
    ds_read_b64_tr_b16 v[40:41], v8 offset:25088
    ds_read_b64_tr_b16 v[42:43], v8 offset:26112
    v_mfma_f32_32x32x16_bf16 v[112:127], v[44:47], a[108:111], v[112:127]
    s_waitcnt lgkmcnt(4)
    ds_read_b64_tr_b16 v[44:45], v9 offset:25088
    ds_read_b64_tr_b16 v[46:47], v9 offset:26112
    v_mfma_f32_32x32x16_bf16 v[96:111], v[32:35], a[112:115], v[96:111]
    s_waitcnt lgkmcnt(4)
    ds_read_b64_tr_b16 v[32:33], v8 offset:28672
    ds_read_b64_tr_b16 v[34:35], v8 offset:29696
    v_mfma_f32_32x32x16_bf16 v[112:127], v[36:39], a[112:115], v[112:127]
    s_waitcnt lgkmcnt(4)
    ds_read_b64_tr_b16 v[36:37], v9 offset:28672
    ds_read_b64_tr_b16 v[38:39], v9 offset:29696
    v_mfma_f32_32x32x16_bf16 v[96:111], v[40:43], a[116:119], v[96:111]
    s_waitcnt lgkmcnt(4)
    ds_read_b64_tr_b16 v[40:41], v8 offset:29184
    ds_read_b64_tr_b16 v[42:43], v8 offset:30208
    v_mfma_f32_32x32x16_bf16 v[112:127], v[44:47], a[116:119], v[112:127]
    s_waitcnt lgkmcnt(4)
    ds_read_b64_tr_b16 v[44:45], v9 offset:29184
    ds_read_b64_tr_b16 v[46:47], v9 offset:30208
    v_mfma_f32_32x32x16_bf16 v[96:111], v[32:35], a[120:123], v[96:111]
    s_waitcnt lgkmcnt(4)
    ds_read_b64_tr_b16 v[32:33], v10 offset:0
    ds_read_b64_tr_b16 v[34:35], v10 offset:1024
    v_mfma_f32_32x32x16_bf16 v[112:127], v[36:39], a[120:123], v[112:127]
    s_waitcnt lgkmcnt(4)
    ds_read_b64_tr_b16 v[36:37], v11 offset:0
    ds_read_b64_tr_b16 v[38:39], v11 offset:1024
    v_mfma_f32_32x32x16_bf16 v[96:111], v[40:43], a[124:127], v[96:111]
    s_waitcnt lgkmcnt(4)
    ds_read_b64_tr_b16 v[40:41], v10 offset:512
    ds_read_b64_tr_b16 v[42:43], v10 offset:1536
    v_mfma_f32_32x32x16_bf16 v[112:127], v[44:47], a[124:127], v[112:127]
    v_mov_b32 v8, v10
    v_mov_b32 v9, v11
    s_add_u32 s43, s43, 32768
    s_and_b32 s43, s43, 0x1ffff
    v_add_u32 v10, s43, v12
    v_add_u32 v11, s43, v13
    s_waitcnt lgkmcnt(4)
    ds_read_b64_tr_b16 v[44:45], v9 offset:512
    ds_read_b64_tr_b16 v[46:47], v9 offset:1536
    v_mfma_f32_32x32x16_bf16 v[96:111], v[32:35], a[128:131], v[96:111]
    s_waitcnt lgkmcnt(4)
    ds_read_b64_tr_b16 v[32:33], v8 offset:4096
    ds_read_b64_tr_b16 v[34:35], v8 offset:5120
    v_mfma_f32_32x32x16_bf16 v[112:127], v[36:39], a[128:131], v[112:127]
    s_waitcnt lgkmcnt(4)
    ds_read_b64_tr_b16 v[36:37], v9 offset:4096
    ds_read_b64_tr_b16 v[38:39], v9 offset:5120
    v_mfma_f32_32x32x16_bf16 v[96:111], v[40:43], a[132:135], v[96:111]
    s_waitcnt lgkmcnt(4)
    ds_read_b64_tr_b16 v[40:41], v8 offset:4608
    ds_read_b64_tr_b16 v[42:43], v8 offset:5632
    v_mfma_f32_32x32x16_bf16 v[112:127], v[44:47], a[132:135], v[112:127]
    s_waitcnt lgkmcnt(4)
    ds_read_b64_tr_b16 v[44:45], v9 offset:4608
    ds_read_b64_tr_b16 v[46:47], v9 offset:5632
    v_mfma_f32_32x32x16_bf16 v[96:111], v[32:35], a[136:139], v[96:111]
    s_waitcnt lgkmcnt(4)
    ds_read_b64_tr_b16 v[32:33], v8 offset:8192
    ds_read_b64_tr_b16 v[34:35], v8 offset:9216
    v_mfma_f32_32x32x16_bf16 v[112:127], v[36:39], a[136:139], v[112:127]
    s_waitcnt lgkmcnt(4)
    ds_read_b64_tr_b16 v[36:37], v9 offset:8192
    ds_read_b64_tr_b16 v[38:39], v9 offset:9216
    v_mfma_f32_32x32x16_bf16 v[96:111], v[40:43], a[140:143], v[96:111]
    s_waitcnt lgkmcnt(4)
    ds_read_b64_tr_b16 v[40:41], v8 offset:8704
    ds_read_b64_tr_b16 v[42:43], v8 offset:9728
    v_mfma_f32_32x32x16_bf16 v[112:127], v[44:47], a[140:143], v[112:127]
    s_waitcnt lgkmcnt(4)
    ds_read_b64_tr_b16 v[44:45], v9 offset:8704
    ds_read_b64_tr_b16 v[46:47], v9 offset:9728
    v_mfma_f32_32x32x16_bf16 v[96:111], v[32:35], a[144:147], v[96:111]
    s_waitcnt lgkmcnt(4)
    ds_read_b64_tr_b16 v[32:33], v8 offset:12288
    ds_read_b64_tr_b16 v[34:35], v8 offset:13312
    v_mfma_f32_32x32x16_bf16 v[112:127], v[36:39], a[144:147], v[112:127]
    s_waitcnt lgkmcnt(4)
    ds_read_b64_tr_b16 v[36:37], v9 offset:12288
    ds_read_b64_tr_b16 v[38:39], v9 offset:13312
    v_mfma_f32_32x32x16_bf16 v[96:111], v[40:43], a[148:151], v[96:111]
    s_waitcnt lgkmcnt(4)
    ds_read_b64_tr_b16 v[40:41], v8 offset:12800
    ds_read_b64_tr_b16 v[42:43], v8 offset:13824
    v_mfma_f32_32x32x16_bf16 v[112:127], v[44:47], a[148:151], v[112:127]
    s_waitcnt lgkmcnt(4)
    ds_read_b64_tr_b16 v[44:45], v9 offset:12800
    ds_read_b64_tr_b16 v[46:47], v9 offset:13824
    v_mfma_f32_32x32x16_bf16 v[96:111], v[32:35], a[152:155], v[96:111]
    s_waitcnt lgkmcnt(4)
    ds_read_b64_tr_b16 v[32:33], v8 offset:16384
    ds_read_b64_tr_b16 v[34:35], v8 offset:17408
    v_mfma_f32_32x32x16_bf16 v[112:127], v[36:39], a[152:155], v[112:127]
    s_waitcnt lgkmcnt(4)
    ds_read_b64_tr_b16 v[36:37], v9 offset:16384
    ds_read_b64_tr_b16 v[38:39], v9 offset:17408
    v_mfma_f32_32x32x16_bf16 v[96:111], v[40:43], a[156:159], v[96:111]
    s_waitcnt lgkmcnt(4)
    ds_read_b64_tr_b16 v[40:41], v8 offset:16896
    ds_read_b64_tr_b16 v[42:43], v8 offset:17920
    v_mfma_f32_32x32x16_bf16 v[112:127], v[44:47], a[156:159], v[112:127]
    s_waitcnt vmcnt(0)
    s_barrier
    s_waitcnt lgkmcnt(4)
    ds_read_b64_tr_b16 v[44:45], v9 offset:16896
    ds_read_b64_tr_b16 v[46:47], v9 offset:17920
    v_mfma_f32_32x32x16_bf16 v[96:111], v[32:35], a[160:163], v[96:111]
    s_waitcnt lgkmcnt(4)
    ds_read_b64_tr_b16 v[32:33], v8 offset:20480
    ds_read_b64_tr_b16 v[34:35], v8 offset:21504
    v_mfma_f32_32x32x16_bf16 v[112:127], v[36:39], a[160:163], v[112:127]
    s_waitcnt lgkmcnt(4)
    ds_read_b64_tr_b16 v[36:37], v9 offset:20480
    ds_read_b64_tr_b16 v[38:39], v9 offset:21504
    v_mfma_f32_32x32x16_bf16 v[96:111], v[40:43], a[164:167], v[96:111]
    s_waitcnt lgkmcnt(4)
    ds_read_b64_tr_b16 v[40:41], v8 offset:20992
    ds_read_b64_tr_b16 v[42:43], v8 offset:22016
    v_mfma_f32_32x32x16_bf16 v[112:127], v[44:47], a[164:167], v[112:127]
    s_waitcnt lgkmcnt(4)
    ds_read_b64_tr_b16 v[44:45], v9 offset:20992
    ds_read_b64_tr_b16 v[46:47], v9 offset:22016
    v_mfma_f32_32x32x16_bf16 v[96:111], v[32:35], a[168:171], v[96:111]
    s_waitcnt lgkmcnt(4)
    ds_read_b64_tr_b16 v[32:33], v8 offset:24576
    ds_read_b64_tr_b16 v[34:35], v8 offset:25600
    v_mfma_f32_32x32x16_bf16 v[112:127], v[36:39], a[168:171], v[112:127]
    s_waitcnt lgkmcnt(4)
    ds_read_b64_tr_b16 v[36:37], v9 offset:24576
    ds_read_b64_tr_b16 v[38:39], v9 offset:25600
    v_mfma_f32_32x32x16_bf16 v[96:111], v[40:43], a[172:175], v[96:111]
    s_waitcnt lgkmcnt(4)
    ds_read_b64_tr_b16 v[40:41], v8 offset:25088
    ds_read_b64_tr_b16 v[42:43], v8 offset:26112
    v_mfma_f32_32x32x16_bf16 v[112:127], v[44:47], a[172:175], v[112:127]
    s_waitcnt lgkmcnt(4)
    ds_read_b64_tr_b16 v[44:45], v9 offset:25088
    ds_read_b64_tr_b16 v[46:47], v9 offset:26112
    v_mfma_f32_32x32x16_bf16 v[96:111], v[32:35], a[176:179], v[96:111]
    s_waitcnt lgkmcnt(4)
    ds_read_b64_tr_b16 v[32:33], v8 offset:28672
    ds_read_b64_tr_b16 v[34:35], v8 offset:29696
    v_mfma_f32_32x32x16_bf16 v[112:127], v[36:39], a[176:179], v[112:127]
    s_waitcnt lgkmcnt(4)
    ds_read_b64_tr_b16 v[36:37], v9 offset:28672
    ds_read_b64_tr_b16 v[38:39], v9 offset:29696
    v_mfma_f32_32x32x16_bf16 v[96:111], v[40:43], a[180:183], v[96:111]
    s_waitcnt lgkmcnt(4)
    ds_read_b64_tr_b16 v[40:41], v8 offset:29184
    ds_read_b64_tr_b16 v[42:43], v8 offset:30208
    v_mfma_f32_32x32x16_bf16 v[112:127], v[44:47], a[180:183], v[112:127]
    s_waitcnt lgkmcnt(4)
    ds_read_b64_tr_b16 v[44:45], v9 offset:29184
    ds_read_b64_tr_b16 v[46:47], v9 offset:30208
    v_mfma_f32_32x32x16_bf16 v[96:111], v[32:35], a[184:187], v[96:111]
    s_waitcnt lgkmcnt(4)
    ds_read_b64_tr_b16 v[32:33], v10 offset:0
    ds_read_b64_tr_b16 v[34:35], v10 offset:1024
    v_mfma_f32_32x32x16_bf16 v[112:127], v[36:39], a[184:187], v[112:127]
    s_waitcnt lgkmcnt(4)
    ds_read_b64_tr_b16 v[36:37], v11 offset:0
    ds_read_b64_tr_b16 v[38:39], v11 offset:1024
    v_mfma_f32_32x32x16_bf16 v[96:111], v[40:43], a[188:191], v[96:111]
    s_waitcnt lgkmcnt(4)
    ds_read_b64_tr_b16 v[40:41], v10 offset:512
    ds_read_b64_tr_b16 v[42:43], v10 offset:1536
    v_mfma_f32_32x32x16_bf16 v[112:127], v[44:47], a[188:191], v[112:127]
    v_mov_b32 v8, v10
    v_mov_b32 v9, v11
    s_add_u32 s43, s43, 32768
    s_and_b32 s43, s43, 0x1ffff
    v_add_u32 v10, s43, v12
    v_add_u32 v11, s43, v13
    s_waitcnt lgkmcnt(4)
    ds_read_b64_tr_b16 v[44:45], v9 offset:512
    ds_read_b64_tr_b16 v[46:47], v9 offset:1536
    v_mfma_f32_32x32x16_bf16 v[96:111], v[32:35], a[192:195], v[96:111]
    s_waitcnt lgkmcnt(4)
    ds_read_b64_tr_b16 v[32:33], v8 offset:4096
    ds_read_b64_tr_b16 v[34:35], v8 offset:5120
    v_mfma_f32_32x32x16_bf16 v[112:127], v[36:39], a[192:195], v[112:127]
    s_waitcnt lgkmcnt(4)
    ds_read_b64_tr_b16 v[36:37], v9 offset:4096
    ds_read_b64_tr_b16 v[38:39], v9 offset:5120
    v_mfma_f32_32x32x16_bf16 v[96:111], v[40:43], a[196:199], v[96:111]
    s_waitcnt lgkmcnt(4)
    ds_read_b64_tr_b16 v[40:41], v8 offset:4608
    ds_read_b64_tr_b16 v[42:43], v8 offset:5632
    v_mfma_f32_32x32x16_bf16 v[112:127], v[44:47], a[196:199], v[112:127]
    s_waitcnt lgkmcnt(4)
    ds_read_b64_tr_b16 v[44:45], v9 offset:4608
    ds_read_b64_tr_b16 v[46:47], v9 offset:5632
    v_mfma_f32_32x32x16_bf16 v[96:111], v[32:35], a[200:203], v[96:111]
    s_waitcnt lgkmcnt(4)
    ds_read_b64_tr_b16 v[32:33], v8 offset:8192
    ds_read_b64_tr_b16 v[34:35], v8 offset:9216
    v_mfma_f32_32x32x16_bf16 v[112:127], v[36:39], a[200:203], v[112:127]
    s_waitcnt lgkmcnt(4)
    ds_read_b64_tr_b16 v[36:37], v9 offset:8192
    ds_read_b64_tr_b16 v[38:39], v9 offset:9216
    v_mfma_f32_32x32x16_bf16 v[96:111], v[40:43], a[204:207], v[96:111]
    s_waitcnt lgkmcnt(4)
    ds_read_b64_tr_b16 v[40:41], v8 offset:8704
    ds_read_b64_tr_b16 v[42:43], v8 offset:9728
    v_mfma_f32_32x32x16_bf16 v[112:127], v[44:47], a[204:207], v[112:127]
    s_waitcnt lgkmcnt(4)
    ds_read_b64_tr_b16 v[44:45], v9 offset:8704
    ds_read_b64_tr_b16 v[46:47], v9 offset:9728
    v_mfma_f32_32x32x16_bf16 v[96:111], v[32:35], a[208:211], v[96:111]
    s_waitcnt lgkmcnt(4)
    ds_read_b64_tr_b16 v[32:33], v8 offset:12288
    ds_read_b64_tr_b16 v[34:35], v8 offset:13312
    v_mfma_f32_32x32x16_bf16 v[112:127], v[36:39], a[208:211], v[112:127]
    s_waitcnt lgkmcnt(4)
    ds_read_b64_tr_b16 v[36:37], v9 offset:12288
    ds_read_b64_tr_b16 v[38:39], v9 offset:13312
    v_mfma_f32_32x32x16_bf16 v[96:111], v[40:43], a[212:215], v[96:111]
    s_waitcnt lgkmcnt(4)
    ds_read_b64_tr_b16 v[40:41], v8 offset:12800
    ds_read_b64_tr_b16 v[42:43], v8 offset:13824
    v_mfma_f32_32x32x16_bf16 v[112:127], v[44:47], a[212:215], v[112:127]
    s_waitcnt lgkmcnt(4)
    ds_read_b64_tr_b16 v[44:45], v9 offset:12800
    ds_read_b64_tr_b16 v[46:47], v9 offset:13824
    v_mfma_f32_32x32x16_bf16 v[96:111], v[32:35], a[216:219], v[96:111]
    s_waitcnt lgkmcnt(4)
    ds_read_b64_tr_b16 v[32:33], v8 offset:16384
    ds_read_b64_tr_b16 v[34:35], v8 offset:17408
    v_mfma_f32_32x32x16_bf16 v[112:127], v[36:39], a[216:219], v[112:127]
    s_waitcnt lgkmcnt(4)
    ds_read_b64_tr_b16 v[36:37], v9 offset:16384
    ds_read_b64_tr_b16 v[38:39], v9 offset:17408
    v_mfma_f32_32x32x16_bf16 v[96:111], v[40:43], a[220:223], v[96:111]
    s_waitcnt lgkmcnt(4)
    ds_read_b64_tr_b16 v[40:41], v8 offset:16896
    ds_read_b64_tr_b16 v[42:43], v8 offset:17920
    v_mfma_f32_32x32x16_bf16 v[112:127], v[44:47], a[220:223], v[112:127]
    s_waitcnt vmcnt(0)
    s_barrier
    s_waitcnt lgkmcnt(4)
    ds_read_b64_tr_b16 v[44:45], v9 offset:16896
    ds_read_b64_tr_b16 v[46:47], v9 offset:17920
    v_mfma_f32_32x32x16_bf16 v[96:111], v[32:35], a[224:227], v[96:111]
    s_waitcnt lgkmcnt(4)
    ds_read_b64_tr_b16 v[32:33], v8 offset:20480
    ds_read_b64_tr_b16 v[34:35], v8 offset:21504
    v_mfma_f32_32x32x16_bf16 v[112:127], v[36:39], a[224:227], v[112:127]
    s_waitcnt lgkmcnt(4)
    ds_read_b64_tr_b16 v[36:37], v9 offset:20480
    ds_read_b64_tr_b16 v[38:39], v9 offset:21504
    v_mfma_f32_32x32x16_bf16 v[96:111], v[40:43], a[228:231], v[96:111]
    s_waitcnt lgkmcnt(4)
    ds_read_b64_tr_b16 v[40:41], v8 offset:20992
    ds_read_b64_tr_b16 v[42:43], v8 offset:22016
    v_mfma_f32_32x32x16_bf16 v[112:127], v[44:47], a[228:231], v[112:127]
    s_waitcnt lgkmcnt(4)
    ds_read_b64_tr_b16 v[44:45], v9 offset:20992
    ds_read_b64_tr_b16 v[46:47], v9 offset:22016
    v_mfma_f32_32x32x16_bf16 v[96:111], v[32:35], a[232:235], v[96:111]
    s_waitcnt lgkmcnt(4)
    ds_read_b64_tr_b16 v[32:33], v8 offset:24576
    ds_read_b64_tr_b16 v[34:35], v8 offset:25600
    v_mfma_f32_32x32x16_bf16 v[112:127], v[36:39], a[232:235], v[112:127]
    s_waitcnt lgkmcnt(4)
    ds_read_b64_tr_b16 v[36:37], v9 offset:24576
    ds_read_b64_tr_b16 v[38:39], v9 offset:25600
    v_mfma_f32_32x32x16_bf16 v[96:111], v[40:43], a[236:239], v[96:111]
    s_waitcnt lgkmcnt(4)
    ds_read_b64_tr_b16 v[40:41], v8 offset:25088
    ds_read_b64_tr_b16 v[42:43], v8 offset:26112
    v_mfma_f32_32x32x16_bf16 v[112:127], v[44:47], a[236:239], v[112:127]
    s_waitcnt lgkmcnt(4)
    ds_read_b64_tr_b16 v[44:45], v9 offset:25088
    ds_read_b64_tr_b16 v[46:47], v9 offset:26112
    v_mfma_f32_32x32x16_bf16 v[96:111], v[32:35], a[240:243], v[96:111]
    s_waitcnt lgkmcnt(4)
    ds_read_b64_tr_b16 v[32:33], v8 offset:28672
    ds_read_b64_tr_b16 v[34:35], v8 offset:29696
    v_mfma_f32_32x32x16_bf16 v[112:127], v[36:39], a[240:243], v[112:127]
    s_waitcnt lgkmcnt(4)
    ds_read_b64_tr_b16 v[36:37], v9 offset:28672
    ds_read_b64_tr_b16 v[38:39], v9 offset:29696
    v_mfma_f32_32x32x16_bf16 v[96:111], v[40:43], a[244:247], v[96:111]
    s_waitcnt lgkmcnt(4)
    ds_read_b64_tr_b16 v[40:41], v8 offset:29184
    ds_read_b64_tr_b16 v[42:43], v8 offset:30208
    v_mfma_f32_32x32x16_bf16 v[112:127], v[44:47], a[244:247], v[112:127]
    s_waitcnt lgkmcnt(4)
    ds_read_b64_tr_b16 v[44:45], v9 offset:29184
    ds_read_b64_tr_b16 v[46:47], v9 offset:30208
    v_mfma_f32_32x32x16_bf16 v[96:111], v[32:35], a[248:251], v[96:111]
    s_waitcnt lgkmcnt(4)
    ds_read_b64_tr_b16 v[32:33], v10 offset:0
    ds_read_b64_tr_b16 v[34:35], v10 offset:1024
    v_mfma_f32_32x32x16_bf16 v[112:127], v[36:39], a[248:251], v[112:127]
    s_waitcnt lgkmcnt(4)
    ds_read_b64_tr_b16 v[36:37], v11 offset:0
    ds_read_b64_tr_b16 v[38:39], v11 offset:1024
    v_mfma_f32_32x32x16_bf16 v[96:111], v[40:43], a[252:255], v[96:111]
    s_waitcnt lgkmcnt(4)
    ds_read_b64_tr_b16 v[40:41], v10 offset:512
    ds_read_b64_tr_b16 v[42:43], v10 offset:1536
    v_mfma_f32_32x32x16_bf16 v[112:127], v[44:47], a[252:255], v[112:127]
    v_mov_b32 v8, v10
    v_mov_b32 v9, v11
    s_add_u32 s43, s43, 32768
    s_and_b32 s43, s43, 0x1ffff
    v_add_u32 v10, s43, v12
    v_add_u32 v11, s43, v13
    s_nop 1
    v_cvt_pk_bf16_f32 v48, v96, v97
    v_cvt_pk_bf16_f32 v49, v98, v99
    v_cvt_pk_bf16_f32 v50, v100, v101
    v_cvt_pk_bf16_f32 v51, v102, v103
    v_cvt_pk_bf16_f32 v52, v104, v105
    v_cvt_pk_bf16_f32 v53, v106, v107
    v_cvt_pk_bf16_f32 v54, v108, v109
    v_cvt_pk_bf16_f32 v55, v110, v111
    s_add_u32 s61, s60, 262144
    buffer_store_dwordx4 v[48:51], v15, s[12:15], s61 offen
    s_add_u32 s61, s60, 294912
    buffer_store_dwordx4 v[52:55], v15, s[12:15], s61 offen
    v_cvt_pk_bf16_f32 v56, v112, v113
    v_cvt_pk_bf16_f32 v57, v114, v115
    v_cvt_pk_bf16_f32 v58, v116, v117
    v_cvt_pk_bf16_f32 v59, v118, v119
    v_cvt_pk_bf16_f32 v60, v120, v121
    v_cvt_pk_bf16_f32 v61, v122, v123
    v_cvt_pk_bf16_f32 v62, v124, v125
    v_cvt_pk_bf16_f32 v63, v126, v127
    s_add_u32 s61, s60, 393216
    buffer_store_dwordx4 v[56:59], v15, s[12:15], s61 offen
    s_add_u32 s61, s60, 425984
    buffer_store_dwordx4 v[60:63], v15, s[12:15], s61 offen
    s_waitcnt vmcnt(0) lgkmcnt(0)
L_op_end:
    s_endpgm
.globl red_kernel
.p2align 8
.type red_kernel,@function
red_kernel:
    s_cmp_ge_u32 s2, 256
    s_cbranch_scc1 L_red_end
    s_load_dwordx2 s[4:5], s[0:1], 0
    s_load_dwordx2 s[8:9], s[0:1], 112
    s_mov_b32 s41, s2
    v_and_b32 v1, 7, v0
    v_lshrrev_b32 v2, 3, v0
    s_lshl_b32 s20, s41, 3
    v_add_u32 v11, s20, v1
    v_lshlrev_b32 v3, 4, v11
    v_lshl_add_u32 v3, v2, 17, v3
    v_lshrrev_b32 v12, 1, v2
    v_and_b32 v13, 1, v2
    v_lshlrev_b32 v12, 5, v12
    v_lshl_add_u32 v12, v13, 2, v12
    v_lshlrev_b32 v4, 10, v11
    v_lshl_add_u32 v4, v12, 1, v4
    v_lshlrev_b32 v5, 2, v12
    v_lshlrev_b32 v6, 4, v11
    v_lshl_add_u32 v6, v2, 16, v6
    s_waitcnt lgkmcnt(0)
    s_mov_b32 s12, s4
    s_mov_b32 s13, s5
    s_and_b32 s13, s13, 0xffff
    s_mov_b32 s14, 2097152
    s_mov_b32 s15, 0x00020000
    s_mov_b32 s16, s8
    s_mov_b32 s17, s9
    s_and_b32 s17, s17, 0xffff
    s_mov_b32 s18, 12288
    s_mov_b32 s19, 0x00020000
    s_add_u32 s20, s8, 71303168
    s_addc_u32 s21, s9, 0
    s_and_b32 s21, s21, 0xffff
    s_mov_b32 s22, 8388608
    s_mov_b32 s23, 0x00020000
    s_add_u32 s24, s8, 104857600
    s_addc_u32 s25, s9, 0
    s_and_b32 s25, s25, 0xffff
    s_mov_b32 s26, 4194304
    s_mov_b32 s27, 0x00020000
    s_add_u32 s28, s8, 109051904
    s_addc_u32 s29, s9, 0
    s_and_b32 s29, s29, 0xffff
    s_mov_b32 s30, 2097152
    s_mov_b32 s31, 0x00020000
    s_mov_b32 s40, 0
    buffer_load_dwordx4 v[32:35], v6, s[20:23], s40 offen
    s_mov_b32 s40, 32768
    buffer_load_dwordx4 v[36:39], v6, s[20:23], s40 offen
    s_mov_b32 s40, 2097152
    buffer_load_dwordx4 v[40:43], v6, s[20:23], s40 offen
    s_mov_b32 s40, 2129920
    buffer_load_dwordx4 v[44:47], v6, s[20:23], s40 offen
    s_mov_b32 s40, 4194304
    buffer_load_dwordx4 v[48:51], v6, s[20:23], s40 offen
    s_mov_b32 s40, 4227072
    buffer_load_dwordx4 v[52:55], v6, s[20:23], s40 offen
    s_mov_b32 s40, 6291456
    buffer_load_dwordx4 v[56:59], v6, s[20:23], s40 offen
    s_mov_b32 s40, 6324224
    buffer_load_dwordx4 v[60:63], v6, s[20:23], s40 offen
    buffer_load_dwordx2 v[80:81], v4, s[12:15], 0 offen offset:0
    buffer_load_dwordx2 v[82:83], v4, s[12:15], 0 offen offset:16
    buffer_load_dwordx2 v[84:85], v4, s[12:15], 0 offen offset:32
    buffer_load_dwordx2 v[86:87], v4, s[12:15], 0 offen offset:48
    v_add_u32 v7, 4096, v5
    buffer_load_dwordx4 v[96:99], v7, s[16:19], 0 offen offset:0
    buffer_load_dwordx4 v[100:103], v7, s[16:19], 0 offen offset:32
    buffer_load_dwordx4 v[104:107], v7, s[16:19], 0 offen offset:64
    buffer_load_dwordx4 v[108:111], v7, s[16:19], 0 offen offset:96
    v_add_u32 v7, 8192, v5
    buffer_load_dwordx4 v[112:115], v7, s[16:19], 0 offen offset:0
    buffer_load_dwordx4 v[116:119], v7, s[16:19], 0 offen offset:32
    buffer_load_dwordx4 v[120:123], v7, s[16:19], 0 offen offset:64
    buffer_load_dwordx4 v[124:127], v7, s[16:19], 0 offen offset:96
    v_add_u32 v7, 6144, v5
    buffer_load_dwordx4 v[128:131], v7, s[16:19], 0 offen offset:0
    buffer_load_dwordx4 v[132:135], v7, s[16:19], 0 offen offset:32
    buffer_load_dwordx4 v[136:139], v7, s[16:19], 0 offen offset:64
    buffer_load_dwordx4 v[140:143], v7, s[16:19], 0 offen offset:96
    s_waitcnt vmcnt(16)
    v_lshlrev_b32 v16, 16, v32
    v_and_b32 v17, 0xffff0000, v32
    v_lshlrev_b32 v18, 16, v33
    v_and_b32 v19, 0xffff0000, v33
    v_lshlrev_b32 v20, 16, v34
    v_and_b32 v21, 0xffff0000, v34
    v_lshlrev_b32 v22, 16, v35
    v_and_b32 v23, 0xffff0000, v35
    v_lshlrev_b32 v24, 16, v36
    v_and_b32 v25, 0xffff0000, v36
    v_lshlrev_b32 v26, 16, v37
    v_and_b32 v27, 0xffff0000, v37
    v_lshlrev_b32 v28, 16, v38
    v_and_b32 v29, 0xffff0000, v38
    v_lshlrev_b32 v30, 16, v39
    v_and_b32 v31, 0xffff0000, v39
    v_lshlrev_b32 v8, 16, v40
    v_and_b32 v9, 0xffff0000, v40
    v_add_f32 v16, v16, v8
    v_add_f32 v17, v17, v9
    v_lshlrev_b32 v8, 16, v41
    v_and_b32 v9, 0xffff0000, v41
    v_add_f32 v18, v18, v8
    v_add_f32 v19, v19, v9
    v_lshlrev_b32 v8, 16, v42
    v_and_b32 v9, 0xffff0000, v42
    v_add_f32 v20, v20, v8
    v_add_f32 v21, v21, v9
    v_lshlrev_b32 v8, 16, v43
    v_and_b32 v9, 0xffff0000, v43
    v_add_f32 v22, v22, v8
    v_add_f32 v23, v23, v9
    v_lshlrev_b32 v8, 16, v44
    v_and_b32 v9, 0xffff0000, v44
    v_add_f32 v24, v24, v8
    v_add_f32 v25, v25, v9
    v_lshlrev_b32 v8, 16, v45
    v_and_b32 v9, 0xffff0000, v45
    v_add_f32 v26, v26, v8
    v_add_f32 v27, v27, v9
    v_lshlrev_b32 v8, 16, v46
    v_and_b32 v9, 0xffff0000, v46
    v_add_f32 v28, v28, v8
    v_add_f32 v29, v29, v9
    v_lshlrev_b32 v8, 16, v47
    v_and_b32 v9, 0xffff0000, v47
    v_add_f32 v30, v30, v8
    v_add_f32 v31, v31, v9
    v_lshlrev_b32 v8, 16, v48
    v_and_b32 v9, 0xffff0000, v48
    v_add_f32 v16, v16, v8
    v_add_f32 v17, v17, v9
    v_lshlrev_b32 v8, 16, v49
    v_and_b32 v9, 0xffff0000, v49
    v_add_f32 v18, v18, v8
    v_add_f32 v19, v19, v9
    v_lshlrev_b32 v8, 16, v50
    v_and_b32 v9, 0xffff0000, v50
    v_add_f32 v20, v20, v8
    v_add_f32 v21, v21, v9
    v_lshlrev_b32 v8, 16, v51
    v_and_b32 v9, 0xffff0000, v51
    v_add_f32 v22, v22, v8
    v_add_f32 v23, v23, v9
    v_lshlrev_b32 v8, 16, v52
    v_and_b32 v9, 0xffff0000, v52
    v_add_f32 v24, v24, v8
    v_add_f32 v25, v25, v9
    v_lshlrev_b32 v8, 16, v53
    v_and_b32 v9, 0xffff0000, v53
    v_add_f32 v26, v26, v8
    v_add_f32 v27, v27, v9
    v_lshlrev_b32 v8, 16, v54
    v_and_b32 v9, 0xffff0000, v54
    v_add_f32 v28, v28, v8
    v_add_f32 v29, v29, v9
    v_lshlrev_b32 v8, 16, v55
    v_and_b32 v9, 0xffff0000, v55
    v_add_f32 v30, v30, v8
    v_add_f32 v31, v31, v9
    v_lshlrev_b32 v8, 16, v56
    v_and_b32 v9, 0xffff0000, v56
    v_add_f32 v16, v16, v8
    v_add_f32 v17, v17, v9
    v_lshlrev_b32 v8, 16, v57
    v_and_b32 v9, 0xffff0000, v57
    v_add_f32 v18, v18, v8
    v_add_f32 v19, v19, v9
    v_lshlrev_b32 v8, 16, v58
    v_and_b32 v9, 0xffff0000, v58
    v_add_f32 v20, v20, v8
    v_add_f32 v21, v21, v9
    v_lshlrev_b32 v8, 16, v59
    v_and_b32 v9, 0xffff0000, v59
    v_add_f32 v22, v22, v8
    v_add_f32 v23, v23, v9
    v_lshlrev_b32 v8, 16, v60
    v_and_b32 v9, 0xffff0000, v60
    v_add_f32 v24, v24, v8
    v_add_f32 v25, v25, v9
    v_lshlrev_b32 v8, 16, v61
    v_and_b32 v9, 0xffff0000, v61
    v_add_f32 v26, v26, v8
    v_add_f32 v27, v27, v9
    v_lshlrev_b32 v8, 16, v62
    v_and_b32 v9, 0xffff0000, v62
    v_add_f32 v28, v28, v8
    v_add_f32 v29, v29, v9
    v_lshlrev_b32 v8, 16, v63
    v_and_b32 v9, 0xffff0000, v63
    v_add_f32 v30, v30, v8
    v_add_f32 v31, v31, v9
    s_waitcnt vmcnt(8)
    v_lshlrev_b32 v8, 16, v80
    v_fma_f32 v16, v16, v96, v8
    v_and_b32 v8, 0xffff0000, v80
    v_fma_f32 v17, v17, v97, v8
    v_lshlrev_b32 v8, 16, v81
    v_fma_f32 v18, v18, v98, v8
    v_and_b32 v8, 0xffff0000, v81
    v_fma_f32 v19, v19, v99, v8
    v_lshlrev_b32 v8, 16, v82
    v_fma_f32 v20, v20, v100, v8
    v_and_b32 v8, 0xffff0000, v82
    v_fma_f32 v21, v21, v101, v8
    v_lshlrev_b32 v8, 16, v83
    v_fma_f32 v22, v22, v102, v8
    v_and_b32 v8, 0xffff0000, v83
    v_fma_f32 v23, v23, v103, v8
    v_lshlrev_b32 v8, 16, v84
    v_fma_f32 v24, v24, v104, v8
    v_and_b32 v8, 0xffff0000, v84
    v_fma_f32 v25, v25, v105, v8
    v_lshlrev_b32 v8, 16, v85
    v_fma_f32 v26, v26, v106, v8
    v_and_b32 v8, 0xffff0000, v85
    v_fma_f32 v27, v27, v107, v8
    v_lshlrev_b32 v8, 16, v86
    v_fma_f32 v28, v28, v108, v8
    v_and_b32 v8, 0xffff0000, v86
    v_fma_f32 v29, v29, v109, v8
    v_lshlrev_b32 v8, 16, v87
    v_fma_f32 v30, v30, v110, v8
    v_and_b32 v8, 0xffff0000, v87
    v_fma_f32 v31, v31, v111, v8
    s_mov_b32 s40, 0
    buffer_store_dwordx4 v[16:19], v3, s[24:27], s40 offen
    s_mov_b32 s40, 32768
    buffer_store_dwordx4 v[20:23], v3, s[24:27], s40 offen
    s_mov_b32 s40, 65536
    buffer_store_dwordx4 v[24:27], v3, s[24:27], s40 offen
    s_mov_b32 s40, 98304
    buffer_store_dwordx4 v[28:31], v3, s[24:27], s40 offen
    v_add_f32 v8, v16, v17
    v_add_f32 v8, v8, v18
    v_add_f32 v8, v8, v19
    v_add_f32 v8, v8, v20
    v_add_f32 v8, v8, v21
    v_add_f32 v8, v8, v22
    v_add_f32 v8, v8, v23
    v_add_f32 v8, v8, v24
    v_add_f32 v8, v8, v25
    v_add_f32 v8, v8, v26
    v_add_f32 v8, v8, v27
    v_add_f32 v8, v8, v28
    v_add_f32 v8, v8, v29
    v_add_f32 v8, v8, v30
    v_add_f32 v8, v8, v31
    s_nop 1
    v_add_f32_dpp v8, v8, v8 row_ror:8 row_mask:0xf bank_mask:0xf
    v_mov_b32 v10, v8
    s_nop 1
    v_permlane16_swap_b32 v8, v10
    v_add_f32 v8, v8, v10
    v_mov_b32 v10, v8
    s_nop 1
    v_permlane32_swap_b32 v8, v10
    v_add_f32 v8, v8, v10
    v_lshrrev_b32 v9, 6, v0
    v_lshl_add_u32 v9, v9, 3, v1
    v_lshlrev_b32 v9, 2, v9
    ds_write_b32 v9, v8 offset:0
    s_waitcnt lgkmcnt(0)
    s_barrier
    v_lshlrev_b32 v9, 2, v1
    ds_read_b32 v144, v9 offset:0
    ds_read_b32 v145, v9 offset:32
    ds_read_b32 v146, v9 offset:64
    ds_read_b32 v147, v9 offset:96
    s_waitcnt lgkmcnt(0)
    v_add_f32 v144, v144, v145
    v_add_f32 v146, v146, v147
    v_add_f32 v8, v144, v146
    v_mul_f32 v8, 0.001953125, v8
    v_sub_f32 v32, v16, v8
    v_sub_f32 v33, v17, v8
    v_sub_f32 v34, v18, v8
    v_sub_f32 v35, v19, v8
    v_sub_f32 v36, v20, v8
    v_sub_f32 v37, v21, v8
    v_sub_f32 v38, v22, v8
    v_sub_f32 v39, v23, v8
    v_sub_f32 v40, v24, v8
    v_sub_f32 v41, v25, v8
    v_sub_f32 v42, v26, v8
    v_sub_f32 v43, v27, v8
    v_sub_f32 v44, v28, v8
    v_sub_f32 v45, v29, v8
    v_sub_f32 v46, v30, v8
    v_sub_f32 v47, v31, v8
    v_mul_f32 v8, v32, v32
    v_fmac_f32 v8, v33, v33
    v_fmac_f32 v8, v34, v34
    v_fmac_f32 v8, v35, v35
    v_fmac_f32 v8, v36, v36
    v_fmac_f32 v8, v37, v37
    v_fmac_f32 v8, v38, v38
    v_fmac_f32 v8, v39, v39
    v_fmac_f32 v8, v40, v40
    v_fmac_f32 v8, v41, v41
    v_fmac_f32 v8, v42, v42
    v_fmac_f32 v8, v43, v43
    v_fmac_f32 v8, v44, v44
    v_fmac_f32 v8, v45, v45
    v_fmac_f32 v8, v46, v46
    v_fmac_f32 v8, v47, v47
    s_nop 1
    v_add_f32_dpp v8, v8, v8 row_ror:8 row_mask:0xf bank_mask:0xf
    v_mov_b32 v10, v8
    s_nop 1
    v_permlane16_swap_b32 v8, v10
    v_add_f32 v8, v8, v10
    v_mov_b32 v10, v8
    s_nop 1
    v_permlane32_swap_b32 v8, v10
    v_add_f32 v8, v8, v10
    v_lshrrev_b32 v9, 6, v0
    v_lshl_add_u32 v9, v9, 3, v1
    v_lshlrev_b32 v9, 2, v9
    ds_write_b32 v9, v8 offset:128
    s_waitcnt lgkmcnt(0)
    s_barrier
    v_lshlrev_b32 v9, 2, v1
    ds_read_b32 v144, v9 offset:128
    ds_read_b32 v145, v9 offset:160
    ds_read_b32 v146, v9 offset:192
    ds_read_b32 v147, v9 offset:224
    s_waitcnt lgkmcnt(0)
    v_add_f32 v144, v144, v145
    v_add_f32 v146, v146, v147
    v_add_f32 v8, v144, v146
    v_mov_b32 v9, 925353388
    v_fmac_f32 v9, 0.001953125, v8
    v_rsq_f32 v8, v9
    s_waitcnt vmcnt(4)
    v_add_f32 v112, 1.0, v112
    v_mul_f32 v32, v32, v8
    v_fma_f32 v32, v32, v112, v128
    v_add_f32 v113, 1.0, v113
    v_mul_f32 v33, v33, v8
    v_fma_f32 v33, v33, v113, v129
    v_add_f32 v114, 1.0, v114
    v_mul_f32 v34, v34, v8
    v_fma_f32 v34, v34, v114, v130
    v_add_f32 v115, 1.0, v115
    v_mul_f32 v35, v35, v8
    v_fma_f32 v35, v35, v115, v131
    v_add_f32 v116, 1.0, v116
    v_mul_f32 v36, v36, v8
    v_fma_f32 v36, v36, v116, v132
    v_add_f32 v117, 1.0, v117
    v_mul_f32 v37, v37, v8
    v_fma_f32 v37, v37, v117, v133
    v_add_f32 v118, 1.0, v118
    v_mul_f32 v38, v38, v8
    v_fma_f32 v38, v38, v118, v134
    v_add_f32 v119, 1.0, v119
    v_mul_f32 v39, v39, v8
    v_fma_f32 v39, v39, v119, v135
    v_add_f32 v120, 1.0, v120
    v_mul_f32 v40, v40, v8
    v_fma_f32 v40, v40, v120, v136
    v_add_f32 v121, 1.0, v121
    v_mul_f32 v41, v41, v8
    v_fma_f32 v41, v41, v121, v137
    v_add_f32 v122, 1.0, v122
    v_mul_f32 v42, v42, v8
    v_fma_f32 v42, v42, v122, v138
    v_add_f32 v123, 1.0, v123
    v_mul_f32 v43, v43, v8
    v_fma_f32 v43, v43, v123, v139
    v_add_f32 v124, 1.0, v124
    v_mul_f32 v44, v44, v8
    v_fma_f32 v44, v44, v124, v140
    v_add_f32 v125, 1.0, v125
    v_mul_f32 v45, v45, v8
    v_fma_f32 v45, v45, v125, v141
    v_add_f32 v126, 1.0, v126
    v_mul_f32 v46, v46, v8
    v_fma_f32 v46, v46, v126, v142
    v_add_f32 v127, 1.0, v127
    v_mul_f32 v47, v47, v8
    v_fma_f32 v47, v47, v127, v143
    v_cvt_pk_bf16_f32 v48, v32, v33
    v_cvt_pk_bf16_f32 v49, v34, v35
    v_cvt_pk_bf16_f32 v50, v36, v37
    v_cvt_pk_bf16_f32 v51, v38, v39
    v_cvt_pk_bf16_f32 v52, v40, v41
    v_cvt_pk_bf16_f32 v53, v42, v43
    v_cvt_pk_bf16_f32 v54, v44, v45
    v_cvt_pk_bf16_f32 v55, v46, v47
    buffer_store_dwordx4 v[48:51], v6, s[28:31], 0 offen
    s_mov_b32 s40, 32768
    buffer_store_dwordx4 v[52:55], v6, s[28:31], s40 offen
L_red_end:
    s_endpgm
.globl ffn1_kernel
.p2align 8
.type ffn1_kernel,@function
ffn1_kernel:
    s_cmp_ge_u32 s2, 224
    s_cbranch_scc1 L_f1_end
    s_load_dwordx2 s[18:19], s[0:1], 56
    s_load_dwordx2 s[20:21], s[0:1], 64
    s_load_dwordx2 s[24:25], s[0:1], 112
    v_and_b32 v1, 63, v0
    v_lshrrev_b32 v2, 6, v0
    s_nop 0
    v_readfirstlane_b32 s38, v2
    s_and_b32 s30, s2, 7
    s_lshr_b32 s33, s2, 3
    s_and_b32 s31, s30, 1
    s_lshl_b32 s31, s31, 2
    s_and_b32 s32, s33, 3
    s_add_u32 s31, s31, s32
    s_lshr_b32 s59, s30, 1
    s_mul_i32 s59, s59, 7
    s_lshr_b32 s33, s33, 2
    s_add_u32 s59, s59, s33
    s_lshl_b32 s39, s31, 8
    s_lshl_b32 s32, s38, 6
    s_add_u32 s39, s39, s32
    s_mov_b32 s37, 3584
    s_lshl_b32 s36, s59, 7
    v_lshrrev_b32 v2, 4, v1
    v_and_b32 v3, 15, v1
    v_lshrrev_b32 v4, 2, v3
    v_and_b32 v5, 3, v3
    v_lshrrev_b32 v6, 1, v2
    v_lshl_add_u32 v6, v6, 4, v4
    v_lshlrev_b32 v6, 7, v6
    v_and_b32 v7, 1, v2
    v_lshlrev_b32 v7, 1, v7
    v_lshrrev_b32 v2, 1, v5
    v_add_u32 v7, v7, v2
    v_lshrrev_b32 v2, 1, v4
    v_lshl_add_u32 v7, v2, 2, v7
    v_lshl_add_u32 v6, v7, 4, v6
    v_and_b32 v2, 1, v5
    v_lshl_add_u32 v12, v2, 3, v6
    v_xor_b32 v13, 64, v12
    v_mov_b32 v8, v12
    v_mov_b32 v9, v13
    v_add_u32 v10, 32768, v12
    v_add_u32 v11, 32768, v13
    s_mov_b32 s43, 32768
    v_lshrrev_b32 v2, 3, v1
    v_bfe_u32 v4, v1, 4, 1
    v_lshlrev_b32 v4, 2, v4
    v_and_b32 v3, 7, v1
    v_xor_b32 v3, v3, v4
    s_lshl_b32 s30, s38, 6
    v_add_u32 v2, s30, v2
    v_mul_lo_u32 v2, v2, s37
    v_lshl_add_u32 v2, v3, 4, v2
    v_add_u32 v14, s36, v2
    s_mul_i32 s44, s37, 0
    s_mul_i32 s45, s37, 8
    s_mul_i32 s46, s37, 16
    s_mul_i32 s47, s37, 24
    s_mul_i32 s48, s37, 32
    s_mul_i32 s49, s37, 40
    s_mul_i32 s50, s37, 48
    s_mul_i32 s51, s37, 56
    s_lshl_b32 s42, s38, 13
    s_mov_b32 s41, 0
    s_mov_b32 s40, s42
    v_and_b32 v2, 31, v1
    v_add_u32 v2, s39, v2
    v_lshlrev_b32 v2, 4, v2
    v_lshrrev_b32 v3, 5, v1
    v_lshl_add_u32 v19, v3, 15, v2
    s_waitcnt lgkmcnt(0)
    s_mov_b32 s8, s18
    s_mov_b32 s9, s19
    s_and_b32 s9, s9, 0xffff
    s_mov_b32 s10, 1835008
    s_mov_b32 s11, 0x00020000
    s_add_u32 s4, s24, 109051904
    s_addc_u32 s5, s25, 0
    s_and_b32 s5, s5, 0xffff
    s_mov_b32 s6, 2097152
    s_mov_b32 s7, 0x00020000
    s_mov_b32 s12, s20
    s_mov_b32 s13, s21
    s_and_b32 s13, s13, 0xffff
    s_mov_b32 s14, 1835008
    s_mov_b32 s15, 0x00020000
    s_add_u32 s16, s24, 111149056
    s_addc_u32 s17, s25, 0
    s_and_b32 s17, s17, 0xffff
    s_mov_b32 s18, 7340032
    s_mov_b32 s19, 0x00020000
    s_add_u32 m0, s40, 0
    s_nop 0
    buffer_load_dwordx4 v14, s[8:11], s44 offen lds
    s_add_u32 m0, s40, 1024
    s_nop 0
    buffer_load_dwordx4 v14, s[8:11], s45 offen lds
    s_add_u32 m0, s40, 2048
    s_nop 0
    buffer_load_dwordx4 v14, s[8:11], s46 offen lds
    s_add_u32 m0, s40, 3072
    s_nop 0
    buffer_load_dwordx4 v14, s[8:11], s47 offen lds
    s_add_u32 m0, s40, 4096
    s_nop 0
    buffer_load_dwordx4 v14, s[8:11], s48 offen lds
    s_add_u32 m0, s40, 5120
    s_nop 0
    buffer_load_dwordx4 v14, s[8:11], s49 offen lds
    s_add_u32 m0, s40, 6144
    s_nop 0
    buffer_load_dwordx4 v14, s[8:11], s50 offen lds
    s_add_u32 m0, s40, 7168
    s_nop 0
    buffer_load_dwordx4 v14, s[8:11], s51 offen lds
    v_add_u32 v14, 917504, v14
    s_add_u32 s41, s41, 32768
    s_and_b32 s41, s41, 0x1ffff
    s_add_u32 s40, s41, s42
    s_mov_b32 s30, 0
    buffer_load_dwordx4 a[0:3], v19, s[4:7], s30 offen offset:0
    buffer_load_dwordx4 a[128:131], v19, s[4:7], s30 offen offset:512
    s_mov_b32 s30, 65536
    buffer_load_dwordx4 a[4:7], v19, s[4:7], s30 offen offset:0
    buffer_load_dwordx4 a[132:135], v19, s[4:7], s30 offen offset:512
    s_mov_b32 s30, 131072
    buffer_load_dwordx4 a[8:11], v19, s[4:7], s30 offen offset:0
    buffer_load_dwordx4 a[136:139], v19, s[4:7], s30 offen offset:512
    s_mov_b32 s30, 196608
    buffer_load_dwordx4 a[12:15], v19, s[4:7], s30 offen offset:0
    buffer_load_dwordx4 a[140:143], v19, s[4:7], s30 offen offset:512
    s_mov_b32 s30, 262144
    buffer_load_dwordx4 a[16:19], v19, s[4:7], s30 offen offset:0
    buffer_load_dwordx4 a[144:147], v19, s[4:7], s30 offen offset:512
    s_mov_b32 s30, 327680
    buffer_load_dwordx4 a[20:23], v19, s[4:7], s30 offen offset:0
    buffer_load_dwordx4 a[148:151], v19, s[4:7], s30 offen offset:512
    s_mov_b32 s30, 393216
    buffer_load_dwordx4 a[24:27], v19, s[4:7], s30 offen offset:0
    buffer_load_dwordx4 a[152:155], v19, s[4:7], s30 offen offset:512
    s_mov_b32 s30, 458752
    buffer_load_dwordx4 a[28:31], v19, s[4:7], s30 offen offset:0
    buffer_load_dwordx4 a[156:159], v19, s[4:7], s30 offen offset:512
    s_add_u32 m0, s40, 0
    s_nop 0
    buffer_load_dwordx4 v14, s[8:11], s44 offen lds
    s_add_u32 m0, s40, 1024
    s_nop 0
    buffer_load_dwordx4 v14, s[8:11], s45 offen lds
    s_add_u32 m0, s40, 2048
    s_nop 0
    buffer_load_dwordx4 v14, s[8:11], s46 offen lds
    s_add_u32 m0, s40, 3072
    s_nop 0
    buffer_load_dwordx4 v14, s[8:11], s47 offen lds
    s_add_u32 m0, s40, 4096
    s_nop 0
    buffer_load_dwordx4 v14, s[8:11], s48 offen lds
    s_add_u32 m0, s40, 5120
    s_nop 0
    buffer_load_dwordx4 v14, s[8:11], s49 offen lds
    s_add_u32 m0, s40, 6144
    s_nop 0
    buffer_load_dwordx4 v14, s[8:11], s50 offen lds
    s_add_u32 m0, s40, 7168
    s_nop 0
    buffer_load_dwordx4 v14, s[8:11], s51 offen lds
    v_add_u32 v14, 4294049792, v14
    s_add_u32 s41, s41, 32768
    s_and_b32 s41, s41, 0x1ffff
    s_add_u32 s40, s41, s42
    s_add_u32 m0, s40, 0
    s_nop 0
    buffer_load_dwordx4 v14, s[12:15], s44 offen lds
    s_add_u32 m0, s40, 1024
    s_nop 0
    buffer_load_dwordx4 v14, s[12:15], s45 offen lds
    s_add_u32 m0, s40, 2048
    s_nop 0
    buffer_load_dwordx4 v14, s[12:15], s46 offen lds
    s_add_u32 m0, s40, 3072
    s_nop 0
    buffer_load_dwordx4 v14, s[12:15], s47 offen lds
    s_add_u32 m0, s40, 4096
    s_nop 0
    buffer_load_dwordx4 v14, s[12:15], s48 offen lds
    s_add_u32 m0, s40, 5120
    s_nop 0
    buffer_load_dwordx4 v14, s[12:15], s49 offen lds
    s_add_u32 m0, s40, 6144
    s_nop 0
    buffer_load_dwordx4 v14, s[12:15], s50 offen lds
    s_add_u32 m0, s40, 7168
    s_nop 0
    buffer_load_dwordx4 v14, s[12:15], s51 offen lds
    v_add_u32 v14, 917504, v14
    s_add_u32 s41, s41, 32768
    s_and_b32 s41, s41, 0x1ffff
    s_add_u32 s40, s41, s42
    v_and_b32 v4, 31, v1
    v_lshrrev_b32 v5, 5, v1
    v_add_u32 v6, s39, v4
    v_lshlrev_b32 v6, 4, v6
    v_lshl_add_u32 v15, v5, 16, v6
    s_lshl_b32 s60, s59, 18
    s_waitcnt vmcnt(32)
    s_barrier
    ds_read_b64_tr_b16 v[32:33], v8 offset:0
    ds_read_b64_tr_b16 v[34:35], v8 offset:1024
    ds_read_b64_tr_b16 v[36:37], v9 offset:0
    ds_read_b64_tr_b16 v[38:39], v9 offset:1024
    ds_read_b64_tr_b16 v[40:41], v8 offset:512
    ds_read_b64_tr_b16 v[42:43], v8 offset:1536
    s_waitcnt lgkmcnt(4)
    ds_read_b64_tr_b16 v[44:45], v9 offset:512
    ds_read_b64_tr_b16 v[46:47], v9 offset:1536
    s_mov_b32 s30, 524288
    buffer_load_dwordx4 a[32:35], v19, s[4:7], s30 offen offset:0
    buffer_load_dwordx4 a[160:163], v19, s[4:7], s30 offen offset:512
    s_waitcnt vmcnt(32)
    v_mfma_f32_32x32x16_bf16 v[64:79], v[32:35], a[0:3], 0
    v_mfma_f32_32x32x16_bf16 v[80:95], v[32:35], a[128:131], 0
    s_waitcnt lgkmcnt(4)
    ds_read_b64_tr_b16 v[32:33], v8 offset:4096
    ds_read_b64_tr_b16 v[34:35], v8 offset:5120
    v_mfma_f32_32x32x16_bf16 v[96:111], v[36:39], a[0:3], 0
    v_mfma_f32_32x32x16_bf16 v[112:127], v[36:39], a[128:131], 0
    s_waitcnt lgkmcnt(4)
    ds_read_b64_tr_b16 v[36:37], v9 offset:4096
    ds_read_b64_tr_b16 v[38:39], v9 offset:5120
    s_mov_b32 s30, 589824
    buffer_load_dwordx4 a[36:39], v19, s[4:7], s30 offen offset:0
    buffer_load_dwordx4 a[164:167], v19, s[4:7], s30 offen offset:512
    s_waitcnt vmcnt(32)
    v_mfma_f32_32x32x16_bf16 v[64:79], v[40:43], a[4:7], v[64:79]
    v_mfma_f32_32x32x16_bf16 v[80:95], v[40:43], a[132:135], v[80:95]
    s_waitcnt lgkmcnt(4)
    ds_read_b64_tr_b16 v[40:41], v8 offset:4608
    ds_read_b64_tr_b16 v[42:43], v8 offset:5632
    v_mfma_f32_32x32x16_bf16 v[96:111], v[44:47], a[4:7], v[96:111]
    v_mfma_f32_32x32x16_bf16 v[112:127], v[44:47], a[132:135], v[112:127]
    s_waitcnt lgkmcnt(4)
    ds_read_b64_tr_b16 v[44:45], v9 offset:4608
    ds_read_b64_tr_b16 v[46:47], v9 offset:5632
    s_mov_b32 s30, 655360
    buffer_load_dwordx4 a[40:43], v19, s[4:7], s30 offen offset:0
    buffer_load_dwordx4 a[168:171], v19, s[4:7], s30 offen offset:512
    s_waitcnt vmcnt(32)
    v_mfma_f32_32x32x16_bf16 v[64:79], v[32:35], a[8:11], v[64:79]
    v_mfma_f32_32x32x16_bf16 v[80:95], v[32:35], a[136:139], v[80:95]
    s_waitcnt lgkmcnt(4)
    ds_read_b64_tr_b16 v[32:33], v8 offset:8192
    ds_read_b64_tr_b16 v[34:35], v8 offset:9216
    v_mfma_f32_32x32x16_bf16 v[96:111], v[36:39], a[8:11], v[96:111]
    v_mfma_f32_32x32x16_bf16 v[112:127], v[36:39], a[136:139], v[112:127]
    s_waitcnt lgkmcnt(4)
    ds_read_b64_tr_b16 v[36:37], v9 offset:8192
    ds_read_b64_tr_b16 v[38:39], v9 offset:9216
    s_mov_b32 s30, 720896
    buffer_load_dwordx4 a[44:47], v19, s[4:7], s30 offen offset:0
    buffer_load_dwordx4 a[172:175], v19, s[4:7], s30 offen offset:512
    s_waitcnt vmcnt(32)
    v_mfma_f32_32x32x16_bf16 v[64:79], v[40:43], a[12:15], v[64:79]
    v_mfma_f32_32x32x16_bf16 v[80:95], v[40:43], a[140:143], v[80:95]
    s_waitcnt lgkmcnt(4)
    ds_read_b64_tr_b16 v[40:41], v8 offset:8704
    ds_read_b64_tr_b16 v[42:43], v8 offset:9728
    v_mfma_f32_32x32x16_bf16 v[96:111], v[44:47], a[12:15], v[96:111]
    v_mfma_f32_32x32x16_bf16 v[112:127], v[44:47], a[140:143], v[112:127]
    s_waitcnt lgkmcnt(4)
    ds_read_b64_tr_b16 v[44:45], v9 offset:8704
    ds_read_b64_tr_b16 v[46:47], v9 offset:9728
    s_mov_b32 s30, 786432
    buffer_load_dwordx4 a[48:51], v19, s[4:7], s30 offen offset:0
    buffer_load_dwordx4 a[176:179], v19, s[4:7], s30 offen offset:512
    s_waitcnt vmcnt(32)
    v_mfma_f32_32x32x16_bf16 v[64:79], v[32:35], a[16:19], v[64:79]
    v_mfma_f32_32x32x16_bf16 v[80:95], v[32:35], a[144:147], v[80:95]
    s_waitcnt lgkmcnt(4)
    ds_read_b64_tr_b16 v[32:33], v8 offset:12288
    ds_read_b64_tr_b16 v[34:35], v8 offset:13312
    v_mfma_f32_32x32x16_bf16 v[96:111], v[36:39], a[16:19], v[96:111]
    v_mfma_f32_32x32x16_bf16 v[112:127], v[36:39], a[144:147], v[112:127]
    s_waitcnt lgkmcnt(4)
    ds_read_b64_tr_b16 v[36:37], v9 offset:12288
    ds_read_b64_tr_b16 v[38:39], v9 offset:13312
    s_mov_b32 s30, 851968
    buffer_load_dwordx4 a[52:55], v19, s[4:7], s30 offen offset:0
    buffer_load_dwordx4 a[180:183], v19, s[4:7], s30 offen offset:512
    s_waitcnt vmcnt(32)
    v_mfma_f32_32x32x16_bf16 v[64:79], v[40:43], a[20:23], v[64:79]
    v_mfma_f32_32x32x16_bf16 v[80:95], v[40:43], a[148:151], v[80:95]
    s_waitcnt lgkmcnt(4)
    ds_read_b64_tr_b16 v[40:41], v8 offset:12800
    ds_read_b64_tr_b16 v[42:43], v8 offset:13824
    v_mfma_f32_32x32x16_bf16 v[96:111], v[44:47], a[20:23], v[96:111]
    v_mfma_f32_32x32x16_bf16 v[112:127], v[44:47], a[148:151], v[112:127]
    s_waitcnt lgkmcnt(4)
    ds_read_b64_tr_b16 v[44:45], v9 offset:12800
    ds_read_b64_tr_b16 v[46:47], v9 offset:13824
    s_mov_b32 s30, 917504
    buffer_load_dwordx4 a[56:59], v19, s[4:7], s30 offen offset:0
    buffer_load_dwordx4 a[184:187], v19, s[4:7], s30 offen offset:512
    s_waitcnt vmcnt(32)
    v_mfma_f32_32x32x16_bf16 v[64:79], v[32:35], a[24:27], v[64:79]
    v_mfma_f32_32x32x16_bf16 v[80:95], v[32:35], a[152:155], v[80:95]
    s_waitcnt lgkmcnt(4)
    ds_read_b64_tr_b16 v[32:33], v8 offset:16384
    ds_read_b64_tr_b16 v[34:35], v8 offset:17408
    v_mfma_f32_32x32x16_bf16 v[96:111], v[36:39], a[24:27], v[96:111]
    v_mfma_f32_32x32x16_bf16 v[112:127], v[36:39], a[152:155], v[112:127]
    s_waitcnt lgkmcnt(4)
    ds_read_b64_tr_b16 v[36:37], v9 offset:16384
    ds_read_b64_tr_b16 v[38:39], v9 offset:17408
    s_mov_b32 s30, 983040
    buffer_load_dwordx4 a[60:63], v19, s[4:7], s30 offen offset:0
    buffer_load_dwordx4 a[188:191], v19, s[4:7], s30 offen offset:512
    s_waitcnt vmcnt(32)
    v_mfma_f32_32x32x16_bf16 v[64:79], v[40:43], a[28:31], v[64:79]
    v_mfma_f32_32x32x16_bf16 v[80:95], v[40:43], a[156:159], v[80:95]
    s_waitcnt lgkmcnt(4)
    ds_read_b64_tr_b16 v[40:41], v8 offset:16896
    ds_read_b64_tr_b16 v[42:43], v8 offset:17920
    v_mfma_f32_32x32x16_bf16 v[96:111], v[44:47], a[28:31], v[96:111]
    v_mfma_f32_32x32x16_bf16 v[112:127], v[44:47], a[156:159], v[112:127]
    s_waitcnt vmcnt(24)
    s_barrier
    s_waitcnt lgkmcnt(4)
    ds_read_b64_tr_b16 v[44:45], v9 offset:16896
    ds_read_b64_tr_b16 v[46:47], v9 offset:17920
    s_mov_b32 s30, 1048576
    buffer_load_dwordx4 a[64:67], v19, s[4:7], s30 offen offset:0
    buffer_load_dwordx4 a[192:195], v19, s[4:7], s30 offen offset:512
    s_waitcnt vmcnt(16)
    v_mfma_f32_32x32x16_bf16 v[64:79], v[32:35], a[32:35], v[64:79]
    v_mfma_f32_32x32x16_bf16 v[80:95], v[32:35], a[160:163], v[80:95]
    s_waitcnt lgkmcnt(4)
    ds_read_b64_tr_b16 v[32:33], v8 offset:20480
    ds_read_b64_tr_b16 v[34:35], v8 offset:21504
    s_add_u32 m0, s40, 0
    s_nop 0
    buffer_load_dwordx4 v14, s[12:15], s44 offen lds
    v_mfma_f32_32x32x16_bf16 v[96:111], v[36:39], a[32:35], v[96:111]
    v_mfma_f32_32x32x16_bf16 v[112:127], v[36:39], a[160:163], v[112:127]
    s_waitcnt lgkmcnt(4)
    ds_read_b64_tr_b16 v[36:37], v9 offset:20480
    ds_read_b64_tr_b16 v[38:39], v9 offset:21504
    s_mov_b32 s30, 1114112
    buffer_load_dwordx4 a[68:71], v19, s[4:7], s30 offen offset:0
    buffer_load_dwordx4 a[196:199], v19, s[4:7], s30 offen offset:512
    s_waitcnt vmcnt(17)
    v_mfma_f32_32x32x16_bf16 v[64:79], v[40:43], a[36:39], v[64:79]
    s_add_u32 m0, s40, 1024
    s_nop 0
    buffer_load_dwordx4 v14, s[12:15], s45 offen lds
    v_mfma_f32_32x32x16_bf16 v[80:95], v[40:43], a[164:167], v[80:95]
    s_waitcnt lgkmcnt(4)
    ds_read_b64_tr_b16 v[40:41], v8 offset:20992
    ds_read_b64_tr_b16 v[42:43], v8 offset:22016
    v_mfma_f32_32x32x16_bf16 v[96:111], v[44:47], a[36:39], v[96:111]
    v_mfma_f32_32x32x16_bf16 v[112:127], v[44:47], a[164:167], v[112:127]
    s_waitcnt lgkmcnt(4)
    ds_read_b64_tr_b16 v[44:45], v9 offset:20992
    ds_read_b64_tr_b16 v[46:47], v9 offset:22016
    s_mov_b32 s30, 1179648
    buffer_load_dwordx4 a[72:75], v19, s[4:7], s30 offen offset:0
    buffer_load_dwordx4 a[200:203], v19, s[4:7], s30 offen offset:512
    s_waitcnt vmcnt(18)
    s_add_u32 m0, s40, 2048
    s_nop 0
    buffer_load_dwordx4 v14, s[12:15], s46 offen lds
    v_mfma_f32_32x32x16_bf16 v[64:79], v[32:35], a[40:43], v[64:79]
    v_mfma_f32_32x32x16_bf16 v[80:95], v[32:35], a[168:171], v[80:95]
    s_waitcnt lgkmcnt(4)
    ds_read_b64_tr_b16 v[32:33], v8 offset:24576
    ds_read_b64_tr_b16 v[34:35], v8 offset:25600
    v_mfma_f32_32x32x16_bf16 v[96:111], v[36:39], a[40:43], v[96:111]
    s_add_u32 m0, s40, 3072
    s_nop 0
    buffer_load_dwordx4 v14, s[12:15], s47 offen lds
    v_mfma_f32_32x32x16_bf16 v[112:127], v[36:39], a[168:171], v[112:127]
    s_waitcnt lgkmcnt(4)
    ds_read_b64_tr_b16 v[36:37], v9 offset:24576
    ds_read_b64_tr_b16 v[38:39], v9 offset:25600
    s_mov_b32 s30, 1245184
    buffer_load_dwordx4 a[76:79], v19, s[4:7], s30 offen offset:0
    buffer_load_dwordx4 a[204:207], v19, s[4:7], s30 offen offset:512
    s_waitcnt vmcnt(20)
    v_mfma_f32_32x32x16_bf16 v[64:79], v[40:43], a[44:47], v[64:79]
    v_mfma_f32_32x32x16_bf16 v[80:95], v[40:43], a[172:175], v[80:95]
    s_waitcnt lgkmcnt(4)
    ds_read_b64_tr_b16 v[40:41], v8 offset:25088
    ds_read_b64_tr_b16 v[42:43], v8 offset:26112
    s_add_u32 m0, s40, 4096
    s_nop 0
    buffer_load_dwordx4 v14, s[12:15], s48 offen lds
    v_mfma_f32_32x32x16_bf16 v[96:111], v[44:47], a[44:47], v[96:111]
    v_mfma_f32_32x32x16_bf16 v[112:127], v[44:47], a[172:175], v[112:127]
    s_waitcnt lgkmcnt(4)
    ds_read_b64_tr_b16 v[44:45], v9 offset:25088
    ds_read_b64_tr_b16 v[46:47], v9 offset:26112
    s_mov_b32 s30, 1310720
    buffer_load_dwordx4 a[80:83], v19, s[4:7], s30 offen offset:0
    buffer_load_dwordx4 a[208:211], v19, s[4:7], s30 offen offset:512
    s_waitcnt vmcnt(21)
    v_mfma_f32_32x32x16_bf16 v[64:79], v[32:35], a[48:51], v[64:79]
    s_add_u32 m0, s40, 5120
    s_nop 0
    buffer_load_dwordx4 v14, s[12:15], s49 offen lds
    v_mfma_f32_32x32x16_bf16 v[80:95], v[32:35], a[176:179], v[80:95]
    s_waitcnt lgkmcnt(4)
    ds_read_b64_tr_b16 v[32:33], v8 offset:28672
    ds_read_b64_tr_b16 v[34:35], v8 offset:29696
    v_mfma_f32_32x32x16_bf16 v[96:111], v[36:39], a[48:51], v[96:111]
    v_mfma_f32_32x32x16_bf16 v[112:127], v[36:39], a[176:179], v[112:127]
    s_waitcnt lgkmcnt(4)
    ds_read_b64_tr_b16 v[36:37], v9 offset:28672
    ds_read_b64_tr_b16 v[38:39], v9 offset:29696
    s_mov_b32 s30, 1376256
    buffer_load_dwordx4 a[84:87], v19, s[4:7], s30 offen offset:0
    buffer_load_dwordx4 a[212:215], v19, s[4:7], s30 offen offset:512
    s_waitcnt vmcnt(22)
    s_add_u32 m0, s40, 6144
    s_nop 0
    buffer_load_dwordx4 v14, s[12:15], s50 offen lds
    v_mfma_f32_32x32x16_bf16 v[64:79], v[40:43], a[52:55], v[64:79]
    v_mfma_f32_32x32x16_bf16 v[80:95], v[40:43], a[180:183], v[80:95]
    s_waitcnt lgkmcnt(4)
    ds_read_b64_tr_b16 v[40:41], v8 offset:29184
    ds_read_b64_tr_b16 v[42:43], v8 offset:30208
    v_mfma_f32_32x32x16_bf16 v[96:111], v[44:47], a[52:55], v[96:111]
    s_add_u32 m0, s40, 7168
    s_nop 0
    buffer_load_dwordx4 v14, s[12:15], s51 offen lds
    v_mfma_f32_32x32x16_bf16 v[112:127], v[44:47], a[180:183], v[112:127]
    s_waitcnt lgkmcnt(4)
    ds_read_b64_tr_b16 v[44:45], v9 offset:29184
    ds_read_b64_tr_b16 v[46:47], v9 offset:30208
    s_mov_b32 s30, 1441792
    buffer_load_dwordx4 a[88:91], v19, s[4:7], s30 offen offset:0
    buffer_load_dwordx4 a[216:219], v19, s[4:7], s30 offen offset:512
    s_waitcnt vmcnt(24)
    v_mfma_f32_32x32x16_bf16 v[64:79], v[32:35], a[56:59], v[64:79]
    v_mfma_f32_32x32x16_bf16 v[80:95], v[32:35], a[184:187], v[80:95]
    s_waitcnt lgkmcnt(4)
    ds_read_b64_tr_b16 v[32:33], v10 offset:0
    ds_read_b64_tr_b16 v[34:35], v10 offset:1024
    v_add_u32 v14, 0, v14
    s_add_u32 s41, s41, 32768
    s_and_b32 s41, s41, 0x1ffff
    s_add_u32 s40, s41, s42
    v_mfma_f32_32x32x16_bf16 v[96:111], v[36:39], a[56:59], v[96:111]
    v_mfma_f32_32x32x16_bf16 v[112:127], v[36:39], a[184:187], v[112:127]
    s_waitcnt lgkmcnt(4)
    ds_read_b64_tr_b16 v[36:37], v11 offset:0
    ds_read_b64_tr_b16 v[38:39], v11 offset:1024
    s_mov_b32 s30, 1507328
    buffer_load_dwordx4 a[92:95], v19, s[4:7], s30 offen offset:0
    buffer_load_dwordx4 a[220:223], v19, s[4:7], s30 offen offset:512
    s_waitcnt vmcnt(24)
    v_mfma_f32_32x32x16_bf16 v[64:79], v[40:43], a[60:63], v[64:79]
    v_mfma_f32_32x32x16_bf16 v[80:95], v[40:43], a[188:191], v[80:95]
    s_waitcnt lgkmcnt(4)
    ds_read_b64_tr_b16 v[40:41], v10 offset:512
    ds_read_b64_tr_b16 v[42:43], v10 offset:1536
    v_mfma_f32_32x32x16_bf16 v[96:111], v[44:47], a[60:63], v[96:111]
    v_mfma_f32_32x32x16_bf16 v[112:127], v[44:47], a[188:191], v[112:127]
    v_mov_b32 v8, v10
    v_mov_b32 v9, v11
    s_add_u32 s43, s43, 32768
    s_and_b32 s43, s43, 0x1ffff
    v_add_u32 v10, s43, v12
    v_add_u32 v11, s43, v13
    s_waitcnt lgkmcnt(4)
    ds_read_b64_tr_b16 v[44:45], v9 offset:512
    ds_read_b64_tr_b16 v[46:47], v9 offset:1536
    s_mov_b32 s30, 1572864
    buffer_load_dwordx4 a[96:99], v19, s[4:7], s30 offen offset:0
    buffer_load_dwordx4 a[224:227], v19, s[4:7], s30 offen offset:512
    s_waitcnt vmcnt(24)
    v_mfma_f32_32x32x16_bf16 v[64:79], v[32:35], a[64:67], v[64:79]
    v_mfma_f32_32x32x16_bf16 v[80:95], v[32:35], a[192:195], v[80:95]
    s_waitcnt lgkmcnt(4)
    ds_read_b64_tr_b16 v[32:33], v8 offset:4096
    ds_read_b64_tr_b16 v[34:35], v8 offset:5120
    v_mfma_f32_32x32x16_bf16 v[96:111], v[36:39], a[64:67], v[96:111]
    v_mfma_f32_32x32x16_bf16 v[112:127], v[36:39], a[192:195], v[112:127]
    s_waitcnt lgkmcnt(4)
    ds_read_b64_tr_b16 v[36:37], v9 offset:4096
    ds_read_b64_tr_b16 v[38:39], v9 offset:5120
    s_mov_b32 s30, 1638400
    buffer_load_dwordx4 a[100:103], v19, s[4:7], s30 offen offset:0
    buffer_load_dwordx4 a[228:231], v19, s[4:7], s30 offen offset:512
    s_waitcnt vmcnt(23)
    v_mfma_f32_32x32x16_bf16 v[64:79], v[40:43], a[68:71], v[64:79]
    v_mfma_f32_32x32x16_bf16 v[80:95], v[40:43], a[196:199], v[80:95]
    s_waitcnt lgkmcnt(4)
    ds_read_b64_tr_b16 v[40:41], v8 offset:4608
    ds_read_b64_tr_b16 v[42:43], v8 offset:5632
    v_mfma_f32_32x32x16_bf16 v[96:111], v[44:47], a[68:71], v[96:111]
    v_mfma_f32_32x32x16_bf16 v[112:127], v[44:47], a[196:199], v[112:127]
    s_waitcnt lgkmcnt(4)
    ds_read_b64_tr_b16 v[44:45], v9 offset:4608
    ds_read_b64_tr_b16 v[46:47], v9 offset:5632
    s_mov_b32 s30, 1703936
    buffer_load_dwordx4 a[104:107], v19, s[4:7], s30 offen offset:0
    buffer_load_dwordx4 a[232:235], v19, s[4:7], s30 offen offset:512
    s_waitcnt vmcnt(22)
    v_mfma_f32_32x32x16_bf16 v[64:79], v[32:35], a[72:75], v[64:79]
    v_mfma_f32_32x32x16_bf16 v[80:95], v[32:35], a[200:203], v[80:95]
    s_waitcnt lgkmcnt(4)
    ds_read_b64_tr_b16 v[32:33], v8 offset:8192
    ds_read_b64_tr_b16 v[34:35], v8 offset:9216
    v_mfma_f32_32x32x16_bf16 v[96:111], v[36:39], a[72:75], v[96:111]
    v_mfma_f32_32x32x16_bf16 v[112:127], v[36:39], a[200:203], v[112:127]
    s_waitcnt lgkmcnt(4)
    ds_read_b64_tr_b16 v[36:37], v9 offset:8192
    ds_read_b64_tr_b16 v[38:39], v9 offset:9216
    s_mov_b32 s30, 1769472
    buffer_load_dwordx4 a[108:111], v19, s[4:7], s30 offen offset:0
    buffer_load_dwordx4 a[236:239], v19, s[4:7], s30 offen offset:512
    s_waitcnt vmcnt(20)
    v_mfma_f32_32x32x16_bf16 v[64:79], v[40:43], a[76:79], v[64:79]
    v_mfma_f32_32x32x16_bf16 v[80:95], v[40:43], a[204:207], v[80:95]
    s_waitcnt lgkmcnt(4)
    ds_read_b64_tr_b16 v[40:41], v8 offset:8704
    ds_read_b64_tr_b16 v[42:43], v8 offset:9728
    v_mfma_f32_32x32x16_bf16 v[96:111], v[44:47], a[76:79], v[96:111]
    v_mfma_f32_32x32x16_bf16 v[112:127], v[44:47], a[204:207], v[112:127]
    s_waitcnt lgkmcnt(4)
    ds_read_b64_tr_b16 v[44:45], v9 offset:8704
    ds_read_b64_tr_b16 v[46:47], v9 offset:9728
    s_mov_b32 s30, 1835008
    buffer_load_dwordx4 a[112:115], v19, s[4:7], s30 offen offset:0
    buffer_load_dwordx4 a[240:243], v19, s[4:7], s30 offen offset:512
    s_waitcnt vmcnt(19)
    v_mfma_f32_32x32x16_bf16 v[64:79], v[32:35], a[80:83], v[64:79]
    v_mfma_f32_32x32x16_bf16 v[80:95], v[32:35], a[208:211], v[80:95]
    s_waitcnt lgkmcnt(4)
    ds_read_b64_tr_b16 v[32:33], v8 offset:12288
    ds_read_b64_tr_b16 v[34:35], v8 offset:13312
    v_mfma_f32_32x32x16_bf16 v[96:111], v[36:39], a[80:83], v[96:111]
    v_mfma_f32_32x32x16_bf16 v[112:127], v[36:39], a[208:211], v[112:127]
    s_waitcnt lgkmcnt(4)
    ds_read_b64_tr_b16 v[36:37], v9 offset:12288
    ds_read_b64_tr_b16 v[38:39], v9 offset:13312
    s_mov_b32 s30, 1900544
    buffer_load_dwordx4 a[116:119], v19, s[4:7], s30 offen offset:0
    buffer_load_dwordx4 a[244:247], v19, s[4:7], s30 offen offset:512
    s_waitcnt vmcnt(18)
    v_mfma_f32_32x32x16_bf16 v[64:79], v[40:43], a[84:87], v[64:79]
    v_mfma_f32_32x32x16_bf16 v[80:95], v[40:43], a[212:215], v[80:95]
    s_waitcnt lgkmcnt(4)
    ds_read_b64_tr_b16 v[40:41], v8 offset:12800
    ds_read_b64_tr_b16 v[42:43], v8 offset:13824
    v_mfma_f32_32x32x16_bf16 v[96:111], v[44:47], a[84:87], v[96:111]
    v_mfma_f32_32x32x16_bf16 v[112:127], v[44:47], a[212:215], v[112:127]
    s_waitcnt lgkmcnt(4)
    ds_read_b64_tr_b16 v[44:45], v9 offset:12800
    ds_read_b64_tr_b16 v[46:47], v9 offset:13824
    s_mov_b32 s30, 1966080
    buffer_load_dwordx4 a[120:123], v19, s[4:7], s30 offen offset:0
    buffer_load_dwordx4 a[248:251], v19, s[4:7], s30 offen offset:512
    s_waitcnt vmcnt(16)
    v_mfma_f32_32x32x16_bf16 v[64:79], v[32:35], a[88:91], v[64:79]
    v_mfma_f32_32x32x16_bf16 v[80:95], v[32:35], a[216:219], v[80:95]
    s_waitcnt lgkmcnt(4)
    ds_read_b64_tr_b16 v[32:33], v8 offset:16384
    ds_read_b64_tr_b16 v[34:35], v8 offset:17408
    v_mfma_f32_32x32x16_bf16 v[96:111], v[36:39], a[88:91], v[96:111]
    v_mfma_f32_32x32x16_bf16 v[112:127], v[36:39], a[216:219], v[112:127]
    s_waitcnt lgkmcnt(4)
    ds_read_b64_tr_b16 v[36:37], v9 offset:16384
    ds_read_b64_tr_b16 v[38:39], v9 offset:17408
    s_mov_b32 s30, 2031616
    buffer_load_dwordx4 a[124:127], v19, s[4:7], s30 offen offset:0
    buffer_load_dwordx4 a[252:255], v19, s[4:7], s30 offen offset:512
    s_waitcnt vmcnt(16)
    v_mfma_f32_32x32x16_bf16 v[64:79], v[40:43], a[92:95], v[64:79]
    v_mfma_f32_32x32x16_bf16 v[80:95], v[40:43], a[220:223], v[80:95]
    s_waitcnt lgkmcnt(4)
    ds_read_b64_tr_b16 v[40:41], v8 offset:16896
    ds_read_b64_tr_b16 v[42:43], v8 offset:17920
    v_mfma_f32_32x32x16_bf16 v[96:111], v[44:47], a[92:95], v[96:111]
    v_mfma_f32_32x32x16_bf16 v[112:127], v[44:47], a[220:223], v[112:127]
    s_waitcnt vmcnt(56)
    s_barrier
    s_waitcnt lgkmcnt(4)
    ds_read_b64_tr_b16 v[44:45], v9 offset:16896
    ds_read_b64_tr_b16 v[46:47], v9 offset:17920
    s_waitcnt vmcnt(14)
    v_mfma_f32_32x32x16_bf16 v[64:79], v[32:35], a[96:99], v[64:79]
    v_mfma_f32_32x32x16_bf16 v[80:95], v[32:35], a[224:227], v[80:95]
    s_waitcnt lgkmcnt(4)
    ds_read_b64_tr_b16 v[32:33], v8 offset:20480
    ds_read_b64_tr_b16 v[34:35], v8 offset:21504
    v_mfma_f32_32x32x16_bf16 v[96:111], v[36:39], a[96:99], v[96:111]
    v_mfma_f32_32x32x16_bf16 v[112:127], v[36:39], a[224:227], v[112:127]
    s_waitcnt lgkmcnt(4)
    ds_read_b64_tr_b16 v[36:37], v9 offset:20480
    ds_read_b64_tr_b16 v[38:39], v9 offset:21504
    s_waitcnt vmcnt(12)
    v_mfma_f32_32x32x16_bf16 v[64:79], v[40:43], a[100:103], v[64:79]
    v_mfma_f32_32x32x16_bf16 v[80:95], v[40:43], a[228:231], v[80:95]
    s_waitcnt lgkmcnt(4)
    ds_read_b64_tr_b16 v[40:41], v8 offset:20992
    ds_read_b64_tr_b16 v[42:43], v8 offset:22016
    v_mfma_f32_32x32x16_bf16 v[96:111], v[44:47], a[100:103], v[96:111]
    v_mfma_f32_32x32x16_bf16 v[112:127], v[44:47], a[228:231], v[112:127]
    s_waitcnt lgkmcnt(4)
    ds_read_b64_tr_b16 v[44:45], v9 offset:20992
    ds_read_b64_tr_b16 v[46:47], v9 offset:22016
    s_waitcnt vmcnt(10)
    v_mfma_f32_32x32x16_bf16 v[64:79], v[32:35], a[104:107], v[64:79]
    v_mfma_f32_32x32x16_bf16 v[80:95], v[32:35], a[232:235], v[80:95]
    s_waitcnt lgkmcnt(4)
    ds_read_b64_tr_b16 v[32:33], v8 offset:24576
    ds_read_b64_tr_b16 v[34:35], v8 offset:25600
    v_mfma_f32_32x32x16_bf16 v[96:111], v[36:39], a[104:107], v[96:111]
    v_mfma_f32_32x32x16_bf16 v[112:127], v[36:39], a[232:235], v[112:127]
    s_waitcnt lgkmcnt(4)
    ds_read_b64_tr_b16 v[36:37], v9 offset:24576
    ds_read_b64_tr_b16 v[38:39], v9 offset:25600
    s_waitcnt vmcnt(8)
    v_mfma_f32_32x32x16_bf16 v[64:79], v[40:43], a[108:111], v[64:79]
    v_mfma_f32_32x32x16_bf16 v[80:95], v[40:43], a[236:239], v[80:95]
    s_waitcnt lgkmcnt(4)
    ds_read_b64_tr_b16 v[40:41], v8 offset:25088
    ds_read_b64_tr_b16 v[42:43], v8 offset:26112
    v_mfma_f32_32x32x16_bf16 v[96:111], v[44:47], a[108:111], v[96:111]
    v_mfma_f32_32x32x16_bf16 v[112:127], v[44:47], a[236:239], v[112:127]
    s_waitcnt lgkmcnt(4)
    ds_read_b64_tr_b16 v[44:45], v9 offset:25088
    ds_read_b64_tr_b16 v[46:47], v9 offset:26112
    s_waitcnt vmcnt(6)
    v_mfma_f32_32x32x16_bf16 v[64:79], v[32:35], a[112:115], v[64:79]
    v_mfma_f32_32x32x16_bf16 v[80:95], v[32:35], a[240:243], v[80:95]
    s_waitcnt lgkmcnt(4)
    ds_read_b64_tr_b16 v[32:33], v8 offset:28672
    ds_read_b64_tr_b16 v[34:35], v8 offset:29696
    v_mfma_f32_32x32x16_bf16 v[96:111], v[36:39], a[112:115], v[96:111]
    v_mfma_f32_32x32x16_bf16 v[112:127], v[36:39], a[240:243], v[112:127]
    s_waitcnt lgkmcnt(4)
    ds_read_b64_tr_b16 v[36:37], v9 offset:28672
    ds_read_b64_tr_b16 v[38:39], v9 offset:29696
    s_waitcnt vmcnt(4)
    v_mfma_f32_32x32x16_bf16 v[64:79], v[40:43], a[116:119], v[64:79]
    v_mfma_f32_32x32x16_bf16 v[80:95], v[40:43], a[244:247], v[80:95]
    s_waitcnt lgkmcnt(4)
    ds_read_b64_tr_b16 v[40:41], v8 offset:29184
    ds_read_b64_tr_b16 v[42:43], v8 offset:30208
    v_mfma_f32_32x32x16_bf16 v[96:111], v[44:47], a[116:119], v[96:111]
    v_mfma_f32_32x32x16_bf16 v[112:127], v[44:47], a[244:247], v[112:127]
    s_waitcnt lgkmcnt(4)
    ds_read_b64_tr_b16 v[44:45], v9 offset:29184
    ds_read_b64_tr_b16 v[46:47], v9 offset:30208
    s_waitcnt vmcnt(2)
    v_mfma_f32_32x32x16_bf16 v[64:79], v[32:35], a[120:123], v[64:79]
    v_mfma_f32_32x32x16_bf16 v[80:95], v[32:35], a[248:251], v[80:95]
    s_waitcnt lgkmcnt(4)
    ds_read_b64_tr_b16 v[32:33], v10 offset:0
    ds_read_b64_tr_b16 v[34:35], v10 offset:1024
    v_mfma_f32_32x32x16_bf16 v[96:111], v[36:39], a[120:123], v[96:111]
    v_mfma_f32_32x32x16_bf16 v[112:127], v[36:39], a[248:251], v[112:127]
    s_waitcnt lgkmcnt(4)
    ds_read_b64_tr_b16 v[36:37], v11 offset:0
    ds_read_b64_tr_b16 v[38:39], v11 offset:1024
    s_waitcnt vmcnt(0)
    v_mfma_f32_32x32x16_bf16 v[64:79], v[40:43], a[124:127], v[64:79]
    v_mfma_f32_32x32x16_bf16 v[80:95], v[40:43], a[252:255], v[80:95]
    s_waitcnt lgkmcnt(4)
    ds_read_b64_tr_b16 v[40:41], v10 offset:512
    ds_read_b64_tr_b16 v[42:43], v10 offset:1536
    v_mfma_f32_32x32x16_bf16 v[96:111], v[44:47], a[124:127], v[96:111]
    v_mfma_f32_32x32x16_bf16 v[112:127], v[44:47], a[252:255], v[112:127]
    v_mov_b32 v8, v10
    v_mov_b32 v9, v11
    s_add_u32 s43, s43, 32768
    s_and_b32 s43, s43, 0x1ffff
    v_add_u32 v10, s43, v12
    v_add_u32 v11, s43, v13
    s_mov_b32 s61, 3222493025
    s_mov_b32 s62, 3184710632
    v_mov_b32 v7, s61
    s_waitcnt lgkmcnt(4)
    ds_read_b64_tr_b16 v[44:45], v9 offset:512
    ds_read_b64_tr_b16 v[46:47], v9 offset:1536
    v_mfma_f32_32x32x16_bf16 v[128:143], v[32:35], a[0:3], 0
    v_mfma_f32_32x32x16_bf16 v[144:159], v[32:35], a[128:131], 0
    s_waitcnt lgkmcnt(4)
    ds_read_b64_tr_b16 v[32:33], v8 offset:4096
    ds_read_b64_tr_b16 v[34:35], v8 offset:5120
    v_mfma_f32_32x32x16_bf16 v[160:175], v[36:39], a[0:3], 0
    v_mfma_f32_32x32x16_bf16 v[176:191], v[36:39], a[128:131], 0
    s_waitcnt lgkmcnt(4)
    ds_read_b64_tr_b16 v[36:37], v9 offset:4096
    ds_read_b64_tr_b16 v[38:39], v9 offset:5120
    v_mul_f32 v20, v64, v64
    v_fma_f32 v20, v20, s62, v7
    v_mul_f32 v20, v20, v64
    v_exp_f32 v20, v20
    v_mul_f32 v21, v65, v65
    v_mfma_f32_32x32x16_bf16 v[128:143], v[40:43], a[4:7], v[128:143]
    v_fma_f32 v21, v21, s62, v7
    v_mul_f32 v21, v21, v65
    v_exp_f32 v21, v21
    v_add_f32 v20, 1.0, v20
    v_mfma_f32_32x32x16_bf16 v[144:159], v[40:43], a[132:135], v[144:159]
    s_waitcnt lgkmcnt(4)
    ds_read_b64_tr_b16 v[40:41], v8 offset:4608
    ds_read_b64_tr_b16 v[42:43], v8 offset:5632
    v_rcp_f32 v20, v20
    s_nop 0
    v_mul_f32 v64, v64, v20
    v_mul_f32 v22, v66, v66
    v_fma_f32 v22, v22, s62, v7
    v_mfma_f32_32x32x16_bf16 v[160:175], v[44:47], a[4:7], v[160:175]
    v_mul_f32 v22, v22, v66
    v_exp_f32 v22, v22
    v_add_f32 v21, 1.0, v21
    v_rcp_f32 v21, v21
    v_mfma_f32_32x32x16_bf16 v[176:191], v[44:47], a[132:135], v[176:191]
    s_waitcnt lgkmcnt(4)
    ds_read_b64_tr_b16 v[44:45], v9 offset:4608
    ds_read_b64_tr_b16 v[46:47], v9 offset:5632
    v_mul_f32 v65, v65, v21
    v_mul_f32 v23, v67, v67
    v_fma_f32 v23, v23, s62, v7
    v_mul_f32 v23, v23, v67
    v_mfma_f32_32x32x16_bf16 v[128:143], v[32:35], a[8:11], v[128:143]
    v_exp_f32 v23, v23
    v_add_f32 v22, 1.0, v22
    v_rcp_f32 v22, v22
    s_nop 0
    v_mul_f32 v66, v66, v22
    v_mfma_f32_32x32x16_bf16 v[144:159], v[32:35], a[136:139], v[144:159]
    s_waitcnt lgkmcnt(4)
    ds_read_b64_tr_b16 v[32:33], v8 offset:8192
    ds_read_b64_tr_b16 v[34:35], v8 offset:9216
    v_mul_f32 v20, v68, v68
    v_fma_f32 v20, v20, s62, v7
    v_mul_f32 v20, v20, v68
    v_exp_f32 v20, v20
    v_add_f32 v23, 1.0, v23
    v_mfma_f32_32x32x16_bf16 v[160:175], v[36:39], a[8:11], v[160:175]
    v_rcp_f32 v23, v23
    s_nop 0
    v_mul_f32 v67, v67, v23
    v_mul_f32 v21, v69, v69
    v_fma_f32 v21, v21, s62, v7
    v_mfma_f32_32x32x16_bf16 v[176:191], v[36:39], a[136:139], v[176:191]
    s_waitcnt lgkmcnt(4)
    ds_read_b64_tr_b16 v[36:37], v9 offset:8192
    ds_read_b64_tr_b16 v[38:39], v9 offset:9216
    v_mul_f32 v21, v21, v69
    v_exp_f32 v21, v21
    v_add_f32 v20, 1.0, v20
    v_rcp_f32 v20, v20
    v_mfma_f32_32x32x16_bf16 v[128:143], v[40:43], a[12:15], v[128:143]
    v_mul_f32 v68, v68, v20
    v_mul_f32 v22, v70, v70
    v_fma_f32 v22, v22, s62, v7
    v_mul_f32 v22, v22, v70
    v_mfma_f32_32x32x16_bf16 v[144:159], v[40:43], a[140:143], v[144:159]
    s_waitcnt lgkmcnt(4)
    ds_read_b64_tr_b16 v[40:41], v8 offset:8704
    ds_read_b64_tr_b16 v[42:43], v8 offset:9728
    v_exp_f32 v22, v22
    v_add_f32 v21, 1.0, v21
    v_rcp_f32 v21, v21
    s_nop 0
    v_mul_f32 v69, v69, v21
    v_mfma_f32_32x32x16_bf16 v[160:175], v[44:47], a[12:15], v[160:175]
    v_mul_f32 v23, v71, v71
    v_fma_f32 v23, v23, s62, v7
    v_mul_f32 v23, v23, v71
    v_exp_f32 v23, v23
    v_mfma_f32_32x32x16_bf16 v[176:191], v[44:47], a[140:143], v[176:191]
    s_waitcnt lgkmcnt(4)
    ds_read_b64_tr_b16 v[44:45], v9 offset:8704
    ds_read_b64_tr_b16 v[46:47], v9 offset:9728
    v_add_f32 v22, 1.0, v22
    v_rcp_f32 v22, v22
    s_nop 0
    v_mul_f32 v70, v70, v22
    v_mul_f32 v20, v72, v72
    v_mfma_f32_32x32x16_bf16 v[128:143], v[32:35], a[16:19], v[128:143]
    v_fma_f32 v20, v20, s62, v7
    v_mul_f32 v20, v20, v72
    v_exp_f32 v20, v20
    v_add_f32 v23, 1.0, v23
    v_rcp_f32 v23, v23
    v_mfma_f32_32x32x16_bf16 v[144:159], v[32:35], a[144:147], v[144:159]
    s_waitcnt lgkmcnt(4)
    ds_read_b64_tr_b16 v[32:33], v8 offset:12288
    ds_read_b64_tr_b16 v[34:35], v8 offset:13312
    v_mul_f32 v71, v71, v23
    v_mul_f32 v21, v73, v73
    v_fma_f32 v21, v21, s62, v7
    v_mul_f32 v21, v21, v73
    v_mfma_f32_32x32x16_bf16 v[160:175], v[36:39], a[16:19], v[160:175]
    v_exp_f32 v21, v21
    v_add_f32 v20, 1.0, v20
    v_rcp_f32 v20, v20
    s_nop 0
    v_mul_f32 v72, v72, v20
    v_mfma_f32_32x32x16_bf16 v[176:191], v[36:39], a[144:147], v[176:191]
    s_waitcnt lgkmcnt(4)
    ds_read_b64_tr_b16 v[36:37], v9 offset:12288
    ds_read_b64_tr_b16 v[38:39], v9 offset:13312
    v_mul_f32 v22, v74, v74
    v_fma_f32 v22, v22, s62, v7
    v_mul_f32 v22, v22, v74
    v_exp_f32 v22, v22
    v_mfma_f32_32x32x16_bf16 v[128:143], v[40:43], a[20:23], v[128:143]
    v_add_f32 v21, 1.0, v21
    v_rcp_f32 v21, v21
    s_nop 0
    v_mul_f32 v73, v73, v21
    v_mul_f32 v23, v75, v75
    v_mfma_f32_32x32x16_bf16 v[144:159], v[40:43], a[148:151], v[144:159]
    s_waitcnt lgkmcnt(4)
    ds_read_b64_tr_b16 v[40:41], v8 offset:12800
    ds_read_b64_tr_b16 v[42:43], v8 offset:13824
    v_fma_f32 v23, v23, s62, v7
    v_mul_f32 v23, v23, v75
    v_exp_f32 v23, v23
    v_add_f32 v22, 1.0, v22
    v_mfma_f32_32x32x16_bf16 v[160:175], v[44:47], a[20:23], v[160:175]
    v_rcp_f32 v22, v22
    s_nop 0
    v_mul_f32 v74, v74, v22
    v_mul_f32 v20, v76, v76
    v_fma_f32 v20, v20, s62, v7
    v_mfma_f32_32x32x16_bf16 v[176:191], v[44:47], a[148:151], v[176:191]
    s_waitcnt lgkmcnt(4)
    ds_read_b64_tr_b16 v[44:45], v9 offset:12800
    ds_read_b64_tr_b16 v[46:47], v9 offset:13824
    v_mul_f32 v20, v20, v76
    v_exp_f32 v20, v20
    v_add_f32 v23, 1.0, v23
    v_rcp_f32 v23, v23
    s_nop 0
    v_mul_f32 v75, v75, v23
    v_mfma_f32_32x32x16_bf16 v[128:143], v[32:35], a[24:27], v[128:143]
    v_mul_f32 v21, v77, v77
    v_fma_f32 v21, v21, s62, v7
    v_mul_f32 v21, v21, v77
    v_exp_f32 v21, v21
    v_mfma_f32_32x32x16_bf16 v[144:159], v[32:35], a[152:155], v[144:159]
    s_waitcnt lgkmcnt(4)
    ds_read_b64_tr_b16 v[32:33], v8 offset:16384
    ds_read_b64_tr_b16 v[34:35], v8 offset:17408
    v_add_f32 v20, 1.0, v20
    v_rcp_f32 v20, v20
    s_nop 0
    v_mul_f32 v76, v76, v20
    v_mul_f32 v22, v78, v78
    v_mfma_f32_32x32x16_bf16 v[160:175], v[36:39], a[24:27], v[160:175]
    v_fma_f32 v22, v22, s62, v7
    v_mul_f32 v22, v22, v78
    v_exp_f32 v22, v22
    v_add_f32 v21, 1.0, v21
    v_mfma_f32_32x32x16_bf16 v[176:191], v[36:39], a[152:155], v[176:191]
    s_waitcnt lgkmcnt(4)
    ds_read_b64_tr_b16 v[36:37], v9 offset:16384
    ds_read_b64_tr_b16 v[38:39], v9 offset:17408
    v_rcp_f32 v21, v21
    s_nop 0
    v_mul_f32 v77, v77, v21
    v_mul_f32 v23, v79, v79
    v_fma_f32 v23, v23, s62, v7
    v_mfma_f32_32x32x16_bf16 v[128:143], v[40:43], a[28:31], v[128:143]
    v_mul_f32 v23, v23, v79
    v_exp_f32 v23, v23
    v_add_f32 v22, 1.0, v22
    v_rcp_f32 v22, v22
    v_mfma_f32_32x32x16_bf16 v[144:159], v[40:43], a[156:159], v[144:159]
    s_waitcnt lgkmcnt(4)
    ds_read_b64_tr_b16 v[40:41], v8 offset:16896
    ds_read_b64_tr_b16 v[42:43], v8 offset:17920
    v_mul_f32 v78, v78, v22
    v_mul_f32 v20, v80, v80
    v_fma_f32 v20, v20, s62, v7
    v_mul_f32 v20, v20, v80
    v_mfma_f32_32x32x16_bf16 v[160:175], v[44:47], a[28:31], v[160:175]
    v_exp_f32 v20, v20
    v_add_f32 v23, 1.0, v23
    v_rcp_f32 v23, v23
    s_nop 0
    v_mul_f32 v79, v79, v23
    v_mul_f32 v21, v81, v81
    v_mfma_f32_32x32x16_bf16 v[176:191], v[44:47], a[156:159], v[176:191]
    s_waitcnt vmcnt(20)
    s_barrier
    s_waitcnt lgkmcnt(4)
    ds_read_b64_tr_b16 v[44:45], v9 offset:16896
    ds_read_b64_tr_b16 v[46:47], v9 offset:17920
    v_fma_f32 v21, v21, s62, v7
    v_mul_f32 v21, v21, v81
    v_exp_f32 v21, v21
    v_add_f32 v20, 1.0, v20
    v_mfma_f32_32x32x16_bf16 v[128:143], v[32:35], a[32:35], v[128:143]
    v_rcp_f32 v20, v20
    s_nop 0
    v_mul_f32 v80, v80, v20
    v_mul_f32 v22, v82, v82
    v_fma_f32 v22, v22, s62, v7
    v_mfma_f32_32x32x16_bf16 v[144:159], v[32:35], a[160:163], v[144:159]
    s_waitcnt lgkmcnt(4)
    ds_read_b64_tr_b16 v[32:33], v8 offset:20480
    ds_read_b64_tr_b16 v[34:35], v8 offset:21504
    v_mul_f32 v22, v22, v82
    v_exp_f32 v22, v22
    v_add_f32 v21, 1.0, v21
    v_rcp_f32 v21, v21
    v_mfma_f32_32x32x16_bf16 v[160:175], v[36:39], a[32:35], v[160:175]
    v_mul_f32 v81, v81, v21
    v_mul_f32 v23, v83, v83
    v_fma_f32 v23, v23, s62, v7
    v_mul_f32 v23, v23, v83
    v_mfma_f32_32x32x16_bf16 v[176:191], v[36:39], a[160:163], v[176:191]
    s_waitcnt lgkmcnt(4)
    ds_read_b64_tr_b16 v[36:37], v9 offset:20480
    ds_read_b64_tr_b16 v[38:39], v9 offset:21504
    v_exp_f32 v23, v23
    v_add_f32 v22, 1.0, v22
    v_rcp_f32 v22, v22
    s_nop 0
    v_mul_f32 v82, v82, v22
    v_mfma_f32_32x32x16_bf16 v[128:143], v[40:43], a[36:39], v[128:143]
    v_mul_f32 v20, v84, v84
    v_fma_f32 v20, v20, s62, v7
    v_mul_f32 v20, v20, v84
    v_exp_f32 v20, v20
    v_add_f32 v23, 1.0, v23
    v_mfma_f32_32x32x16_bf16 v[144:159], v[40:43], a[164:167], v[144:159]
    s_waitcnt lgkmcnt(4)
    ds_read_b64_tr_b16 v[40:41], v8 offset:20992
    ds_read_b64_tr_b16 v[42:43], v8 offset:22016
    v_rcp_f32 v23, v23
    s_nop 0
    v_mul_f32 v83, v83, v23
    v_mul_f32 v21, v85, v85
    v_fma_f32 v21, v21, s62, v7
    v_mfma_f32_32x32x16_bf16 v[160:175], v[44:47], a[36:39], v[160:175]
    v_mul_f32 v21, v21, v85
    v_exp_f32 v21, v21
    v_add_f32 v20, 1.0, v20
    v_rcp_f32 v20, v20
    v_mfma_f32_32x32x16_bf16 v[176:191], v[44:47], a[164:167], v[176:191]
    s_waitcnt lgkmcnt(4)
    ds_read_b64_tr_b16 v[44:45], v9 offset:20992
    ds_read_b64_tr_b16 v[46:47], v9 offset:22016
    v_mul_f32 v84, v84, v20
    v_mul_f32 v22, v86, v86
    v_fma_f32 v22, v22, s62, v7
    v_mul_f32 v22, v22, v86
    v_mfma_f32_32x32x16_bf16 v[128:143], v[32:35], a[40:43], v[128:143]
    v_exp_f32 v22, v22
    v_add_f32 v21, 1.0, v21
    v_rcp_f32 v21, v21
    s_nop 0
    v_mul_f32 v85, v85, v21
    v_mfma_f32_32x32x16_bf16 v[144:159], v[32:35], a[168:171], v[144:159]
    s_waitcnt lgkmcnt(4)
    ds_read_b64_tr_b16 v[32:33], v8 offset:24576
    ds_read_b64_tr_b16 v[34:35], v8 offset:25600
    v_mul_f32 v23, v87, v87
    v_fma_f32 v23, v23, s62, v7
    v_mul_f32 v23, v23, v87
    v_exp_f32 v23, v23
    v_mfma_f32_32x32x16_bf16 v[160:175], v[36:39], a[40:43], v[160:175]
    v_add_f32 v22, 1.0, v22
    v_rcp_f32 v22, v22
    s_nop 0
    v_mul_f32 v86, v86, v22
    v_mul_f32 v20, v88, v88
    v_mfma_f32_32x32x16_bf16 v[176:191], v[36:39], a[168:171], v[176:191]
    s_waitcnt lgkmcnt(4)
    ds_read_b64_tr_b16 v[36:37], v9 offset:24576
    ds_read_b64_tr_b16 v[38:39], v9 offset:25600
    v_fma_f32 v20, v20, s62, v7
    v_mul_f32 v20, v20, v88
    v_exp_f32 v20, v20
    v_add_f32 v23, 1.0, v23
    v_rcp_f32 v23, v23
    v_mfma_f32_32x32x16_bf16 v[128:143], v[40:43], a[44:47], v[128:143]
    v_mul_f32 v87, v87, v23
    v_mul_f32 v21, v89, v89
    v_fma_f32 v21, v21, s62, v7
    v_mul_f32 v21, v21, v89
    v_mfma_f32_32x32x16_bf16 v[144:159], v[40:43], a[172:175], v[144:159]
    s_waitcnt lgkmcnt(4)
    ds_read_b64_tr_b16 v[40:41], v8 offset:25088
    ds_read_b64_tr_b16 v[42:43], v8 offset:26112
    v_exp_f32 v21, v21
    v_add_f32 v20, 1.0, v20
    v_rcp_f32 v20, v20
    s_nop 0
    v_mul_f32 v88, v88, v20
    v_mfma_f32_32x32x16_bf16 v[160:175], v[44:47], a[44:47], v[160:175]
    v_mul_f32 v22, v90, v90
    v_fma_f32 v22, v22, s62, v7
    v_mul_f32 v22, v22, v90
    v_exp_f32 v22, v22
    v_mfma_f32_32x32x16_bf16 v[176:191], v[44:47], a[172:175], v[176:191]
    s_waitcnt lgkmcnt(4)
    ds_read_b64_tr_b16 v[44:45], v9 offset:25088
    ds_read_b64_tr_b16 v[46:47], v9 offset:26112
    v_add_f32 v21, 1.0, v21
    v_rcp_f32 v21, v21
    s_nop 0
    v_mul_f32 v89, v89, v21
    v_mul_f32 v23, v91, v91
    v_mfma_f32_32x32x16_bf16 v[128:143], v[32:35], a[48:51], v[128:143]
    v_fma_f32 v23, v23, s62, v7
    v_mul_f32 v23, v23, v91
    v_exp_f32 v23, v23
    v_add_f32 v22, 1.0, v22
    v_mfma_f32_32x32x16_bf16 v[144:159], v[32:35], a[176:179], v[144:159]
    s_waitcnt lgkmcnt(4)
    ds_read_b64_tr_b16 v[32:33], v8 offset:28672
    ds_read_b64_tr_b16 v[34:35], v8 offset:29696
    v_rcp_f32 v22, v22
    s_nop 0
    v_mul_f32 v90, v90, v22
    v_mul_f32 v20, v92, v92
    v_fma_f32 v20, v20, s62, v7
    v_mfma_f32_32x32x16_bf16 v[160:175], v[36:39], a[48:51], v[160:175]
    v_mul_f32 v20, v20, v92
    v_exp_f32 v20, v20
    v_add_f32 v23, 1.0, v23
    v_rcp_f32 v23, v23
    s_nop 0
    v_mul_f32 v91, v91, v23
    v_mfma_f32_32x32x16_bf16 v[176:191], v[36:39], a[176:179], v[176:191]
    s_waitcnt lgkmcnt(4)
    ds_read_b64_tr_b16 v[36:37], v9 offset:28672
    ds_read_b64_tr_b16 v[38:39], v9 offset:29696
    v_mul_f32 v21, v93, v93
    v_fma_f32 v21, v21, s62, v7
    v_mul_f32 v21, v21, v93
    v_exp_f32 v21, v21
    v_mfma_f32_32x32x16_bf16 v[128:143], v[40:43], a[52:55], v[128:143]
    v_add_f32 v20, 1.0, v20
    v_rcp_f32 v20, v20
    s_nop 0
    v_mul_f32 v92, v92, v20
    v_mul_f32 v22, v94, v94
    v_mfma_f32_32x32x16_bf16 v[144:159], v[40:43], a[180:183], v[144:159]
    s_waitcnt lgkmcnt(4)
    ds_read_b64_tr_b16 v[40:41], v8 offset:29184
    ds_read_b64_tr_b16 v[42:43], v8 offset:30208
    v_fma_f32 v22, v22, s62, v7
    v_mul_f32 v22, v22, v94
    v_exp_f32 v22, v22
    v_add_f32 v21, 1.0, v21
    v_mfma_f32_32x32x16_bf16 v[160:175], v[44:47], a[52:55], v[160:175]
    v_rcp_f32 v21, v21
    s_nop 0
    v_mul_f32 v93, v93, v21
    v_mul_f32 v23, v95, v95
    v_fma_f32 v23, v23, s62, v7
    v_mfma_f32_32x32x16_bf16 v[176:191], v[44:47], a[180:183], v[176:191]
    s_waitcnt lgkmcnt(4)
    ds_read_b64_tr_b16 v[44:45], v9 offset:29184
    ds_read_b64_tr_b16 v[46:47], v9 offset:30208
    v_mul_f32 v23, v23, v95
    v_exp_f32 v23, v23
    v_add_f32 v22, 1.0, v22
    v_rcp_f32 v22, v22
    v_mfma_f32_32x32x16_bf16 v[128:143], v[32:35], a[56:59], v[128:143]
    v_mul_f32 v94, v94, v22
    v_mul_f32 v20, v96, v96
    v_fma_f32 v20, v20, s62, v7
    v_mul_f32 v20, v20, v96
    v_mfma_f32_32x32x16_bf16 v[144:159], v[32:35], a[184:187], v[144:159]
    s_waitcnt lgkmcnt(4)
    ds_read_b64_tr_b16 v[32:33], v10 offset:0
    ds_read_b64_tr_b16 v[34:35], v10 offset:1024
    v_mfma_f32_32x32x16_bf16 v[160:175], v[36:39], a[56:59], v[160:175]
    v_mfma_f32_32x32x16_bf16 v[176:191], v[36:39], a[184:187], v[176:191]
    s_waitcnt lgkmcnt(4)
    ds_read_b64_tr_b16 v[36:37], v11 offset:0
    ds_read_b64_tr_b16 v[38:39], v11 offset:1024
    v_mfma_f32_32x32x16_bf16 v[128:143], v[40:43], a[60:63], v[128:143]
    v_mfma_f32_32x32x16_bf16 v[144:159], v[40:43], a[188:191], v[144:159]
    s_waitcnt lgkmcnt(4)
    ds_read_b64_tr_b16 v[40:41], v10 offset:512
    ds_read_b64_tr_b16 v[42:43], v10 offset:1536
    v_mfma_f32_32x32x16_bf16 v[160:175], v[44:47], a[60:63], v[160:175]
    v_mfma_f32_32x32x16_bf16 v[176:191], v[44:47], a[188:191], v[176:191]
    v_mov_b32 v8, v10
    v_mov_b32 v9, v11
    s_add_u32 s43, s43, 32768
    s_and_b32 s43, s43, 0x1ffff
    v_add_u32 v10, s43, v12
    v_add_u32 v11, s43, v13
    s_waitcnt lgkmcnt(4)
    ds_read_b64_tr_b16 v[44:45], v9 offset:512
    ds_read_b64_tr_b16 v[46:47], v9 offset:1536
    v_mfma_f32_32x32x16_bf16 v[128:143], v[32:35], a[64:67], v[128:143]
    v_mfma_f32_32x32x16_bf16 v[144:159], v[32:35], a[192:195], v[144:159]
    s_waitcnt lgkmcnt(4)
    ds_read_b64_tr_b16 v[32:33], v8 offset:4096
    ds_read_b64_tr_b16 v[34:35], v8 offset:5120
    v_exp_f32 v20, v20
    v_add_f32 v23, 1.0, v23
    v_rcp_f32 v23, v23
    s_nop 0
    v_mul_f32 v95, v95, v23
    v_mul_f32 v21, v97, v97
    v_mfma_f32_32x32x16_bf16 v[160:175], v[36:39], a[64:67], v[160:175]
    v_fma_f32 v21, v21, s62, v7
    v_mul_f32 v21, v21, v97
    v_exp_f32 v21, v21
    v_add_f32 v20, 1.0, v20
    v_mfma_f32_32x32x16_bf16 v[176:191], v[36:39], a[192:195], v[176:191]
    s_waitcnt lgkmcnt(4)
    ds_read_b64_tr_b16 v[36:37], v9 offset:4096
    ds_read_b64_tr_b16 v[38:39], v9 offset:5120
    v_rcp_f32 v20, v20
    s_nop 0
    v_mul_f32 v96, v96, v20
    v_mul_f32 v22, v98, v98
    v_fma_f32 v22, v22, s62, v7
    v_mfma_f32_32x32x16_bf16 v[128:143], v[40:43], a[68:71], v[128:143]
    v_mul_f32 v22, v22, v98
    v_exp_f32 v22, v22
    v_add_f32 v21, 1.0, v21
    v_rcp_f32 v21, v21
    v_mfma_f32_32x32x16_bf16 v[144:159], v[40:43], a[196:199], v[144:159]
    s_waitcnt lgkmcnt(4)
    ds_read_b64_tr_b16 v[40:41], v8 offset:4608
    ds_read_b64_tr_b16 v[42:43], v8 offset:5632
    v_mul_f32 v97, v97, v21
    v_mul_f32 v23, v99, v99
    v_fma_f32 v23, v23, s62, v7
    v_mul_f32 v23, v23, v99
    v_mfma_f32_32x32x16_bf16 v[160:175], v[44:47], a[68:71], v[160:175]
    v_exp_f32 v23, v23
    v_add_f32 v22, 1.0, v22
    v_rcp_f32 v22, v22
    s_nop 0
    v_mul_f32 v98, v98, v22
    v_mfma_f32_32x32x16_bf16 v[176:191], v[44:47], a[196:199], v[176:191]
    s_waitcnt lgkmcnt(4)
    ds_read_b64_tr_b16 v[44:45], v9 offset:4608
    ds_read_b64_tr_b16 v[46:47], v9 offset:5632
    v_mul_f32 v20, v100, v100
    v_fma_f32 v20, v20, s62, v7
    v_mul_f32 v20, v20, v100
    v_exp_f32 v20, v20
    v_add_f32 v23, 1.0, v23
    v_mfma_f32_32x32x16_bf16 v[128:143], v[32:35], a[72:75], v[128:143]
    v_rcp_f32 v23, v23
    s_nop 0
    v_mul_f32 v99, v99, v23
    v_mul_f32 v21, v101, v101
    v_fma_f32 v21, v21, s62, v7
    v_mfma_f32_32x32x16_bf16 v[144:159], v[32:35], a[200:203], v[144:159]
    s_waitcnt lgkmcnt(4)
    ds_read_b64_tr_b16 v[32:33], v8 offset:8192
    ds_read_b64_tr_b16 v[34:35], v8 offset:9216
    v_mul_f32 v21, v21, v101
    v_exp_f32 v21, v21
    v_add_f32 v20, 1.0, v20
    v_rcp_f32 v20, v20
    v_mfma_f32_32x32x16_bf16 v[160:175], v[36:39], a[72:75], v[160:175]
    v_mul_f32 v100, v100, v20
    v_mul_f32 v22, v102, v102
    v_fma_f32 v22, v22, s62, v7
    v_mul_f32 v22, v22, v102
    v_mfma_f32_32x32x16_bf16 v[176:191], v[36:39], a[200:203], v[176:191]
    s_waitcnt lgkmcnt(4)
    ds_read_b64_tr_b16 v[36:37], v9 offset:8192
    ds_read_b64_tr_b16 v[38:39], v9 offset:9216
    v_exp_f32 v22, v22
    v_add_f32 v21, 1.0, v21
    v_rcp_f32 v21, v21
    s_nop 0
    v_mul_f32 v101, v101, v21
    v_mfma_f32_32x32x16_bf16 v[128:143], v[40:43], a[76:79], v[128:143]
    v_mul_f32 v23, v103, v103
    v_fma_f32 v23, v23, s62, v7
    v_mul_f32 v23, v23, v103
    v_exp_f32 v23, v23
    v_mfma_f32_32x32x16_bf16 v[144:159], v[40:43], a[204:207], v[144:159]
    s_waitcnt lgkmcnt(4)
    ds_read_b64_tr_b16 v[40:41], v8 offset:8704
    ds_read_b64_tr_b16 v[42:43], v8 offset:9728
    v_add_f32 v22, 1.0, v22
    v_rcp_f32 v22, v22
    s_nop 0
    v_mul_f32 v102, v102, v22
    v_mul_f32 v20, v104, v104
    v_mfma_f32_32x32x16_bf16 v[160:175], v[44:47], a[76:79], v[160:175]
    v_fma_f32 v20, v20, s62, v7
    v_mul_f32 v20, v20, v104
    v_exp_f32 v20, v20
    v_add_f32 v23, 1.0, v23
    v_rcp_f32 v23, v23
    v_mfma_f32_32x32x16_bf16 v[176:191], v[44:47], a[204:207], v[176:191]
    s_waitcnt lgkmcnt(4)
    ds_read_b64_tr_b16 v[44:45], v9 offset:8704
    ds_read_b64_tr_b16 v[46:47], v9 offset:9728
    v_mul_f32 v103, v103, v23
    v_mul_f32 v21, v105, v105
    v_fma_f32 v21, v21, s62, v7
    v_mul_f32 v21, v21, v105
    v_mfma_f32_32x32x16_bf16 v[128:143], v[32:35], a[80:83], v[128:143]
    v_exp_f32 v21, v21
    v_add_f32 v20, 1.0, v20
    v_rcp_f32 v20, v20
    s_nop 0
    v_mul_f32 v104, v104, v20
    v_mfma_f32_32x32x16_bf16 v[144:159], v[32:35], a[208:211], v[144:159]
    s_waitcnt lgkmcnt(4)
    ds_read_b64_tr_b16 v[32:33], v8 offset:12288
    ds_read_b64_tr_b16 v[34:35], v8 offset:13312
    v_mul_f32 v22, v106, v106
    v_fma_f32 v22, v22, s62, v7
    v_mul_f32 v22, v22, v106
    v_exp_f32 v22, v22
    v_mfma_f32_32x32x16_bf16 v[160:175], v[36:39], a[80:83], v[160:175]
    v_add_f32 v21, 1.0, v21
    v_rcp_f32 v21, v21
    s_nop 0
    v_mul_f32 v105, v105, v21
    v_mul_f32 v23, v107, v107
    v_mfma_f32_32x32x16_bf16 v[176:191], v[36:39], a[208:211], v[176:191]
    s_waitcnt lgkmcnt(4)
    ds_read_b64_tr_b16 v[36:37], v9 offset:12288
    ds_read_b64_tr_b16 v[38:39], v9 offset:13312
    v_fma_f32 v23, v23, s62, v7
    v_mul_f32 v23, v23, v107
    v_exp_f32 v23, v23
    v_add_f32 v22, 1.0, v22
    v_mfma_f32_32x32x16_bf16 v[128:143], v[40:43], a[84:87], v[128:143]
    v_rcp_f32 v22, v22
    s_nop 0
    v_mul_f32 v106, v106, v22
    v_mul_f32 v20, v108, v108
    v_fma_f32 v20, v20, s62, v7
    v_mfma_f32_32x32x16_bf16 v[144:159], v[40:43], a[212:215], v[144:159]
    s_waitcnt lgkmcnt(4)
    ds_read_b64_tr_b16 v[40:41], v8 offset:12800
    ds_read_b64_tr_b16 v[42:43], v8 offset:13824
    v_mul_f32 v20, v20, v108
    v_exp_f32 v20, v20
    v_add_f32 v23, 1.0, v23
    v_rcp_f32 v23, v23
    s_nop 0
    v_mul_f32 v107, v107, v23
    v_mfma_f32_32x32x16_bf16 v[160:175], v[44:47], a[84:87], v[160:175]
    v_mul_f32 v21, v109, v109
    v_fma_f32 v21, v21, s62, v7
    v_mul_f32 v21, v21, v109
    v_exp_f32 v21, v21
    v_mfma_f32_32x32x16_bf16 v[176:191], v[44:47], a[212:215], v[176:191]
    s_waitcnt lgkmcnt(4)
    ds_read_b64_tr_b16 v[44:45], v9 offset:12800
    ds_read_b64_tr_b16 v[46:47], v9 offset:13824
    v_add_f32 v20, 1.0, v20
    v_rcp_f32 v20, v20
    s_nop 0
    v_mul_f32 v108, v108, v20
    v_mul_f32 v22, v110, v110
    v_mfma_f32_32x32x16_bf16 v[128:143], v[32:35], a[88:91], v[128:143]
    v_fma_f32 v22, v22, s62, v7
    v_mul_f32 v22, v22, v110
    v_exp_f32 v22, v22
    v_add_f32 v21, 1.0, v21
    v_mfma_f32_32x32x16_bf16 v[144:159], v[32:35], a[216:219], v[144:159]
    s_waitcnt lgkmcnt(4)
    ds_read_b64_tr_b16 v[32:33], v8 offset:16384
    ds_read_b64_tr_b16 v[34:35], v8 offset:17408
    v_rcp_f32 v21, v21
    s_nop 0
    v_mul_f32 v109, v109, v21
    v_mul_f32 v23, v111, v111
    v_fma_f32 v23, v23, s62, v7
    v_mfma_f32_32x32x16_bf16 v[160:175], v[36:39], a[88:91], v[160:175]
    v_mul_f32 v23, v23, v111
    v_exp_f32 v23, v23
    v_add_f32 v22, 1.0, v22
    v_rcp_f32 v22, v22
    v_mfma_f32_32x32x16_bf16 v[176:191], v[36:39], a[216:219], v[176:191]
    s_waitcnt lgkmcnt(4)
    ds_read_b64_tr_b16 v[36:37], v9 offset:16384
    ds_read_b64_tr_b16 v[38:39], v9 offset:17408
    v_mul_f32 v110, v110, v22
    v_mul_f32 v20, v112, v112
    v_fma_f32 v20, v20, s62, v7
    v_mul_f32 v20, v20, v112
    v_mfma_f32_32x32x16_bf16 v[128:143], v[40:43], a[92:95], v[128:143]
    v_exp_f32 v20, v20
    v_add_f32 v23, 1.0, v23
    v_rcp_f32 v23, v23
    s_nop 0
    v_mul_f32 v111, v111, v23
    v_mul_f32 v21, v113, v113
    v_mfma_f32_32x32x16_bf16 v[144:159], v[40:43], a[220:223], v[144:159]
    s_waitcnt lgkmcnt(4)
    ds_read_b64_tr_b16 v[40:41], v8 offset:16896
    ds_read_b64_tr_b16 v[42:43], v8 offset:17920
    v_fma_f32 v21, v21, s62, v7
    v_mul_f32 v21, v21, v113
    v_exp_f32 v21, v21
    v_add_f32 v20, 1.0, v20
    v_mfma_f32_32x32x16_bf16 v[160:175], v[44:47], a[92:95], v[160:175]
    v_rcp_f32 v20, v20
    s_nop 0
    v_mul_f32 v112, v112, v20
    v_mul_f32 v22, v114, v114
    v_fma_f32 v22, v22, s62, v7
    v_mfma_f32_32x32x16_bf16 v[176:191], v[44:47], a[220:223], v[176:191]
    s_waitcnt vmcnt(20)
    s_barrier
    s_waitcnt lgkmcnt(4)
    ds_read_b64_tr_b16 v[44:45], v9 offset:16896
    ds_read_b64_tr_b16 v[46:47], v9 offset:17920
    v_mul_f32 v22, v22, v114
    v_exp_f32 v22, v22
    v_add_f32 v21, 1.0, v21
    v_rcp_f32 v21, v21
    v_mfma_f32_32x32x16_bf16 v[128:143], v[32:35], a[96:99], v[128:143]
    v_mul_f32 v113, v113, v21
    v_mul_f32 v23, v115, v115
    v_fma_f32 v23, v23, s62, v7
    v_mul_f32 v23, v23, v115
    v_mfma_f32_32x32x16_bf16 v[144:159], v[32:35], a[224:227], v[144:159]
    s_waitcnt lgkmcnt(4)
    ds_read_b64_tr_b16 v[32:33], v8 offset:20480
    ds_read_b64_tr_b16 v[34:35], v8 offset:21504
    v_exp_f32 v23, v23
    v_add_f32 v22, 1.0, v22
    v_rcp_f32 v22, v22
    s_nop 0
    v_mul_f32 v114, v114, v22
    v_mfma_f32_32x32x16_bf16 v[160:175], v[36:39], a[96:99], v[160:175]
    v_mul_f32 v20, v116, v116
    v_fma_f32 v20, v20, s62, v7
    v_mul_f32 v20, v20, v116
    v_exp_f32 v20, v20
    v_add_f32 v23, 1.0, v23
    v_mfma_f32_32x32x16_bf16 v[176:191], v[36:39], a[224:227], v[176:191]
    s_waitcnt lgkmcnt(4)
    ds_read_b64_tr_b16 v[36:37], v9 offset:20480
    ds_read_b64_tr_b16 v[38:39], v9 offset:21504
    v_rcp_f32 v23, v23
    s_nop 0
    v_mul_f32 v115, v115, v23
    v_mul_f32 v21, v117, v117
    v_fma_f32 v21, v21, s62, v7
    v_mfma_f32_32x32x16_bf16 v[128:143], v[40:43], a[100:103], v[128:143]
    v_mul_f32 v21, v21, v117
    v_exp_f32 v21, v21
    v_add_f32 v20, 1.0, v20
    v_rcp_f32 v20, v20
    v_mfma_f32_32x32x16_bf16 v[144:159], v[40:43], a[228:231], v[144:159]
    s_waitcnt lgkmcnt(4)
    ds_read_b64_tr_b16 v[40:41], v8 offset:20992
    ds_read_b64_tr_b16 v[42:43], v8 offset:22016
    v_mul_f32 v116, v116, v20
    v_mul_f32 v22, v118, v118
    v_fma_f32 v22, v22, s62, v7
    v_mul_f32 v22, v22, v118
    v_mfma_f32_32x32x16_bf16 v[160:175], v[44:47], a[100:103], v[160:175]
    v_exp_f32 v22, v22
    v_add_f32 v21, 1.0, v21
    v_rcp_f32 v21, v21
    s_nop 0
    v_mul_f32 v117, v117, v21
    v_mfma_f32_32x32x16_bf16 v[176:191], v[44:47], a[228:231], v[176:191]
    s_waitcnt lgkmcnt(4)
    ds_read_b64_tr_b16 v[44:45], v9 offset:20992
    ds_read_b64_tr_b16 v[46:47], v9 offset:22016
    v_mul_f32 v23, v119, v119
    v_fma_f32 v23, v23, s62, v7
    v_mul_f32 v23, v23, v119
    v_exp_f32 v23, v23
    v_mfma_f32_32x32x16_bf16 v[128:143], v[32:35], a[104:107], v[128:143]
    v_add_f32 v22, 1.0, v22
    v_rcp_f32 v22, v22
    s_nop 0
    v_mul_f32 v118, v118, v22
    v_mul_f32 v20, v120, v120
    v_mfma_f32_32x32x16_bf16 v[144:159], v[32:35], a[232:235], v[144:159]
    s_waitcnt lgkmcnt(4)
    ds_read_b64_tr_b16 v[32:33], v8 offset:24576
    ds_read_b64_tr_b16 v[34:35], v8 offset:25600
    v_fma_f32 v20, v20, s62, v7
    v_mul_f32 v20, v20, v120
    v_exp_f32 v20, v20
    v_add_f32 v23, 1.0, v23
    v_rcp_f32 v23, v23
    v_mfma_f32_32x32x16_bf16 v[160:175], v[36:39], a[104:107], v[160:175]
    v_mul_f32 v119, v119, v23
    v_mul_f32 v21, v121, v121
    v_fma_f32 v21, v21, s62, v7
    v_mul_f32 v21, v21, v121
    v_mfma_f32_32x32x16_bf16 v[176:191], v[36:39], a[232:235], v[176:191]
    s_waitcnt lgkmcnt(4)
    ds_read_b64_tr_b16 v[36:37], v9 offset:24576
    ds_read_b64_tr_b16 v[38:39], v9 offset:25600
    v_exp_f32 v21, v21
    v_add_f32 v20, 1.0, v20
    v_rcp_f32 v20, v20
    s_nop 0
    v_mul_f32 v120, v120, v20
    v_mfma_f32_32x32x16_bf16 v[128:143], v[40:43], a[108:111], v[128:143]
    v_mul_f32 v22, v122, v122
    v_fma_f32 v22, v22, s62, v7
    v_mul_f32 v22, v22, v122
    v_exp_f32 v22, v22
    v_mfma_f32_32x32x16_bf16 v[144:159], v[40:43], a[236:239], v[144:159]
    s_waitcnt lgkmcnt(4)
    ds_read_b64_tr_b16 v[40:41], v8 offset:25088
    ds_read_b64_tr_b16 v[42:43], v8 offset:26112
    v_add_f32 v21, 1.0, v21
    v_rcp_f32 v21, v21
    s_nop 0
    v_mul_f32 v121, v121, v21
    v_mul_f32 v23, v123, v123
    v_mfma_f32_32x32x16_bf16 v[160:175], v[44:47], a[108:111], v[160:175]
    v_fma_f32 v23, v23, s62, v7
    v_mul_f32 v23, v23, v123
    v_exp_f32 v23, v23
    v_add_f32 v22, 1.0, v22
    v_mfma_f32_32x32x16_bf16 v[176:191], v[44:47], a[236:239], v[176:191]
    s_waitcnt lgkmcnt(4)
    ds_read_b64_tr_b16 v[44:45], v9 offset:25088
    ds_read_b64_tr_b16 v[46:47], v9 offset:26112
    v_rcp_f32 v22, v22
    s_nop 0
    v_mul_f32 v122, v122, v22
    v_mul_f32 v20, v124, v124
    v_fma_f32 v20, v20, s62, v7
    v_mfma_f32_32x32x16_bf16 v[128:143], v[32:35], a[112:115], v[128:143]
    v_mul_f32 v20, v20, v124
    v_exp_f32 v20, v20
    v_add_f32 v23, 1.0, v23
    v_rcp_f32 v23, v23
    s_nop 0
    v_mul_f32 v123, v123, v23
    v_mfma_f32_32x32x16_bf16 v[144:159], v[32:35], a[240:243], v[144:159]
    s_waitcnt lgkmcnt(4)
    ds_read_b64_tr_b16 v[32:33], v8 offset:28672
    ds_read_b64_tr_b16 v[34:35], v8 offset:29696
    v_mul_f32 v21, v125, v125
    v_fma_f32 v21, v21, s62, v7
    v_mul_f32 v21, v21, v125
    v_exp_f32 v21, v21
    v_mfma_f32_32x32x16_bf16 v[160:175], v[36:39], a[112:115], v[160:175]
    v_add_f32 v20, 1.0, v20
    v_rcp_f32 v20, v20
    s_nop 0
    v_mul_f32 v124, v124, v20
    v_mul_f32 v22, v126, v126
    v_mfma_f32_32x32x16_bf16 v[176:191], v[36:39], a[240:243], v[176:191]
    s_waitcnt lgkmcnt(4)
    ds_read_b64_tr_b16 v[36:37], v9 offset:28672
    ds_read_b64_tr_b16 v[38:39], v9 offset:29696
    v_fma_f32 v22, v22, s62, v7
    v_mul_f32 v22, v22, v126
    v_exp_f32 v22, v22
    v_add_f32 v21, 1.0, v21
    v_mfma_f32_32x32x16_bf16 v[128:143], v[40:43], a[116:119], v[128:143]
    v_rcp_f32 v21, v21
    s_nop 0
    v_mul_f32 v125, v125, v21
    v_mul_f32 v23, v127, v127
    v_fma_f32 v23, v23, s62, v7
    v_mfma_f32_32x32x16_bf16 v[144:159], v[40:43], a[244:247], v[144:159]
    s_waitcnt lgkmcnt(4)
    ds_read_b64_tr_b16 v[40:41], v8 offset:29184
    ds_read_b64_tr_b16 v[42:43], v8 offset:30208
    v_mul_f32 v23, v23, v127
    v_exp_f32 v23, v23
    v_add_f32 v22, 1.0, v22
    v_rcp_f32 v22, v22
    v_mfma_f32_32x32x16_bf16 v[160:175], v[44:47], a[116:119], v[160:175]
    v_mul_f32 v126, v126, v22
    v_add_f32 v23, 1.0, v23
    v_rcp_f32 v23, v23
    s_nop 0
    v_mul_f32 v127, v127, v23
    v_mfma_f32_32x32x16_bf16 v[176:191], v[44:47], a[244:247], v[176:191]
    s_waitcnt lgkmcnt(4)
    ds_read_b64_tr_b16 v[44:45], v9 offset:29184
    ds_read_b64_tr_b16 v[46:47], v9 offset:30208
    v_mfma_f32_32x32x16_bf16 v[128:143], v[32:35], a[120:123], v[128:143]
    v_mfma_f32_32x32x16_bf16 v[144:159], v[32:35], a[248:251], v[144:159]
    s_waitcnt lgkmcnt(4)
    ds_read_b64_tr_b16 v[32:33], v10 offset:0
    ds_read_b64_tr_b16 v[34:35], v10 offset:1024
    v_mfma_f32_32x32x16_bf16 v[160:175], v[36:39], a[120:123], v[160:175]
    v_mfma_f32_32x32x16_bf16 v[176:191], v[36:39], a[248:251], v[176:191]
    s_waitcnt lgkmcnt(4)
    ds_read_b64_tr_b16 v[36:37], v11 offset:0
    ds_read_b64_tr_b16 v[38:39], v11 offset:1024
    v_mfma_f32_32x32x16_bf16 v[128:143], v[40:43], a[124:127], v[128:143]
    v_mfma_f32_32x32x16_bf16 v[144:159], v[40:43], a[252:255], v[144:159]
    s_waitcnt lgkmcnt(4)
    ds_read_b64_tr_b16 v[40:41], v10 offset:512
    ds_read_b64_tr_b16 v[42:43], v10 offset:1536
    v_mfma_f32_32x32x16_bf16 v[160:175], v[44:47], a[124:127], v[160:175]
    v_mfma_f32_32x32x16_bf16 v[176:191], v[44:47], a[252:255], v[176:191]
    v_mov_b32 v8, v10
    v_mov_b32 v9, v11
    s_add_u32 s43, s43, 32768
    s_and_b32 s43, s43, 0x1ffff
    v_add_u32 v10, s43, v12
    v_add_u32 v11, s43, v13
    v_mul_f32 v64, v64, v128
    v_mul_f32 v65, v65, v129
    v_mul_f32 v66, v66, v130
    v_mul_f32 v67, v67, v131
    v_mul_f32 v68, v68, v132
    v_mul_f32 v69, v69, v133
    v_mul_f32 v70, v70, v134
    v_mul_f32 v71, v71, v135
    v_mul_f32 v72, v72, v136
    v_mul_f32 v73, v73, v137
    v_mul_f32 v74, v74, v138
    v_mul_f32 v75, v75, v139
    v_mul_f32 v76, v76, v140
    v_mul_f32 v77, v77, v141
    v_mul_f32 v78, v78, v142
    v_mul_f32 v79, v79, v143
    v_cvt_pk_bf16_f32 v48, v64, v65
    v_cvt_pk_bf16_f32 v49, v66, v67
    v_cvt_pk_bf16_f32 v50, v68, v69
    v_cvt_pk_bf16_f32 v51, v70, v71
    v_cvt_pk_bf16_f32 v52, v72, v73
    v_cvt_pk_bf16_f32 v53, v74, v75
    v_cvt_pk_bf16_f32 v54, v76, v77
    v_cvt_pk_bf16_f32 v55, v78, v79
    s_add_u32 s63, s60, 0
    buffer_store_dwordx4 v[48:51], v15, s[16:19], s63 offen offset:0
    s_add_u32 s63, s60, 32768
    buffer_store_dwordx4 v[52:55], v15, s[16:19], s63 offen offset:0
    v_mul_f32 v80, v80, v144
    v_mul_f32 v81, v81, v145
    v_mul_f32 v82, v82, v146
    v_mul_f32 v83, v83, v147
    v_mul_f32 v84, v84, v148
    v_mul_f32 v85, v85, v149
    v_mul_f32 v86, v86, v150
    v_mul_f32 v87, v87, v151
    v_mul_f32 v88, v88, v152
    v_mul_f32 v89, v89, v153
    v_mul_f32 v90, v90, v154
    v_mul_f32 v91, v91, v155
    v_mul_f32 v92, v92, v156
    v_mul_f32 v93, v93, v157
    v_mul_f32 v94, v94, v158
    v_mul_f32 v95, v95, v159
    v_cvt_pk_bf16_f32 v56, v80, v81
    v_cvt_pk_bf16_f32 v57, v82, v83
    v_cvt_pk_bf16_f32 v58, v84, v85
    v_cvt_pk_bf16_f32 v59, v86, v87
    v_cvt_pk_bf16_f32 v60, v88, v89
    v_cvt_pk_bf16_f32 v61, v90, v91
    v_cvt_pk_bf16_f32 v62, v92, v93
    v_cvt_pk_bf16_f32 v63, v94, v95
    s_add_u32 s63, s60, 0
    buffer_store_dwordx4 v[56:59], v15, s[16:19], s63 offen offset:512
    s_add_u32 s63, s60, 32768
    buffer_store_dwordx4 v[60:63], v15, s[16:19], s63 offen offset:512
    v_mul_f32 v96, v96, v160
    v_mul_f32 v97, v97, v161
    v_mul_f32 v98, v98, v162
    v_mul_f32 v99, v99, v163
    v_mul_f32 v100, v100, v164
    v_mul_f32 v101, v101, v165
    v_mul_f32 v102, v102, v166
    v_mul_f32 v103, v103, v167
    v_mul_f32 v104, v104, v168
    v_mul_f32 v105, v105, v169
    v_mul_f32 v106, v106, v170
    v_mul_f32 v107, v107, v171
    v_mul_f32 v108, v108, v172
    v_mul_f32 v109, v109, v173
    v_mul_f32 v110, v110, v174
    v_mul_f32 v111, v111, v175
    v_cvt_pk_bf16_f32 v48, v96, v97
    v_cvt_pk_bf16_f32 v49, v98, v99
    v_cvt_pk_bf16_f32 v50, v100, v101
    v_cvt_pk_bf16_f32 v51, v102, v103
    v_cvt_pk_bf16_f32 v52, v104, v105
    v_cvt_pk_bf16_f32 v53, v106, v107
    v_cvt_pk_bf16_f32 v54, v108, v109
    v_cvt_pk_bf16_f32 v55, v110, v111
    s_add_u32 s63, s60, 131072
    buffer_store_dwordx4 v[48:51], v15, s[16:19], s63 offen offset:0
    s_add_u32 s63, s60, 163840
    buffer_store_dwordx4 v[52:55], v15, s[16:19], s63 offen offset:0
    v_mul_f32 v112, v112, v176
    v_mul_f32 v113, v113, v177
    v_mul_f32 v114, v114, v178
    v_mul_f32 v115, v115, v179
    v_mul_f32 v116, v116, v180
    v_mul_f32 v117, v117, v181
    v_mul_f32 v118, v118, v182
    v_mul_f32 v119, v119, v183
    v_mul_f32 v120, v120, v184
    v_mul_f32 v121, v121, v185
    v_mul_f32 v122, v122, v186
    v_mul_f32 v123, v123, v187
    v_mul_f32 v124, v124, v188
    v_mul_f32 v125, v125, v189
    v_mul_f32 v126, v126, v190
    v_mul_f32 v127, v127, v191
    v_cvt_pk_bf16_f32 v56, v112, v113
    v_cvt_pk_bf16_f32 v57, v114, v115
    v_cvt_pk_bf16_f32 v58, v116, v117
    v_cvt_pk_bf16_f32 v59, v118, v119
    v_cvt_pk_bf16_f32 v60, v120, v121
    v_cvt_pk_bf16_f32 v61, v122, v123
    v_cvt_pk_bf16_f32 v62, v124, v125
    v_cvt_pk_bf16_f32 v63, v126, v127
    s_add_u32 s63, s60, 131072
    buffer_store_dwordx4 v[56:59], v15, s[16:19], s63 offen offset:512
    s_add_u32 s63, s60, 163840
    buffer_store_dwordx4 v[60:63], v15, s[16:19], s63 offen offset:512
    s_waitcnt vmcnt(0) lgkmcnt(0)
L_f1_end:
    s_endpgm
.globl ffn2_kernel
.p2align 8
.type ffn2_kernel,@function
ffn2_kernel:
    s_cmp_ge_u32 s2, 256
    s_cbranch_scc1 L_f2_end
    s_load_dwordx2 s[18:19], s[0:1], 72
    s_load_dwordx2 s[22:23], s[0:1], 96
    s_load_dwordx2 s[24:25], s[0:1], 112
    v_and_b32 v1, 63, v0
    v_lshrrev_b32 v2, 6, v0
    s_nop 0
    v_readfirstlane_b32 s38, v2
    s_and_b32 s30, s2, 7
    s_lshr_b32 s33, s2, 3
    s_and_b32 s59, s33, 7
    s_lshr_b32 s33, s33, 3
    s_lshl_b32 s31, s30, 2
    s_add_u32 s31, s31, s33
    s_lshl_b32 s39, s31, 6
    v_lshrrev_b32 v2, 4, v1
    v_and_b32 v3, 15, v1
    v_lshrrev_b32 v4, 2, v3
    v_and_b32 v5, 3, v3
    v_lshrrev_b32 v6, 1, v2
    v_lshl_add_u32 v6, v6, 4, v4
    v_lshlrev_b32 v6, 7, v6
    v_and_b32 v7, 1, v2
    v_lshlrev_b32 v7, 1, v7
    v_lshrrev_b32 v2, 1, v5
    v_add_u32 v7, v7, v2
    v_lshrrev_b32 v2, 1, v4
    v_lshl_add_u32 v7, v2, 2, v7
    v_lshl_add_u32 v6, v7, 4, v6
    v_and_b32 v2, 1, v5
    v_lshl_add_u32 v6, v2, 3, v6
    s_lshl_b32 s42, s38, 15
    v_add_u32 v12, s42, v6
    v_xor_b32 v13, 64, v12
    v_lshrrev_b32 v2, 3, v1
    v_bfe_u32 v4, v1, 4, 1
    v_lshlrev_b32 v4, 2, v4
    v_and_b32 v3, 7, v1
    v_xor_b32 v3, v3, v4
    v_lshlrev_b32 v2, 10, v2
    v_lshl_add_u32 v2, v3, 4, v2
    s_mul_i32 s30, s38, 458752
    s_lshl_b32 s31, s59, 7
    s_add_u32 s30, s30, s31
    v_add_u32 v14, s30, v2
    s_waitcnt lgkmcnt(0)
    s_mov_b32 s8, s18
    s_mov_b32 s9, s19
    s_and_b32 s9, s9, 0xffff
    s_mov_b32 s10, 1835008
    s_mov_b32 s11, 0x00020000
    s_add_u32 s4, s24, 111149056
    s_addc_u32 s5, s25, 0
    s_and_b32 s5, s5, 0xffff
    s_mov_b32 s6, 7340032
    s_mov_b32 s7, 0x00020000
    s_mov_b32 s12, s22
    s_mov_b32 s13, s23
    s_and_b32 s13, s13, 0xffff
    s_mov_b32 s14, 2097152
    s_mov_b32 s15, 0x00020000
    s_add_u32 s16, s24, 104857600
    s_addc_u32 s17, s25, 0
    s_and_b32 s17, s17, 0xffff
    s_mov_b32 s18, 4194304
    s_mov_b32 s19, 0x00020000
    s_mov_b32 s20, s24
    s_mov_b32 s21, s25
    s_and_b32 s21, s21, 0xffff
    s_mov_b32 s22, 12288
    s_mov_b32 s23, 0x00020000
    s_add_u32 m0, s42, 0
    s_mov_b32 s44, 0
    buffer_load_dwordx4 v14, s[8:11], s44 offen lds
    s_add_u32 m0, s42, 1024
    s_mov_b32 s44, 8192
    buffer_load_dwordx4 v14, s[8:11], s44 offen lds
    s_add_u32 m0, s42, 2048
    s_mov_b32 s44, 16384
    buffer_load_dwordx4 v14, s[8:11], s44 offen lds
    s_add_u32 m0, s42, 3072
    s_mov_b32 s44, 24576
    buffer_load_dwordx4 v14, s[8:11], s44 offen lds
    s_add_u32 m0, s42, 4096
    s_mov_b32 s44, 32768
    buffer_load_dwordx4 v14, s[8:11], s44 offen lds
    s_add_u32 m0, s42, 5120
    s_mov_b32 s44, 40960
    buffer_load_dwordx4 v14, s[8:11], s44 offen lds
    s_add_u32 m0, s42, 6144
    s_mov_b32 s44, 49152
    buffer_load_dwordx4 v14, s[8:11], s44 offen lds
    s_add_u32 m0, s42, 7168
    s_mov_b32 s44, 57344
    buffer_load_dwordx4 v14, s[8:11], s44 offen lds
    s_add_u32 m0, s42, 8192
    s_mov_b32 s44, 65536
    buffer_load_dwordx4 v14, s[8:11], s44 offen lds
    s_add_u32 m0, s42, 9216
    s_mov_b32 s44, 73728
    buffer_load_dwordx4 v14, s[8:11], s44 offen lds
    s_add_u32 m0, s42, 10240
    s_mov_b32 s44, 81920
    buffer_load_dwordx4 v14, s[8:11], s44 offen lds
    s_add_u32 m0, s42, 11264
    s_mov_b32 s44, 90112
    buffer_load_dwordx4 v14, s[8:11], s44 offen lds
    s_add_u32 m0, s42, 12288
    s_mov_b32 s44, 98304
    buffer_load_dwordx4 v14, s[8:11], s44 offen lds
    s_add_u32 m0, s42, 13312
    s_mov_b32 s44, 106496
    buffer_load_dwordx4 v14, s[8:11], s44 offen lds
    s_add_u32 m0, s42, 14336
    s_mov_b32 s44, 114688
    buffer_load_dwordx4 v14, s[8:11], s44 offen lds
    s_add_u32 m0, s42, 15360
    s_mov_b32 s44, 122880
    buffer_load_dwordx4 v14, s[8:11], s44 offen lds
    v_and_b32 v2, 31, v1
    v_add_u32 v2, s39, v2
    v_lshlrev_b32 v2, 4, v2
    v_lshrrev_b32 v3, 5, v1
    v_lshl_add_u32 v19, v3, 15, v2
    s_mul_i32 s57, s38, 1835008
    s_add_u32 s30, s57, 0
    buffer_load_dwordx4 a[0:3], v19, s[4:7], s30 offen offset:0
    buffer_load_dwordx4 a[112:115], v19, s[4:7], s30 offen offset:512
    s_add_u32 s30, s57, 65536
    buffer_load_dwordx4 a[4:7], v19, s[4:7], s30 offen offset:0
    buffer_load_dwordx4 a[116:119], v19, s[4:7], s30 offen offset:512
    s_add_u32 s30, s57, 131072
    buffer_load_dwordx4 a[8:11], v19, s[4:7], s30 offen offset:0
    buffer_load_dwordx4 a[120:123], v19, s[4:7], s30 offen offset:512
    s_add_u32 s30, s57, 196608
    buffer_load_dwordx4 a[12:15], v19, s[4:7], s30 offen offset:0
    buffer_load_dwordx4 a[124:127], v19, s[4:7], s30 offen offset:512
    s_add_u32 s30, s57, 262144
    buffer_load_dwordx4 a[16:19], v19, s[4:7], s30 offen offset:0
    buffer_load_dwordx4 a[128:131], v19, s[4:7], s30 offen offset:512
    s_add_u32 s30, s57, 327680
    buffer_load_dwordx4 a[20:23], v19, s[4:7], s30 offen offset:0
    buffer_load_dwordx4 a[132:135], v19, s[4:7], s30 offen offset:512
    s_add_u32 s30, s57, 393216
    buffer_load_dwordx4 a[24:27], v19, s[4:7], s30 offen offset:0
    buffer_load_dwordx4 a[136:139], v19, s[4:7], s30 offen offset:512
    s_add_u32 s30, s57, 458752
    buffer_load_dwordx4 a[28:31], v19, s[4:7], s30 offen offset:0
    buffer_load_dwordx4 a[140:143], v19, s[4:7], s30 offen offset:512
    s_add_u32 m0, s42, 16384
    s_mov_b32 s44, 131072
    buffer_load_dwordx4 v14, s[8:11], s44 offen lds
    s_add_u32 m0, s42, 17408
    s_mov_b32 s44, 139264
    buffer_load_dwordx4 v14, s[8:11], s44 offen lds
    s_add_u32 m0, s42, 18432
    s_mov_b32 s44, 147456
    buffer_load_dwordx4 v14, s[8:11], s44 offen lds
    s_add_u32 m0, s42, 19456
    s_mov_b32 s44, 155648
    buffer_load_dwordx4 v14, s[8:11], s44 offen lds
    s_add_u32 m0, s42, 20480
    s_mov_b32 s44, 163840
    buffer_load_dwordx4 v14, s[8:11], s44 offen lds
    s_add_u32 m0, s42, 21504
    s_mov_b32 s44, 172032
    buffer_load_dwordx4 v14, s[8:11], s44 offen lds
    s_add_u32 m0, s42, 22528
    s_mov_b32 s44, 180224
    buffer_load_dwordx4 v14, s[8:11], s44 offen lds
    s_add_u32 m0, s42, 23552
    s_mov_b32 s44, 188416
    buffer_load_dwordx4 v14, s[8:11], s44 offen lds
    s_add_u32 m0, s42, 24576
    s_mov_b32 s44, 196608
    buffer_load_dwordx4 v14, s[8:11], s44 offen lds
    s_add_u32 m0, s42, 25600
    s_mov_b32 s44, 204800
    buffer_load_dwordx4 v14, s[8:11], s44 offen lds
    s_add_u32 m0, s42, 26624
    s_mov_b32 s44, 212992
    buffer_load_dwordx4 v14, s[8:11], s44 offen lds
    s_add_u32 m0, s42, 27648
    s_mov_b32 s44, 221184
    buffer_load_dwordx4 v14, s[8:11], s44 offen lds
    s_add_u32 m0, s42, 28672
    s_mov_b32 s44, 229376
    buffer_load_dwordx4 v14, s[8:11], s44 offen lds
    s_add_u32 m0, s42, 29696
    s_mov_b32 s44, 237568
    buffer_load_dwordx4 v14, s[8:11], s44 offen lds
    s_add_u32 m0, s42, 30720
    s_mov_b32 s44, 245760
    buffer_load_dwordx4 v14, s[8:11], s44 offen lds
    s_add_u32 m0, s42, 31744
    s_mov_b32 s44, 253952
    buffer_load_dwordx4 v14, s[8:11], s44 offen lds
    s_waitcnt vmcnt(32)
    ds_read_b64_tr_b16 v[32:33], v12 offset:0
    ds_read_b64_tr_b16 v[34:35], v12 offset:1024
    ds_read_b64_tr_b16 v[36:37], v13 offset:0
    ds_read_b64_tr_b16 v[38:39], v13 offset:1024
    ds_read_b64_tr_b16 v[40:41], v12 offset:512
    ds_read_b64_tr_b16 v[42:43], v12 offset:1536
    s_waitcnt lgkmcnt(4)
    ds_read_b64_tr_b16 v[44:45], v13 offset:512
    ds_read_b64_tr_b16 v[46:47], v13 offset:1536
    s_add_u32 s30, s57, 524288
    buffer_load_dwordx4 a[32:35], v19, s[4:7], s30 offen offset:0
    buffer_load_dwordx4 a[144:147], v19, s[4:7], s30 offen offset:512
    s_waitcnt vmcnt(32)
    v_mfma_f32_32x32x16_bf16 v[64:79], v[32:35], a[0:3], 0
    v_mfma_f32_32x32x16_bf16 v[80:95], v[32:35], a[112:115], 0
    s_waitcnt lgkmcnt(4)
    ds_read_b64_tr_b16 v[32:33], v12 offset:4096
    ds_read_b64_tr_b16 v[34:35], v12 offset:5120
    v_mfma_f32_32x32x16_bf16 v[96:111], v[36:39], a[0:3], 0
    v_mfma_f32_32x32x16_bf16 v[112:127], v[36:39], a[112:115], 0
    s_waitcnt lgkmcnt(4)
    ds_read_b64_tr_b16 v[36:37], v13 offset:4096
    ds_read_b64_tr_b16 v[38:39], v13 offset:5120
    s_add_u32 s30, s57, 589824
    buffer_load_dwordx4 a[36:39], v19, s[4:7], s30 offen offset:0
    buffer_load_dwordx4 a[148:151], v19, s[4:7], s30 offen offset:512
    s_waitcnt vmcnt(32)
    v_mfma_f32_32x32x16_bf16 v[64:79], v[40:43], a[4:7], v[64:79]
    v_mfma_f32_32x32x16_bf16 v[80:95], v[40:43], a[116:119], v[80:95]
    s_waitcnt lgkmcnt(4)
    ds_read_b64_tr_b16 v[40:41], v12 offset:4608
    ds_read_b64_tr_b16 v[42:43], v12 offset:5632
    v_mfma_f32_32x32x16_bf16 v[96:111], v[44:47], a[4:7], v[96:111]
    v_mfma_f32_32x32x16_bf16 v[112:127], v[44:47], a[116:119], v[112:127]
    s_waitcnt lgkmcnt(4)
    ds_read_b64_tr_b16 v[44:45], v13 offset:4608
    ds_read_b64_tr_b16 v[46:47], v13 offset:5632
    s_add_u32 s30, s57, 655360
    buffer_load_dwordx4 a[40:43], v19, s[4:7], s30 offen offset:0
    buffer_load_dwordx4 a[152:155], v19, s[4:7], s30 offen offset:512
    s_waitcnt vmcnt(32)
    v_mfma_f32_32x32x16_bf16 v[64:79], v[32:35], a[8:11], v[64:79]
    v_mfma_f32_32x32x16_bf16 v[80:95], v[32:35], a[120:123], v[80:95]
    s_waitcnt lgkmcnt(4)
    ds_read_b64_tr_b16 v[32:33], v12 offset:8192
    ds_read_b64_tr_b16 v[34:35], v12 offset:9216
    v_mfma_f32_32x32x16_bf16 v[96:111], v[36:39], a[8:11], v[96:111]
    v_mfma_f32_32x32x16_bf16 v[112:127], v[36:39], a[120:123], v[112:127]
    s_waitcnt lgkmcnt(4)
    ds_read_b64_tr_b16 v[36:37], v13 offset:8192
    ds_read_b64_tr_b16 v[38:39], v13 offset:9216
    s_add_u32 s30, s57, 720896
    buffer_load_dwordx4 a[44:47], v19, s[4:7], s30 offen offset:0
    buffer_load_dwordx4 a[156:159], v19, s[4:7], s30 offen offset:512
    s_waitcnt vmcnt(32)
    v_mfma_f32_32x32x16_bf16 v[64:79], v[40:43], a[12:15], v[64:79]
    v_mfma_f32_32x32x16_bf16 v[80:95], v[40:43], a[124:127], v[80:95]
    s_waitcnt lgkmcnt(4)
    ds_read_b64_tr_b16 v[40:41], v12 offset:8704
    ds_read_b64_tr_b16 v[42:43], v12 offset:9728
    v_mfma_f32_32x32x16_bf16 v[96:111], v[44:47], a[12:15], v[96:111]
    v_mfma_f32_32x32x16_bf16 v[112:127], v[44:47], a[124:127], v[112:127]
    s_waitcnt lgkmcnt(4)
    ds_read_b64_tr_b16 v[44:45], v13 offset:8704
    ds_read_b64_tr_b16 v[46:47], v13 offset:9728
    s_add_u32 s30, s57, 786432
    buffer_load_dwordx4 a[48:51], v19, s[4:7], s30 offen offset:0
    buffer_load_dwordx4 a[160:163], v19, s[4:7], s30 offen offset:512
    s_waitcnt vmcnt(32)
    v_mfma_f32_32x32x16_bf16 v[64:79], v[32:35], a[16:19], v[64:79]
    v_mfma_f32_32x32x16_bf16 v[80:95], v[32:35], a[128:131], v[80:95]
    s_waitcnt lgkmcnt(4)
    ds_read_b64_tr_b16 v[32:33], v12 offset:12288
    ds_read_b64_tr_b16 v[34:35], v12 offset:13312
    v_mfma_f32_32x32x16_bf16 v[96:111], v[36:39], a[16:19], v[96:111]
    v_mfma_f32_32x32x16_bf16 v[112:127], v[36:39], a[128:131], v[112:127]
    s_waitcnt lgkmcnt(4)
    ds_read_b64_tr_b16 v[36:37], v13 offset:12288
    ds_read_b64_tr_b16 v[38:39], v13 offset:13312
    s_add_u32 s30, s57, 851968
    buffer_load_dwordx4 a[52:55], v19, s[4:7], s30 offen offset:0
    buffer_load_dwordx4 a[164:167], v19, s[4:7], s30 offen offset:512
    s_waitcnt vmcnt(32)
    v_mfma_f32_32x32x16_bf16 v[64:79], v[40:43], a[20:23], v[64:79]
    v_mfma_f32_32x32x16_bf16 v[80:95], v[40:43], a[132:135], v[80:95]
    s_waitcnt lgkmcnt(4)
    ds_read_b64_tr_b16 v[40:41], v12 offset:12800
    ds_read_b64_tr_b16 v[42:43], v12 offset:13824
    v_mfma_f32_32x32x16_bf16 v[96:111], v[44:47], a[20:23], v[96:111]
    v_mfma_f32_32x32x16_bf16 v[112:127], v[44:47], a[132:135], v[112:127]
    s_waitcnt lgkmcnt(4)
    ds_read_b64_tr_b16 v[44:45], v13 offset:12800
    ds_read_b64_tr_b16 v[46:47], v13 offset:13824
    s_add_u32 s30, s57, 917504
    buffer_load_dwordx4 a[56:59], v19, s[4:7], s30 offen offset:0
    buffer_load_dwordx4 a[168:171], v19, s[4:7], s30 offen offset:512
    s_waitcnt vmcnt(32)
    v_mfma_f32_32x32x16_bf16 v[64:79], v[32:35], a[24:27], v[64:79]
    v_mfma_f32_32x32x16_bf16 v[80:95], v[32:35], a[136:139], v[80:95]
    s_waitcnt lgkmcnt(4)
    v_mfma_f32_32x32x16_bf16 v[96:111], v[36:39], a[24:27], v[96:111]
    v_mfma_f32_32x32x16_bf16 v[112:127], v[36:39], a[136:139], v[112:127]
    s_waitcnt lgkmcnt(2)
    s_add_u32 s30, s57, 983040
    buffer_load_dwordx4 a[60:63], v19, s[4:7], s30 offen offset:0
    buffer_load_dwordx4 a[172:175], v19, s[4:7], s30 offen offset:512
    s_waitcnt vmcnt(32)
    v_mfma_f32_32x32x16_bf16 v[64:79], v[40:43], a[28:31], v[64:79]
    v_mfma_f32_32x32x16_bf16 v[80:95], v[40:43], a[140:143], v[80:95]
    s_waitcnt lgkmcnt(0)
    v_mfma_f32_32x32x16_bf16 v[96:111], v[44:47], a[28:31], v[96:111]
    v_mfma_f32_32x32x16_bf16 v[112:127], v[44:47], a[140:143], v[112:127]
    s_add_u32 m0, s42, 0
    s_mov_b32 s44, 262144
    buffer_load_dwordx4 v14, s[8:11], s44 offen lds
    s_add_u32 m0, s42, 1024
    s_mov_b32 s44, 270336
    buffer_load_dwordx4 v14, s[8:11], s44 offen lds
    s_add_u32 m0, s42, 2048
    s_mov_b32 s44, 278528
    buffer_load_dwordx4 v14, s[8:11], s44 offen lds
    s_add_u32 m0, s42, 3072
    s_mov_b32 s44, 286720
    buffer_load_dwordx4 v14, s[8:11], s44 offen lds
    s_add_u32 m0, s42, 4096
    s_mov_b32 s44, 294912
    buffer_load_dwordx4 v14, s[8:11], s44 offen lds
    s_add_u32 m0, s42, 5120
    s_mov_b32 s44, 303104
    buffer_load_dwordx4 v14, s[8:11], s44 offen lds
    s_add_u32 m0, s42, 6144
    s_mov_b32 s44, 311296
    buffer_load_dwordx4 v14, s[8:11], s44 offen lds
    s_add_u32 m0, s42, 7168
    s_mov_b32 s44, 319488
    buffer_load_dwordx4 v14, s[8:11], s44 offen lds
    s_add_u32 m0, s42, 8192
    s_mov_b32 s44, 327680
    buffer_load_dwordx4 v14, s[8:11], s44 offen lds
    s_add_u32 m0, s42, 9216
    s_mov_b32 s44, 335872
    buffer_load_dwordx4 v14, s[8:11], s44 offen lds
    s_add_u32 m0, s42, 10240
    s_mov_b32 s44, 344064
    buffer_load_dwordx4 v14, s[8:11], s44 offen lds
    s_add_u32 m0, s42, 11264
    s_mov_b32 s44, 352256
    buffer_load_dwordx4 v14, s[8:11], s44 offen lds
    s_waitcnt vmcnt(28)
    ds_read_b64_tr_b16 v[32:33], v12 offset:16384
    ds_read_b64_tr_b16 v[34:35], v12 offset:17408
    ds_read_b64_tr_b16 v[36:37], v13 offset:16384
    ds_read_b64_tr_b16 v[38:39], v13 offset:17408
    ds_read_b64_tr_b16 v[40:41], v12 offset:16896
    ds_read_b64_tr_b16 v[42:43], v12 offset:17920
    s_waitcnt lgkmcnt(4)
    ds_read_b64_tr_b16 v[44:45], v13 offset:16896
    ds_read_b64_tr_b16 v[46:47], v13 offset:17920
    s_add_u32 s30, s57, 1048576
    buffer_load_dwordx4 a[64:67], v19, s[4:7], s30 offen offset:0
    buffer_load_dwordx4 a[176:179], v19, s[4:7], s30 offen offset:512
    s_waitcnt vmcnt(28)
    v_mfma_f32_32x32x16_bf16 v[64:79], v[32:35], a[32:35], v[64:79]
    v_mfma_f32_32x32x16_bf16 v[80:95], v[32:35], a[144:147], v[80:95]
    s_waitcnt lgkmcnt(4)
    ds_read_b64_tr_b16 v[32:33], v12 offset:20480
    ds_read_b64_tr_b16 v[34:35], v12 offset:21504
    v_mfma_f32_32x32x16_bf16 v[96:111], v[36:39], a[32:35], v[96:111]
    v_mfma_f32_32x32x16_bf16 v[112:127], v[36:39], a[144:147], v[112:127]
    s_waitcnt lgkmcnt(4)
    ds_read_b64_tr_b16 v[36:37], v13 offset:20480
    ds_read_b64_tr_b16 v[38:39], v13 offset:21504
    s_add_u32 s30, s57, 1114112
    buffer_load_dwordx4 a[68:71], v19, s[4:7], s30 offen offset:0
    buffer_load_dwordx4 a[180:183], v19, s[4:7], s30 offen offset:512
    s_waitcnt vmcnt(28)
    v_mfma_f32_32x32x16_bf16 v[64:79], v[40:43], a[36:39], v[64:79]
    v_mfma_f32_32x32x16_bf16 v[80:95], v[40:43], a[148:151], v[80:95]
    s_waitcnt lgkmcnt(4)
    ds_read_b64_tr_b16 v[40:41], v12 offset:20992
    ds_read_b64_tr_b16 v[42:43], v12 offset:22016
    v_mfma_f32_32x32x16_bf16 v[96:111], v[44:47], a[36:39], v[96:111]
    v_mfma_f32_32x32x16_bf16 v[112:127], v[44:47], a[148:151], v[112:127]
    s_waitcnt lgkmcnt(4)
    ds_read_b64_tr_b16 v[44:45], v13 offset:20992
    ds_read_b64_tr_b16 v[46:47], v13 offset:22016
    s_add_u32 s30, s57, 1179648
    buffer_load_dwordx4 a[72:75], v19, s[4:7], s30 offen offset:0
    buffer_load_dwordx4 a[184:187], v19, s[4:7], s30 offen offset:512
    s_waitcnt vmcnt(28)
    v_mfma_f32_32x32x16_bf16 v[64:79], v[32:35], a[40:43], v[64:79]
    v_mfma_f32_32x32x16_bf16 v[80:95], v[32:35], a[152:155], v[80:95]
    s_waitcnt lgkmcnt(4)
    ds_read_b64_tr_b16 v[32:33], v12 offset:24576
    ds_read_b64_tr_b16 v[34:35], v12 offset:25600
    v_mfma_f32_32x32x16_bf16 v[96:111], v[36:39], a[40:43], v[96:111]
    v_mfma_f32_32x32x16_bf16 v[112:127], v[36:39], a[152:155], v[112:127]
    s_waitcnt lgkmcnt(4)
    ds_read_b64_tr_b16 v[36:37], v13 offset:24576
    ds_read_b64_tr_b16 v[38:39], v13 offset:25600
    s_add_u32 s30, s57, 1245184
    buffer_load_dwordx4 a[76:79], v19, s[4:7], s30 offen offset:0
    buffer_load_dwordx4 a[188:191], v19, s[4:7], s30 offen offset:512
    s_waitcnt vmcnt(28)
    v_mfma_f32_32x32x16_bf16 v[64:79], v[40:43], a[44:47], v[64:79]
    v_mfma_f32_32x32x16_bf16 v[80:95], v[40:43], a[156:159], v[80:95]
    s_waitcnt lgkmcnt(4)
    ds_read_b64_tr_b16 v[40:41], v12 offset:25088
    ds_read_b64_tr_b16 v[42:43], v12 offset:26112
    v_mfma_f32_32x32x16_bf16 v[96:111], v[44:47], a[44:47], v[96:111]
    v_mfma_f32_32x32x16_bf16 v[112:127], v[44:47], a[156:159], v[112:127]
    s_waitcnt lgkmcnt(4)
    ds_read_b64_tr_b16 v[44:45], v13 offset:25088
    ds_read_b64_tr_b16 v[46:47], v13 offset:26112
    s_add_u32 s30, s57, 1310720
    buffer_load_dwordx4 a[80:83], v19, s[4:7], s30 offen offset:0
    buffer_load_dwordx4 a[192:195], v19, s[4:7], s30 offen offset:512
    s_waitcnt vmcnt(28)
    v_mfma_f32_32x32x16_bf16 v[64:79], v[32:35], a[48:51], v[64:79]
    v_mfma_f32_32x32x16_bf16 v[80:95], v[32:35], a[160:163], v[80:95]
    s_waitcnt lgkmcnt(4)
    ds_read_b64_tr_b16 v[32:33], v12 offset:28672
    ds_read_b64_tr_b16 v[34:35], v12 offset:29696
    v_mfma_f32_32x32x16_bf16 v[96:111], v[36:39], a[48:51], v[96:111]
    v_mfma_f32_32x32x16_bf16 v[112:127], v[36:39], a[160:163], v[112:127]
    s_waitcnt lgkmcnt(4)
    ds_read_b64_tr_b16 v[36:37], v13 offset:28672
    ds_read_b64_tr_b16 v[38:39], v13 offset:29696
    s_add_u32 s30, s57, 1376256
    buffer_load_dwordx4 a[84:87], v19, s[4:7], s30 offen offset:0
    buffer_load_dwordx4 a[196:199], v19, s[4:7], s30 offen offset:512
    s_waitcnt vmcnt(28)
    v_mfma_f32_32x32x16_bf16 v[64:79], v[40:43], a[52:55], v[64:79]
    v_mfma_f32_32x32x16_bf16 v[80:95], v[40:43], a[164:167], v[80:95]
    s_waitcnt lgkmcnt(4)
    ds_read_b64_tr_b16 v[40:41], v12 offset:29184
    ds_read_b64_tr_b16 v[42:43], v12 offset:30208
    v_mfma_f32_32x32x16_bf16 v[96:111], v[44:47], a[52:55], v[96:111]
    v_mfma_f32_32x32x16_bf16 v[112:127], v[44:47], a[164:167], v[112:127]
    s_waitcnt lgkmcnt(4)
    ds_read_b64_tr_b16 v[44:45], v13 offset:29184
    ds_read_b64_tr_b16 v[46:47], v13 offset:30208
    s_add_u32 s30, s57, 1441792
    buffer_load_dwordx4 a[88:91], v19, s[4:7], s30 offen offset:0
    buffer_load_dwordx4 a[200:203], v19, s[4:7], s30 offen offset:512
    s_waitcnt vmcnt(28)
    v_mfma_f32_32x32x16_bf16 v[64:79], v[32:35], a[56:59], v[64:79]
    v_mfma_f32_32x32x16_bf16 v[80:95], v[32:35], a[168:171], v[80:95]
    s_waitcnt lgkmcnt(4)
    v_mfma_f32_32x32x16_bf16 v[96:111], v[36:39], a[56:59], v[96:111]
    v_mfma_f32_32x32x16_bf16 v[112:127], v[36:39], a[168:171], v[112:127]
    s_waitcnt lgkmcnt(2)
    s_add_u32 s30, s57, 1507328
    buffer_load_dwordx4 a[92:95], v19, s[4:7], s30 offen offset:0
    buffer_load_dwordx4 a[204:207], v19, s[4:7], s30 offen offset:512
    s_waitcnt vmcnt(28)
    v_mfma_f32_32x32x16_bf16 v[64:79], v[40:43], a[60:63], v[64:79]
    v_mfma_f32_32x32x16_bf16 v[80:95], v[40:43], a[172:175], v[80:95]
    s_waitcnt lgkmcnt(0)
    v_mfma_f32_32x32x16_bf16 v[96:111], v[44:47], a[60:63], v[96:111]
    v_mfma_f32_32x32x16_bf16 v[112:127], v[44:47], a[172:175], v[112:127]
    s_add_u32 m0, s42, 16384
    s_mov_b32 s44, 360448
    buffer_load_dwordx4 v14, s[8:11], s44 offen lds
    s_add_u32 m0, s42, 17408
    s_mov_b32 s44, 368640
    buffer_load_dwordx4 v14, s[8:11], s44 offen lds
    s_add_u32 m0, s42, 18432
    s_mov_b32 s44, 376832
    buffer_load_dwordx4 v14, s[8:11], s44 offen lds
    s_add_u32 m0, s42, 19456
    s_mov_b32 s44, 385024
    buffer_load_dwordx4 v14, s[8:11], s44 offen lds
    s_add_u32 m0, s42, 20480
    s_mov_b32 s44, 393216
    buffer_load_dwordx4 v14, s[8:11], s44 offen lds
    s_add_u32 m0, s42, 21504
    s_mov_b32 s44, 401408
    buffer_load_dwordx4 v14, s[8:11], s44 offen lds
    s_add_u32 m0, s42, 22528
    s_mov_b32 s44, 409600
    buffer_load_dwordx4 v14, s[8:11], s44 offen lds
    s_add_u32 m0, s42, 23552
    s_mov_b32 s44, 417792
    buffer_load_dwordx4 v14, s[8:11], s44 offen lds
    s_add_u32 m0, s42, 24576
    s_mov_b32 s44, 425984
    buffer_load_dwordx4 v14, s[8:11], s44 offen lds
    s_add_u32 m0, s42, 25600
    s_mov_b32 s44, 434176
    buffer_load_dwordx4 v14, s[8:11], s44 offen lds
    s_add_u32 m0, s42, 26624
    s_mov_b32 s44, 442368
    buffer_load_dwordx4 v14, s[8:11], s44 offen lds
    s_add_u32 m0, s42, 27648
    s_mov_b32 s44, 450560
    buffer_load_dwordx4 v14, s[8:11], s44 offen lds
    s_lshr_b32 s31, s38, 1
    s_and_b32 s32, s38, 1
    v_and_b32 v20, 31, v1
    v_lshrrev_b32 v21, 5, v1
    s_lshl_b32 s33, s32, 5
    s_add_u32 s33, s33, s39
    v_add_u32 v22, s33, v20
    v_lshlrev_b32 v23, 4, v22
    v_lshl_add_u32 v23, v21, 17, v23
    s_lshl_b32 s34, s59, 19
    s_lshl_b32 s35, s31, 18
    s_add_u32 s34, s34, s35
    s_add_u32 s36, s34, 0
    buffer_load_dwordx4 v[128:131], v23, s[16:19], s36 offen
    s_add_u32 s36, s34, 32768
    buffer_load_dwordx4 v[132:135], v23, s[16:19], s36 offen
    s_add_u32 s36, s34, 65536
    buffer_load_dwordx4 v[136:139], v23, s[16:19], s36 offen
    s_add_u32 s36, s34, 98304
    buffer_load_dwordx4 v[140:143], v23, s[16:19], s36 offen
    s_lshl_b32 s34, s59, 8
    s_lshl_b32 s35, s31, 7
    s_add_u32 s34, s34, s35
    s_add_u32 s34, s34, 10240
    v_lshlrev_b32 v24, 4, v21
    buffer_load_dwordx4 v[144:147], v24, s[20:23], s34 offen offset:0
    buffer_load_dwordx4 v[148:151], v24, s[20:23], s34 offen offset:32
    buffer_load_dwordx4 v[152:155], v24, s[20:23], s34 offen offset:64
    buffer_load_dwordx4 v[156:159], v24, s[20:23], s34 offen offset:96
    s_waitcnt vmcnt(36)
    ds_read_b64_tr_b16 v[32:33], v12 offset:0
    ds_read_b64_tr_b16 v[34:35], v12 offset:1024
    ds_read_b64_tr_b16 v[36:37], v13 offset:0
    ds_read_b64_tr_b16 v[38:39], v13 offset:1024
    ds_read_b64_tr_b16 v[40:41], v12 offset:512
    ds_read_b64_tr_b16 v[42:43], v12 offset:1536
    s_waitcnt lgkmcnt(4)
    ds_read_b64_tr_b16 v[44:45], v13 offset:512
    ds_read_b64_tr_b16 v[46:47], v13 offset:1536
    s_add_u32 s30, s57, 1572864
    buffer_load_dwordx4 a[96:99], v19, s[4:7], s30 offen offset:0
    buffer_load_dwordx4 a[208:211], v19, s[4:7], s30 offen offset:512
    s_waitcnt vmcnt(36)
    v_mfma_f32_32x32x16_bf16 v[64:79], v[32:35], a[64:67], v[64:79]
    v_mfma_f32_32x32x16_bf16 v[80:95], v[32:35], a[176:179], v[80:95]
    s_waitcnt lgkmcnt(4)
    ds_read_b64_tr_b16 v[32:33], v12 offset:4096
    ds_read_b64_tr_b16 v[34:35], v12 offset:5120
    v_mfma_f32_32x32x16_bf16 v[96:111], v[36:39], a[64:67], v[96:111]
    v_mfma_f32_32x32x16_bf16 v[112:127], v[36:39], a[176:179], v[112:127]
    s_waitcnt lgkmcnt(4)
    ds_read_b64_tr_b16 v[36:37], v13 offset:4096
    ds_read_b64_tr_b16 v[38:39], v13 offset:5120
    s_add_u32 s30, s57, 1638400
    buffer_load_dwordx4 a[100:103], v19, s[4:7], s30 offen offset:0
    buffer_load_dwordx4 a[212:215], v19, s[4:7], s30 offen offset:512
    s_waitcnt vmcnt(36)
    v_mfma_f32_32x32x16_bf16 v[64:79], v[40:43], a[68:71], v[64:79]
    v_mfma_f32_32x32x16_bf16 v[80:95], v[40:43], a[180:183], v[80:95]
    s_waitcnt lgkmcnt(4)
    ds_read_b64_tr_b16 v[40:41], v12 offset:4608
    ds_read_b64_tr_b16 v[42:43], v12 offset:5632
    v_mfma_f32_32x32x16_bf16 v[96:111], v[44:47], a[68:71], v[96:111]
    v_mfma_f32_32x32x16_bf16 v[112:127], v[44:47], a[180:183], v[112:127]
    s_waitcnt lgkmcnt(4)
    ds_read_b64_tr_b16 v[44:45], v13 offset:4608
    ds_read_b64_tr_b16 v[46:47], v13 offset:5632
    s_add_u32 s30, s57, 1703936
    buffer_load_dwordx4 a[104:107], v19, s[4:7], s30 offen offset:0
    buffer_load_dwordx4 a[216:219], v19, s[4:7], s30 offen offset:512
    s_waitcnt vmcnt(36)
    v_mfma_f32_32x32x16_bf16 v[64:79], v[32:35], a[72:75], v[64:79]
    v_mfma_f32_32x32x16_bf16 v[80:95], v[32:35], a[184:187], v[80:95]
    s_waitcnt lgkmcnt(4)
    ds_read_b64_tr_b16 v[32:33], v12 offset:8192
    ds_read_b64_tr_b16 v[34:35], v12 offset:9216
    v_mfma_f32_32x32x16_bf16 v[96:111], v[36:39], a[72:75], v[96:111]
    v_mfma_f32_32x32x16_bf16 v[112:127], v[36:39], a[184:187], v[112:127]
    s_waitcnt lgkmcnt(4)
    ds_read_b64_tr_b16 v[36:37], v13 offset:8192
    ds_read_b64_tr_b16 v[38:39], v13 offset:9216
    s_add_u32 s30, s57, 1769472
    buffer_load_dwordx4 a[108:111], v19, s[4:7], s30 offen offset:0
    buffer_load_dwordx4 a[220:223], v19, s[4:7], s30 offen offset:512
    s_waitcnt vmcnt(36)
    v_mfma_f32_32x32x16_bf16 v[64:79], v[40:43], a[76:79], v[64:79]
    v_mfma_f32_32x32x16_bf16 v[80:95], v[40:43], a[188:191], v[80:95]
    s_waitcnt lgkmcnt(4)
    ds_read_b64_tr_b16 v[40:41], v12 offset:8704
    ds_read_b64_tr_b16 v[42:43], v12 offset:9728
    v_mfma_f32_32x32x16_bf16 v[96:111], v[44:47], a[76:79], v[96:111]
    v_mfma_f32_32x32x16_bf16 v[112:127], v[44:47], a[188:191], v[112:127]
    s_waitcnt lgkmcnt(4)
    ds_read_b64_tr_b16 v[44:45], v13 offset:8704
    ds_read_b64_tr_b16 v[46:47], v13 offset:9728
    s_waitcnt vmcnt(34)
    v_mfma_f32_32x32x16_bf16 v[64:79], v[32:35], a[80:83], v[64:79]
    v_mfma_f32_32x32x16_bf16 v[80:95], v[32:35], a[192:195], v[80:95]
    s_waitcnt lgkmcnt(4)
    v_mfma_f32_32x32x16_bf16 v[96:111], v[36:39], a[80:83], v[96:111]
    v_mfma_f32_32x32x16_bf16 v[112:127], v[36:39], a[192:195], v[112:127]
    s_waitcnt lgkmcnt(2)
    s_waitcnt vmcnt(32)
    v_mfma_f32_32x32x16_bf16 v[64:79], v[40:43], a[84:87], v[64:79]
    v_mfma_f32_32x32x16_bf16 v[80:95], v[40:43], a[196:199], v[80:95]
    s_waitcnt lgkmcnt(0)
    v_mfma_f32_32x32x16_bf16 v[96:111], v[44:47], a[84:87], v[96:111]
    v_mfma_f32_32x32x16_bf16 v[112:127], v[44:47], a[196:199], v[112:127]
    s_waitcnt vmcnt(16)
    ds_read_b64_tr_b16 v[32:33], v12 offset:16384
    ds_read_b64_tr_b16 v[34:35], v12 offset:17408
    ds_read_b64_tr_b16 v[36:37], v13 offset:16384
    ds_read_b64_tr_b16 v[38:39], v13 offset:17408
    ds_read_b64_tr_b16 v[40:41], v12 offset:16896
    ds_read_b64_tr_b16 v[42:43], v12 offset:17920
    s_waitcnt lgkmcnt(4)
    ds_read_b64_tr_b16 v[44:45], v13 offset:16896
    ds_read_b64_tr_b16 v[46:47], v13 offset:17920
    s_waitcnt vmcnt(30)
    v_mfma_f32_32x32x16_bf16 v[64:79], v[32:35], a[88:91], v[64:79]
    v_mfma_f32_32x32x16_bf16 v[80:95], v[32:35], a[200:203], v[80:95]
    s_waitcnt lgkmcnt(4)
    ds_read_b64_tr_b16 v[32:33], v12 offset:20480
    ds_read_b64_tr_b16 v[34:35], v12 offset:21504
    v_mfma_f32_32x32x16_bf16 v[96:111], v[36:39], a[88:91], v[96:111]
    v_mfma_f32_32x32x16_bf16 v[112:127], v[36:39], a[200:203], v[112:127]
    s_waitcnt lgkmcnt(4)
    ds_read_b64_tr_b16 v[36:37], v13 offset:20480
    ds_read_b64_tr_b16 v[38:39], v13 offset:21504
    s_waitcnt vmcnt(28)
    v_mfma_f32_32x32x16_bf16 v[64:79], v[40:43], a[92:95], v[64:79]
    v_mfma_f32_32x32x16_bf16 v[80:95], v[40:43], a[204:207], v[80:95]
    s_waitcnt lgkmcnt(4)
    ds_read_b64_tr_b16 v[40:41], v12 offset:20992
    ds_read_b64_tr_b16 v[42:43], v12 offset:22016
    v_mfma_f32_32x32x16_bf16 v[96:111], v[44:47], a[92:95], v[96:111]
    v_mfma_f32_32x32x16_bf16 v[112:127], v[44:47], a[204:207], v[112:127]
    s_waitcnt lgkmcnt(4)
    ds_read_b64_tr_b16 v[44:45], v13 offset:20992
    ds_read_b64_tr_b16 v[46:47], v13 offset:22016
    s_waitcnt vmcnt(6)
    v_mfma_f32_32x32x16_bf16 v[64:79], v[32:35], a[96:99], v[64:79]
    v_mfma_f32_32x32x16_bf16 v[80:95], v[32:35], a[208:211], v[80:95]
    s_waitcnt lgkmcnt(4)
    ds_read_b64_tr_b16 v[32:33], v12 offset:24576
    ds_read_b64_tr_b16 v[34:35], v12 offset:25600
    v_mfma_f32_32x32x16_bf16 v[96:111], v[36:39], a[96:99], v[96:111]
    v_mfma_f32_32x32x16_bf16 v[112:127], v[36:39], a[208:211], v[112:127]
    s_waitcnt lgkmcnt(4)
    ds_read_b64_tr_b16 v[36:37], v13 offset:24576
    ds_read_b64_tr_b16 v[38:39], v13 offset:25600
    s_waitcnt vmcnt(4)
    v_mfma_f32_32x32x16_bf16 v[64:79], v[40:43], a[100:103], v[64:79]
    v_mfma_f32_32x32x16_bf16 v[80:95], v[40:43], a[212:215], v[80:95]
    s_waitcnt lgkmcnt(4)
    ds_read_b64_tr_b16 v[40:41], v12 offset:25088
    ds_read_b64_tr_b16 v[42:43], v12 offset:26112
    v_mfma_f32_32x32x16_bf16 v[96:111], v[44:47], a[100:103], v[96:111]
    v_mfma_f32_32x32x16_bf16 v[112:127], v[44:47], a[212:215], v[112:127]
    s_waitcnt lgkmcnt(4)
    ds_read_b64_tr_b16 v[44:45], v13 offset:25088
    ds_read_b64_tr_b16 v[46:47], v13 offset:26112
    s_waitcnt vmcnt(2)
    v_mfma_f32_32x32x16_bf16 v[64:79], v[32:35], a[104:107], v[64:79]
    v_mfma_f32_32x32x16_bf16 v[80:95], v[32:35], a[216:219], v[80:95]
    s_waitcnt lgkmcnt(4)
    v_mfma_f32_32x32x16_bf16 v[96:111], v[36:39], a[104:107], v[96:111]
    v_mfma_f32_32x32x16_bf16 v[112:127], v[36:39], a[216:219], v[112:127]
    s_waitcnt lgkmcnt(2)
    s_waitcnt vmcnt(0)
    v_mfma_f32_32x32x16_bf16 v[64:79], v[40:43], a[108:111], v[64:79]
    v_mfma_f32_32x32x16_bf16 v[80:95], v[40:43], a[220:223], v[80:95]
    s_waitcnt lgkmcnt(0)
    v_mfma_f32_32x32x16_bf16 v[96:111], v[44:47], a[108:111], v[96:111]
    v_mfma_f32_32x32x16_bf16 v[112:127], v[44:47], a[220:223], v[112:127]
    s_barrier
    s_lshl_b32 s30, s38, 14
    v_lshlrev_b32 v2, 4, v1
    v_add_u32 v3, s30, v2
    s_nop 3
    ds_write_b128 v3, v[64:67] offset:0
    ds_write_b128 v3, v[68:71] offset:1024
    ds_write_b128 v3, v[72:75] offset:2048
    ds_write_b128 v3, v[76:79] offset:3072
    ds_write_b128 v3, v[80:83] offset:4096
    ds_write_b128 v3, v[84:87] offset:5120
    ds_write_b128 v3, v[88:91] offset:6144
    ds_write_b128 v3, v[92:95] offset:7168
    ds_write_b128 v3, v[96:99] offset:8192
    ds_write_b128 v3, v[100:103] offset:9216
    ds_write_b128 v3, v[104:107] offset:10240
    ds_write_b128 v3, v[108:111] offset:11264
    ds_write_b128 v3, v[112:115] offset:12288
    ds_write_b128 v3, v[116:119] offset:13312
    ds_write_b128 v3, v[120:123] offset:14336
    ds_write_b128 v3, v[124:127] offset:15360
    s_waitcnt lgkmcnt(0)
    s_barrier
    s_lshl_b32 s30, s38, 12
    v_add_u32 v3, s30, v2
    ds_read_b128 v[64:67], v3 offset:0
    ds_read_b128 v[68:71], v3 offset:1024
    ds_read_b128 v[72:75], v3 offset:2048
    ds_read_b128 v[76:79], v3 offset:3072
    ds_read_b128 v[80:83], v3 offset:16384
    ds_read_b128 v[84:87], v3 offset:17408
    ds_read_b128 v[88:91], v3 offset:18432
    ds_read_b128 v[92:95], v3 offset:19456
    ds_read_b128 v[96:99], v3 offset:32768
    ds_read_b128 v[100:103], v3 offset:33792
    ds_read_b128 v[104:107], v3 offset:34816
    ds_read_b128 v[108:111], v3 offset:35840
    ds_read_b128 v[112:115], v3 offset:49152
    ds_read_b128 v[116:119], v3 offset:50176
    ds_read_b128 v[120:123], v3 offset:51200
    ds_read_b128 v[124:127], v3 offset:52224
    s_waitcnt lgkmcnt(0)
    v_add_f32 v64, v64, v80
    v_add_f32 v96, v96, v112
    v_add_f32 v64, v64, v96
    v_add_f32 v65, v65, v81
    v_add_f32 v97, v97, v113
    v_add_f32 v65, v65, v97
    v_add_f32 v66, v66, v82
    v_add_f32 v98, v98, v114
    v_add_f32 v66, v66, v98
    v_add_f32 v67, v67, v83
    v_add_f32 v99, v99, v115
    v_add_f32 v67, v67, v99
    v_add_f32 v68, v68, v84
    v_add_f32 v100, v100, v116
    v_add_f32 v68, v68, v100
    v_add_f32 v69, v69, v85
    v_add_f32 v101, v101, v117
    v_add_f32 v69, v69, v101
    v_add_f32 v70, v70, v86
    v_add_f32 v102, v102, v118
    v_add_f32 v70, v70, v102
    v_add_f32 v71, v71, v87
    v_add_f32 v103, v103, v119
    v_add_f32 v71, v71, v103
    v_add_f32 v72, v72, v88
    v_add_f32 v104, v104, v120
    v_add_f32 v72, v72, v104
    v_add_f32 v73, v73, v89
    v_add_f32 v105, v105, v121
    v_add_f32 v73, v73, v105
    v_add_f32 v74, v74, v90
    v_add_f32 v106, v106, v122
    v_add_f32 v74, v74, v106
    v_add_f32 v75, v75, v91
    v_add_f32 v107, v107, v123
    v_add_f32 v75, v75, v107
    v_add_f32 v76, v76, v92
    v_add_f32 v108, v108, v124
    v_add_f32 v76, v76, v108
    v_add_f32 v77, v77, v93
    v_add_f32 v109, v109, v125
    v_add_f32 v77, v77, v109
    v_add_f32 v78, v78, v94
    v_add_f32 v110, v110, v126
    v_add_f32 v78, v78, v110
    v_add_f32 v79, v79, v95
    v_add_f32 v111, v111, v127
    v_add_f32 v79, v79, v111
    s_waitcnt vmcnt(0)
    v_fma_f32 v64, v64, v144, v128
    v_fma_f32 v65, v65, v145, v129
    v_fma_f32 v66, v66, v146, v130
    v_fma_f32 v67, v67, v147, v131
    v_fma_f32 v68, v68, v148, v132
    v_fma_f32 v69, v69, v149, v133
    v_fma_f32 v70, v70, v150, v134
    v_fma_f32 v71, v71, v151, v135
    v_fma_f32 v72, v72, v152, v136
    v_fma_f32 v73, v73, v153, v137
    v_fma_f32 v74, v74, v154, v138
    v_fma_f32 v75, v75, v155, v139
    v_fma_f32 v76, v76, v156, v140
    v_fma_f32 v77, v77, v157, v141
    v_fma_f32 v78, v78, v158, v142
    v_fma_f32 v79, v79, v159, v143
    v_cvt_pk_bf16_f32 v32, v64, v65
    v_cvt_pk_bf16_f32 v33, v66, v67
    v_cvt_pk_bf16_f32 v34, v68, v69
    v_cvt_pk_bf16_f32 v35, v70, v71
    v_cvt_pk_bf16_f32 v36, v72, v73
    v_cvt_pk_bf16_f32 v37, v74, v75
    v_cvt_pk_bf16_f32 v38, v76, v77
    v_cvt_pk_bf16_f32 v39, v78, v79
    v_lshlrev_b32 v7, 10, v22
    v_lshl_add_u32 v7, v21, 3, v7
    s_lshl_b32 s34, s59, 7
    s_lshl_b32 s35, s31, 6
    s_add_u32 s34, s34, s35
    buffer_store_dwordx2 v[32:33], v7, s[12:15], s34 offen offset:0
    buffer_store_dwordx2 v[34:35], v7, s[12:15], s34 offen offset:16
    buffer_store_dwordx2 v[36:37], v7, s[12:15], s34 offen offset:32
    buffer_store_dwordx2 v[38:39], v7, s[12:15], s34 offen offset:48
    s_waitcnt vmcnt(0)
L_f2_end:
    s_endpgm
.section .rodata,"a"
.p2align 6
.amdhsa_kernel front_kernel
  .amdhsa_next_free_vgpr 96
  .amdhsa_next_free_sgpr 102
  .amdhsa_accum_offset 96
  .amdhsa_group_segment_fixed_size 0
  .amdhsa_kernarg_size 120
  .amdhsa_user_sgpr_count 2
  .amdhsa_user_sgpr_kernarg_segment_ptr 1
  .amdhsa_system_sgpr_workgroup_id_x 1
.end_amdhsa_kernel
.p2align 6
.amdhsa_kernel qkv_kernel
  .amdhsa_next_free_vgpr 448
  .amdhsa_next_free_sgpr 102
  .amdhsa_accum_offset 192
  .amdhsa_group_segment_fixed_size 0
  .amdhsa_kernarg_size 120
  .amdhsa_user_sgpr_count 2
  .amdhsa_user_sgpr_kernarg_segment_ptr 1
  .amdhsa_system_sgpr_workgroup_id_x 1
.end_amdhsa_kernel
.p2align 6
.amdhsa_kernel attn_kernel
  .amdhsa_next_free_vgpr 256
  .amdhsa_next_free_sgpr 102
  .amdhsa_accum_offset 128
  .amdhsa_group_segment_fixed_size 0
  .amdhsa_kernarg_size 120
  .amdhsa_user_sgpr_count 2
  .amdhsa_user_sgpr_kernarg_segment_ptr 1
  .amdhsa_system_sgpr_workgroup_id_x 1
.end_amdhsa_kernel
.p2align 6
.amdhsa_kernel oproj_kernel
  .amdhsa_next_free_vgpr 448
  .amdhsa_next_free_sgpr 102
  .amdhsa_accum_offset 192
  .amdhsa_group_segment_fixed_size 0
  .amdhsa_kernarg_size 120
  .amdhsa_user_sgpr_count 2
  .amdhsa_user_sgpr_kernarg_segment_ptr 1
  .amdhsa_system_sgpr_workgroup_id_x 1
.end_amdhsa_kernel
.p2align 6
.amdhsa_kernel red_kernel
  .amdhsa_next_free_vgpr 160
  .amdhsa_next_free_sgpr 102
  .amdhsa_accum_offset 160
  .amdhsa_group_segment_fixed_size 0
  .amdhsa_kernarg_size 120
  .amdhsa_user_sgpr_count 2
  .amdhsa_user_sgpr_kernarg_segment_ptr 1
  .amdhsa_system_sgpr_workgroup_id_x 1
.end_amdhsa_kernel
.p2align 6
.amdhsa_kernel ffn1_kernel
  .amdhsa_next_free_vgpr 480
  .amdhsa_next_free_sgpr 102
  .amdhsa_accum_offset 224
  .amdhsa_group_segment_fixed_size 0
  .amdhsa_kernarg_size 120
  .amdhsa_user_sgpr_count 2
  .amdhsa_user_sgpr_kernarg_segment_ptr 1
  .amdhsa_system_sgpr_workgroup_id_x 1
.end_amdhsa_kernel
.p2align 6
.amdhsa_kernel ffn2_kernel
  .amdhsa_next_free_vgpr 448
  .amdhsa_next_free_sgpr 102
  .amdhsa_accum_offset 192
  .amdhsa_group_segment_fixed_size 0
  .amdhsa_kernarg_size 120
  .amdhsa_user_sgpr_count 2
  .amdhsa_user_sgpr_kernarg_segment_ptr 1
  .amdhsa_system_sgpr_workgroup_id_x 1
.end_amdhsa_kernel
```
